```python
import torch

def _softmax(x, axis=-1):
    return torch.softmax(x, dim=axis)
def _gelu(x):
    return torch.nn.functional.gelu(x, approximate="tanh")
def _silu(x):
    return torch.nn.functional.silu(x)
def _sigmoid(x):
    return torch.sigmoid(x)
def _layernorm(x, axis=-1, eps=1e-5):
    m = x.mean(dim=axis, keepdim=True)
    v = x.var(dim=axis, keepdim=True, unbiased=False)
    return (x - m) / torch.sqrt(v + eps)
def _scatter_add(tgt, idx, src, axis=0):
    return tgt.clone().index_add_(axis, idx, src)
def _segment_sum(src, seg, n):
    out = torch.zeros((n,) + src.shape[1:], dtype=src.dtype)
    return out.index_add_(0, seg, src)
def _pad(x, pw):
    flat = tuple(v for pair in reversed(pw) for v in pair)
    return torch.nn.functional.pad(x, flat)

kernel_name = 'concat_heads__linear_kernel_hedgehog__ssm_conv_s5__prompt'

def setup_inputs():

    _w = (lambda a: (lambda t: t.to(torch.bfloat16) if t.is_floating_point() else t)(torch.as_tensor(a)))
    def _A_setup():
        B, S, D, H = 1, 2048, 1024, 32
        Dh = D // H
        return {
            "x": _w((lambda *s: torch.randn(*s, dtype=torch.bfloat16) * 0.4)(B, S, D)),
            "wqkv": _w((lambda *s: torch.randn(*s, dtype=torch.bfloat16) * 0.4)(D, 3 * D)),
            "w_phi": _w((lambda *s: torch.randn(*s, dtype=torch.bfloat16) * 0.4)(H, Dh, Dh) * (Dh ** -0.5)),
            "wo": _w((lambda *s: torch.randn(*s, dtype=torch.bfloat16) * 0.05)(D, D)),
        }
    _A_in = _A_setup()

    def _B_setup():
        B, S, D = 1, 2048, 1024
        P = D
        Lambda_re = -0.5 * (lambda _x: torch.exp(torch.as_tensor(_x)))((lambda *s: torch.randn(*s, dtype=torch.bfloat16) * 0.8)(P))
        Lambda_im = (lambda *s: torch.randn(*s, dtype=torch.bfloat16) * 0.8)(P) * 1.0
        B_re = (lambda *s: torch.randn(*s, dtype=torch.bfloat16) * 0.8)(P, D) * (D ** -0.5)
        B_im = (lambda *s: torch.randn(*s, dtype=torch.bfloat16) * 0.8)(P, D) * (D ** -0.5)
        C_re = (lambda *s: torch.randn(*s, dtype=torch.bfloat16) * 0.8)(D, P) * (P ** -0.5)
        C_im = (lambda *s: torch.randn(*s, dtype=torch.bfloat16) * 0.8)(D, P) * (P ** -0.5)
        log_dt = (lambda *s: torch.randn(*s, dtype=torch.bfloat16) * 0.8)(P) * 0.3 - 2.0
        Dskip = (lambda *s: torch.randn(*s, dtype=torch.bfloat16) * 0.8)(D)
        return {
            "x": _w((lambda *s: torch.randn(*s, dtype=torch.bfloat16) * 0.05)(B, S, D)),
            "Lambda_re": _w(Lambda_re),
            "Lambda_im": _w(Lambda_im),
            "B_re": _w(B_re),
            "B_im": _w(B_im),
            "C_re": _w(C_re),
            "C_im": _w(C_im),
            "log_dt": _w(log_dt),
            "Dskip": _w(Dskip),
        }
    _B_in = _B_setup()

    return {
        "A_x": _A_in["x"],
        "A_wqkv": _A_in["wqkv"],
        "A_w_phi": _A_in["w_phi"],
        "A_wo": _A_in["wo"],
        "B_x": _B_in["x"],
        "B_Lambda_re": _B_in["Lambda_re"],
        "B_Lambda_im": _B_in["Lambda_im"],
        "B_B_re": _B_in["B_re"],
        "B_B_im": _B_in["B_im"],
        "B_C_re": _B_in["C_re"],
        "B_C_im": _B_in["C_im"],
        "B_log_dt": _B_in["log_dt"],
        "B_Dskip": _B_in["Dskip"],
    }

def reference(A_x, A_wqkv, A_w_phi, A_wo, B_x, B_Lambda_re, B_Lambda_im, B_B_re, B_B_im, B_C_re, B_C_im, B_log_dt, B_Dskip):
    def _A_ref(x, wqkv, w_phi, wo):
        B, S, D = x.shape
        H = 32; Dh = D // H
        qkv = (lambda x, *d: x.permute(*d))((x @ wqkv).reshape(B, S, 3, H, Dh), 2, 0, 3, 1, 4)
        q, k, v = qkv[0], qkv[1], qkv[2]
        pq = torch.einsum("bhsd,hdf->bhsf", q, w_phi)
        pk = torch.einsum("bhsd,hdf->bhsf", k, w_phi)
        phi_q = torch.concatenate([_softmax(pq, axis=-1), _softmax(-pq, axis=-1)], axis=-1)
        phi_k = torch.concatenate([_softmax(pk, axis=-1), _softmax(-pk, axis=-1)], axis=-1)
        kv = torch.einsum("bhsf,bhsd->bhfd", phi_k, v)
        z  = torch.einsum("bhsf->bhf", phi_k)
        num = torch.einsum("bhqf,bhfd->bhqd", phi_q, kv)
        den = torch.einsum("bhqf,bhf->bhq", phi_q, z)[..., None] + 1e-6
        o = num / den
        return (lambda x, *d: x.permute(*d))(o, 0, 2, 1, 3).reshape(B, S, D) @ wo

    def _B_ref(x, Lambda_re, Lambda_im, B_re, B_im, C_re, C_im, log_dt, Dskip):
        Bsz, L, H = x.shape
        Lam = Lambda_re + 1j * Lambda_im
        Bmat = B_re + 1j * B_im
        Cmat = C_re + 1j * C_im
        dt = torch.exp(log_dt)
        Lam_bar = torch.exp(dt * Lam)
        B_bar = ((Lam_bar - 1.0) / Lam)[:, None] * Bmat
        Bu = torch.einsum("bld,pd->blp", x + 0j, B_bar)
        h = torch.zeros_like(Bu[:, 0, :])
        hs = []
        for t in range(L):
            h = Lam_bar[None, :] * h + Bu[:, t, :]
            hs.append(h)
        hseq = torch.stack(hs, 1)
        y = 2.0 * torch.einsum("blp,dp->bld", hseq, Cmat).real + x * Dskip[None, None, :]
        return y

    a = _A_ref(A_x, A_wqkv, A_w_phi, A_wo)
    b = _B_ref(B_x, B_Lambda_re, B_Lambda_im, B_B_re, B_B_im, B_C_re, B_C_im, B_log_dt, B_Dskip)
    return torch.concatenate([a, b], axis=-1)
```

```asm
; @launch grid=(256,1,1) block=(512,1,1) lds=163840
.amdgcn_target "amdgcn-amd-amdhsa--gfx950"
.text
.globl concat_heads__linear_kernel_hedgehog__ssm_conv_s5__prompt_kernel
.p2align 8
.type concat_heads__linear_kernel_hedgehog__ssm_conv_s5__prompt_kernel,@function
concat_heads__linear_kernel_hedgehog__ssm_conv_s5__prompt_kernel:
    s_cmp_ge_u32 s2, 256
    s_cbranch_scc1 Lend_1
    s_load_dwordx16 s[4:19], s[0:1], 0
    s_load_dwordx16 s[20:35], s[0:1], 64
    v_and_b32 v1, 63, v0
    v_lshrrev_b32 v0, 6, v0
    s_nop 0
    v_readfirstlane_b32 s36, v0
    s_and_b32 s3, s2, 1
    s_lshl_b32 s37, s3, 2
    s_bfe_u32 s3, s2, 0x20003
    s_add_u32 s37, s37, s3
    s_bfe_u32 s3, s2, 0x10001
    s_lshl_b32 s38, s3, 3
    s_lshr_b32 s3, s2, 5
    s_add_u32 s38, s38, s3
    s_bfe_u32 s39, s2, 0x40003
    s_bitcmp1_b32 s2, 2
    s_cbranch_scc1 Lmap_2
    s_bfe_u32 s37, s2, 0x30003
    s_and_b32 s3, s2, 3
    s_lshl_b32 s38, s3, 2
    s_lshr_b32 s3, s2, 6
    s_add_u32 s38, s38, s3
Lmap_2:
    s_bitcmp1_b32 s2, 2
    s_cbranch_scc1 Lrot_3
    s_and_b32 s3, s38, 3
    s_mul_i32 s39, s3, 1
    s_mul_i32 s3, s37, 8
    s_lshr_b32 s3, s3, 2
    s_add_u32 s39, s39, s3
    s_and_b32 s3, s2, 3
    s_mul_i32 s3, s3, 0
    s_add_u32 s39, s39, s3
    s_and_b32 s39, s39, 15
Lrot_3:
    s_sub_u32 s42, s36, 4
    s_waitcnt lgkmcnt(0)
    s_bitcmp1_b32 s2, 2
    s_cbranch_scc1 LchB_72
    s_cmp_ge_u32 s36, 4
    s_cbranch_scc1 LsAl_69
    s_branch LsAc_68
LchB_72:
    s_cmp_ge_u32 s36, 4
    s_cbranch_scc1 LsBl_71
    s_branch LsBc_70
LsAl_69:
    s_lshl_b32 s59, s37, 8
    s_lshl_b32 s54, s39, 7
    s_mul_i32 s55, s39, 393216
    s_mov_b32 s56, s55
    s_lshl_b32 s57, s42, 10
    s_mov_b32 s58, s57
    s_mov_b32 s60, s4
    s_mov_b32 s61, s5
    s_mov_b32 s62, 4194304
    s_mov_b32 s63, 0x20000
    v_lshrrev_b32 v5, 3, v1
    s_mov_b32 s44, 2048
    v_mul_lo_u32 v5, v5, s44
    v_lshrrev_b32 v2, 4, v1
    v_xor_b32 v2, v2, v1
    v_and_b32 v2, 7, v2
    s_and_b32 s44, s42, 1
    s_lshl_b32 s44, s44, 2
    v_xor_b32 v2, s44, v2
    v_lshl_add_u32 v5, v2, 4, v5
    s_mul_i32 s44, s42, 16384
    v_add_u32 v5, s44, v5
    s_add_u32 s44, s59, 0
    s_mul_i32 s44, s44, 2048
    v_add_u32 v88, s44, v5
    s_add_u32 s44, s59, 32
    s_mul_i32 s44, s44, 2048
    v_add_u32 v89, s44, v5
    s_add_u32 s44, s59, 64
    s_mul_i32 s44, s44, 2048
    v_add_u32 v90, s44, v5
    s_add_u32 s44, s59, 96
    s_mul_i32 s44, s44, 2048
    v_add_u32 v91, s44, v5
    s_add_u32 s44, s59, 128
    s_mul_i32 s44, s44, 2048
    v_add_u32 v92, s44, v5
    s_add_u32 s44, s59, 160
    s_mul_i32 s44, s44, 2048
    v_add_u32 v93, s44, v5
    s_add_u32 s44, s59, 192
    s_mul_i32 s44, s44, 2048
    v_add_u32 v94, s44, v5
    s_add_u32 s44, s59, 224
    s_mul_i32 s44, s44, 2048
    v_add_u32 v95, s44, v5
    s_add_u32 m0, s57, 0
    s_nop 0
    buffer_load_dwordx4 v88, s[60:63], s54 offen lds
    s_add_u32 m0, s57, 4096
    s_nop 0
    buffer_load_dwordx4 v89, s[60:63], s54 offen lds
    s_add_u32 m0, s57, 8192
    s_nop 0
    buffer_load_dwordx4 v90, s[60:63], s54 offen lds
    s_add_u32 m0, s57, 12288
    s_nop 0
    buffer_load_dwordx4 v91, s[60:63], s54 offen lds
    s_add_u32 m0, s57, 16384
    s_nop 0
    buffer_load_dwordx4 v92, s[60:63], s54 offen lds
    s_add_u32 m0, s57, 20480
    s_nop 0
    buffer_load_dwordx4 v93, s[60:63], s54 offen lds
    s_add_u32 m0, s57, 24576
    s_nop 0
    buffer_load_dwordx4 v94, s[60:63], s54 offen lds
    s_add_u32 m0, s57, 28672
    s_nop 0
    buffer_load_dwordx4 v95, s[60:63], s54 offen lds
    s_add_u32 s54, s54, 128
    s_cmp_ge_u32 s54, 2048
    s_cselect_b32 s54, 0, s54
    s_add_u32 s57, s57, 32768
    s_cmp_ge_u32 s57, 98304
    s_cselect_b32 s59, 98304, 0
    s_sub_u32 s57, s57, s59
    s_mov_b32 s64, s6
    s_mov_b32 s65, s7
    s_mov_b32 s66, 6291456
    s_mov_b32 s67, 0x20000
    v_lshrrev_b32 v5, 3, v1
    s_lshl_b32 s44, s42, 3
    v_add_u32 v5, s44, v5
    s_mov_b32 s44, 6144
    v_mul_lo_u32 v5, v5, s44
    v_lshrrev_b32 v2, 3, v1
    v_and_b32 v2, 2, v2
    v_xor_b32 v2, v2, v1
    v_and_b32 v2, 7, v2
    s_and_b32 s44, s42, 1
    s_lshl_b32 s44, s44, 2
    v_xor_b32 v2, s44, v2
    v_and_b32 v3, 3, v2
    v_lshl_add_u32 v5, v3, 4, v5
    v_lshrrev_b32 v3, 2, v2
    s_mov_b32 s44, 2048
    v_mul_lo_u32 v3, v3, s44
    v_add_u32 v5, v5, v3
    s_lshl_b32 s44, s38, 7
    s_add_u32 s44, s44, 2048
    v_add_u32 v96, s44, v5
    s_lshl_b32 s44, s38, 7
    s_add_u32 s44, s44, 198656
    v_add_u32 v97, s44, v5
    s_lshl_b32 s44, s38, 7
    s_add_u32 s44, s44, 2112
    v_add_u32 v98, s44, v5
    s_lshl_b32 s44, s38, 7
    s_add_u32 s44, s44, 198720
    v_add_u32 v99, s44, v5
    s_add_u32 m0, s58, 98304
    s_nop 0
    buffer_load_dwordx4 v96, s[64:67], s55 offen lds
    s_add_u32 m0, s58, 102400
    s_nop 0
    buffer_load_dwordx4 v97, s[64:67], s55 offen lds
    s_add_u32 s58, s58, 8192
    s_and_b32 s58, s58, 0xffff
    s_add_u32 m0, s58, 98304
    s_nop 0
    buffer_load_dwordx4 v98, s[64:67], s55 offen lds
    s_add_u32 m0, s58, 102400
    s_nop 0
    buffer_load_dwordx4 v99, s[64:67], s55 offen lds
    s_add_u32 s58, s58, 8192
    s_and_b32 s58, s58, 0xffff
    s_add_u32 s55, s55, 393216
    s_cmp_ge_u32 s55, 6291456
    s_cselect_b32 s55, 0, s55
    v_lshrrev_b32 v5, 3, v1
    s_lshl_b32 s44, s42, 3
    v_add_u32 v5, s44, v5
    s_mov_b32 s44, 6144
    v_mul_lo_u32 v5, v5, s44
    v_lshrrev_b32 v2, 3, v1
    v_and_b32 v2, 2, v2
    v_xor_b32 v2, v2, v1
    v_and_b32 v2, 7, v2
    s_and_b32 s44, s42, 1
    s_lshl_b32 s44, s44, 2
    v_xor_b32 v2, s44, v2
    v_lshl_add_u32 v5, v2, 4, v5
    s_lshl_b32 s44, s38, 7
    s_add_u32 s44, s44, 0
    v_add_u32 v100, s44, v5
    s_lshl_b32 s44, s38, 7
    s_add_u32 s44, s44, 196608
    v_add_u32 v101, s44, v5
    s_add_u32 m0, s58, 98304
    s_nop 0
    buffer_load_dwordx4 v100, s[64:67], s56 offen lds
    s_add_u32 m0, s58, 102400
    s_nop 0
    buffer_load_dwordx4 v101, s[64:67], s56 offen lds
    s_add_u32 s58, s58, 8192
    s_and_b32 s58, s58, 0xffff
    s_add_u32 s56, s56, 393216
    s_cmp_ge_u32 s56, 6291456
    s_cselect_b32 s56, 0, s56
    s_add_u32 m0, s57, 0
    s_nop 0
    buffer_load_dwordx4 v88, s[60:63], s54 offen lds
    s_add_u32 m0, s57, 4096
    s_nop 0
    buffer_load_dwordx4 v89, s[60:63], s54 offen lds
    s_add_u32 m0, s57, 8192
    s_nop 0
    buffer_load_dwordx4 v90, s[60:63], s54 offen lds
    s_add_u32 m0, s57, 12288
    s_nop 0
    buffer_load_dwordx4 v91, s[60:63], s54 offen lds
    s_add_u32 m0, s57, 16384
    s_nop 0
    buffer_load_dwordx4 v92, s[60:63], s54 offen lds
    s_add_u32 m0, s57, 20480
    s_nop 0
    buffer_load_dwordx4 v93, s[60:63], s54 offen lds
    s_add_u32 m0, s57, 24576
    s_nop 0
    buffer_load_dwordx4 v94, s[60:63], s54 offen lds
    s_add_u32 m0, s57, 28672
    s_nop 0
    buffer_load_dwordx4 v95, s[60:63], s54 offen lds
    s_add_u32 s54, s54, 128
    s_cmp_ge_u32 s54, 2048
    s_cselect_b32 s54, 0, s54
    s_add_u32 s57, s57, 32768
    s_cmp_ge_u32 s57, 98304
    s_cselect_b32 s59, 98304, 0
    s_sub_u32 s57, s57, s59
    s_add_u32 m0, s58, 98304
    s_nop 0
    buffer_load_dwordx4 v96, s[64:67], s55 offen lds
    s_add_u32 m0, s58, 102400
    s_nop 0
    buffer_load_dwordx4 v97, s[64:67], s55 offen lds
    s_add_u32 s58, s58, 8192
    s_and_b32 s58, s58, 0xffff
    s_add_u32 m0, s58, 98304
    s_nop 0
    buffer_load_dwordx4 v98, s[64:67], s55 offen lds
    s_add_u32 m0, s58, 102400
    s_nop 0
    buffer_load_dwordx4 v99, s[64:67], s55 offen lds
    s_add_u32 s58, s58, 8192
    s_and_b32 s58, s58, 0xffff
    s_add_u32 s55, s55, 393216
    s_cmp_ge_u32 s55, 6291456
    s_cselect_b32 s55, 0, s55
    s_mov_b32 s52, 1069066811
    s_mov_b32 s53, 1069066811
    s_lshl_b32 s44, s42, 13
    v_and_b32 v2, 15, v1
    v_lshlrev_b32 v2, 7, v2
    v_lshrrev_b32 v3, 4, v1
    v_bfe_u32 v4, v1, 1, 3
    v_xor_b32 v3, v3, v4
    v_lshl_add_u32 v2, v3, 4, v2
    v_add_u32 v2, s44, v2
    v_xor_b32 v102, 0, v2
    v_xor_b32 v103, 64, v2
    v_lshrrev_b32 v2, 4, v1
    v_lshlrev_b32 v2, 3, v2
    v_bfe_u32 v3, v1, 2, 2
    v_add_u32 v2, v2, v3
    v_lshlrev_b32 v2, 7, v2
    v_bfe_u32 v3, v1, 3, 2
    v_lshl_add_u32 v2, v3, 5, v2
    v_and_b32 v3, 3, v1
    v_lshl_add_u32 v2, v3, 3, v2
    v_add_u32 v2, 98304, v2
    v_xor_b32 v106, 0, v2
    v_xor_b32 v107, 32, v2
    v_xor_b32 v108, 64, v2
    v_xor_b32 v109, 96, v2
    v_mov_b32 v8, 0
    v_mov_b32 v9, 0
    v_mov_b32 v10, 0
    v_mov_b32 v11, 0
    v_mov_b32 v12, 0
    v_mov_b32 v13, 0
    v_mov_b32 v14, 0
    v_mov_b32 v15, 0
    v_mov_b32 v16, 0
    v_mov_b32 v17, 0
    v_mov_b32 v18, 0
    v_mov_b32 v19, 0
    v_mov_b32 v20, 0
    v_mov_b32 v21, 0
    v_mov_b32 v22, 0
    v_mov_b32 v23, 0
    v_mov_b32 v24, 0
    v_mov_b32 v25, 0
    v_mov_b32 v26, 0
    v_mov_b32 v27, 0
    v_mov_b32 v28, 0
    v_mov_b32 v29, 0
    v_mov_b32 v30, 0
    v_mov_b32 v31, 0
    v_mov_b32 v32, 0
    v_mov_b32 v33, 0
    v_mov_b32 v34, 0
    v_mov_b32 v35, 0
    v_mov_b32 v36, 0
    v_mov_b32 v37, 0
    v_mov_b32 v38, 0
    v_mov_b32 v39, 0
    v_mov_b32 v40, 0
    v_mov_b32 v41, 0
    v_mov_b32 v42, 0
    v_mov_b32 v43, 0
    v_mov_b32 v44, 0
    v_mov_b32 v45, 0
    v_mov_b32 v46, 0
    v_mov_b32 v47, 0
    v_mov_b32 v48, 0
    v_mov_b32 v49, 0
    v_mov_b32 v50, 0
    v_mov_b32 v51, 0
    v_mov_b32 v52, 0
    v_mov_b32 v53, 0
    v_mov_b32 v54, 0
    v_mov_b32 v55, 0
    v_mov_b32 v56, 0
    v_mov_b32 v57, 0
    v_mov_b32 v58, 0
    v_mov_b32 v59, 0
    v_mov_b32 v60, 0
    v_mov_b32 v61, 0
    v_mov_b32 v62, 0
    v_mov_b32 v63, 0
    v_mov_b32 v64, 0
    v_mov_b32 v65, 0
    v_mov_b32 v66, 0
    v_mov_b32 v67, 0
    v_mov_b32 v68, 0
    v_mov_b32 v69, 0
    v_mov_b32 v70, 0
    v_mov_b32 v71, 0
    s_mov_b32 s48, 0
    s_mov_b32 s49, 16384
    v_add_u32 v104, s48, v102
    v_add_u32 v105, s48, v103
    v_add_u32 v110, s49, v106
    v_add_u32 v111, s49, v107
    v_add_u32 v112, s49, v108
    v_add_u32 v113, s49, v109
    s_mov_b32 s68, s8
    s_mov_b32 s69, s9
    s_mov_b32 s70, 65536
    s_mov_b32 s71, 0x20000
    v_lshrrev_b32 v2, 2, v1
    v_lshlrev_b32 v180, 6, v2
    v_and_b32 v2, 3, v1
    v_lshl_add_u32 v180, v2, 3, v180
    s_lshl_b32 s46, s38, 12
    v_add_u32 v180, s46, v180
    s_cmp_eq_u32 s42, 0
    s_cbranch_scc0 Linv_39
Linv_39:
    s_and_b32 s72, s37, 3
    s_lshl_b32 s72, s72, 1
    s_and_b32 s73, s38, 1
    s_add_u32 s72, s72, s73
    s_lshl_b32 s72, s72, 2
    s_add_u32 s72, s72, s42
    s_lshr_b32 s73, s38, 1
    s_lshl_b32 s73, s73, 8
    s_lshl_b32 s72, s72, 16
    s_add_u32 s72, s72, s73
    v_lshrrev_b32 v181, 4, v1
    v_lshlrev_b32 v181, 11, v181
    v_and_b32 v184, 15, v1
    v_lshl_add_u32 v181, v184, 4, v181
    s_mov_b32 s76, s10
    s_mov_b32 s77, s11
    s_mov_b32 s78, 2097152
    s_mov_b32 s79, 0x20000
    s_waitcnt vmcnt(12)
    s_barrier
    s_add_u32 m0, s58, 98304
    s_nop 0
    buffer_load_dwordx4 v100, s[64:67], s56 offen lds
    s_add_u32 m0, s58, 102400
    s_nop 0
    buffer_load_dwordx4 v101, s[64:67], s56 offen lds
    s_add_u32 s58, s58, 8192
    s_and_b32 s58, s58, 0xffff
    s_add_u32 s56, s56, 393216
    s_cmp_ge_u32 s56, 6291456
    s_cselect_b32 s56, 0, s56
    s_add_u32 m0, s57, 0
    s_nop 0
    buffer_load_dwordx4 v88, s[60:63], s54 offen lds
    s_add_u32 m0, s57, 4096
    s_nop 0
    buffer_load_dwordx4 v89, s[60:63], s54 offen lds
    s_add_u32 m0, s57, 8192
    s_nop 0
    buffer_load_dwordx4 v90, s[60:63], s54 offen lds
    s_add_u32 m0, s57, 12288
    s_nop 0
    buffer_load_dwordx4 v91, s[60:63], s54 offen lds
    s_add_u32 m0, s57, 16384
    s_nop 0
    buffer_load_dwordx4 v92, s[60:63], s54 offen lds
    s_add_u32 m0, s57, 20480
    s_nop 0
    buffer_load_dwordx4 v93, s[60:63], s54 offen lds
    s_add_u32 m0, s57, 24576
    s_nop 0
    buffer_load_dwordx4 v94, s[60:63], s54 offen lds
    s_add_u32 m0, s57, 28672
    s_nop 0
    buffer_load_dwordx4 v95, s[60:63], s54 offen lds
    s_add_u32 s54, s54, 128
    s_cmp_ge_u32 s54, 2048
    s_cselect_b32 s54, 0, s54
    s_add_u32 s57, s57, 32768
    s_cmp_ge_u32 s57, 98304
    s_cselect_b32 s59, 98304, 0
    s_sub_u32 s57, s57, s59
    s_add_u32 m0, s58, 98304
    s_nop 0
    buffer_load_dwordx4 v96, s[64:67], s55 offen lds
    s_add_u32 m0, s58, 102400
    s_nop 0
    buffer_load_dwordx4 v97, s[64:67], s55 offen lds
    s_add_u32 s58, s58, 8192
    s_and_b32 s58, s58, 0xffff
    s_add_u32 m0, s58, 98304
    s_nop 0
    buffer_load_dwordx4 v98, s[64:67], s55 offen lds
    s_add_u32 m0, s58, 102400
    s_nop 0
    buffer_load_dwordx4 v99, s[64:67], s55 offen lds
    s_add_u32 s58, s58, 8192
    s_and_b32 s58, s58, 0xffff
    s_add_u32 s55, s55, 393216
    s_cmp_ge_u32 s55, 6291456
    s_cselect_b32 s55, 0, s55
    ds_read_b128 v[116:119], v104 offset:0
    ds_read_b128 v[120:123], v104 offset:2048
    ds_read_b128 v[124:127], v104 offset:4096
    ds_read_b128 v[128:131], v104 offset:6144
    ds_read_b64_tr_b16 v[148:149], v110 offset:0
    ds_read_b64_tr_b16 v[150:151], v110 offset:512
    ds_read_b64_tr_b16 v[152:153], v111 offset:0
    ds_read_b64_tr_b16 v[154:155], v111 offset:512
    ds_read_b64_tr_b16 v[156:157], v112 offset:0
    ds_read_b64_tr_b16 v[158:159], v112 offset:512
    ds_read_b64_tr_b16 v[160:161], v113 offset:0
    ds_read_b64_tr_b16 v[162:163], v113 offset:512
    s_mov_b32 s50, 0
Lmm_40:
    s_waitcnt lgkmcnt(0)
    v_mfma_f32_16x16x32_bf16 v[8:11], v[148:151], v[116:119], v[8:11]
    ds_read_b128 v[132:135], v105 offset:0
    ds_read_b128 v[136:139], v105 offset:2048
    v_mfma_f32_16x16x32_bf16 v[12:15], v[152:155], v[116:119], v[12:15]
    ds_read_b128 v[140:143], v105 offset:4096
    ds_read_b128 v[144:147], v105 offset:6144
    v_mfma_f32_16x16x32_bf16 v[16:19], v[156:159], v[116:119], v[16:19]
    ds_read_b64_tr_b16 v[164:165], v110 offset:4096
    ds_read_b64_tr_b16 v[166:167], v110 offset:4608
    v_mfma_f32_16x16x32_bf16 v[20:23], v[160:163], v[116:119], v[20:23]
    ds_read_b64_tr_b16 v[168:169], v111 offset:4096
    ds_read_b64_tr_b16 v[170:171], v111 offset:4608
    v_mfma_f32_16x16x32_bf16 v[24:27], v[148:151], v[120:123], v[24:27]
    ds_read_b64_tr_b16 v[172:173], v112 offset:4096
    ds_read_b64_tr_b16 v[174:175], v112 offset:4608
    v_mfma_f32_16x16x32_bf16 v[28:31], v[152:155], v[120:123], v[28:31]
    ds_read_b64_tr_b16 v[176:177], v113 offset:4096
    ds_read_b64_tr_b16 v[178:179], v113 offset:4608
    v_mfma_f32_16x16x32_bf16 v[32:35], v[156:159], v[120:123], v[32:35]
    s_add_u32 s48, s48, 32768
    s_cmp_ge_u32 s48, 98304
    s_cselect_b32 s48, 0, s48
    s_add_u32 s49, s49, 24576
    s_and_b32 s49, s49, 0xffff
    v_add_u32 v104, s48, v102
    v_mfma_f32_16x16x32_bf16 v[36:39], v[160:163], v[120:123], v[36:39]
    v_add_u32 v105, s48, v103
    v_add_u32 v110, s49, v106
    v_mfma_f32_16x16x32_bf16 v[40:43], v[148:151], v[124:127], v[40:43]
    v_add_u32 v111, s49, v107
    v_add_u32 v112, s49, v108
    v_mfma_f32_16x16x32_bf16 v[44:47], v[152:155], v[124:127], v[44:47]
    v_add_u32 v113, s49, v109
    v_mfma_f32_16x16x32_bf16 v[48:51], v[156:159], v[124:127], v[48:51]
    v_mfma_f32_16x16x32_bf16 v[52:55], v[160:163], v[124:127], v[52:55]
    v_mfma_f32_16x16x32_bf16 v[56:59], v[148:151], v[128:131], v[56:59]
    v_mfma_f32_16x16x32_bf16 v[60:63], v[152:155], v[128:131], v[60:63]
    v_mfma_f32_16x16x32_bf16 v[64:67], v[156:159], v[128:131], v[64:67]
    v_mfma_f32_16x16x32_bf16 v[68:71], v[160:163], v[128:131], v[68:71]
    s_waitcnt lgkmcnt(0)
    v_mfma_f32_16x16x32_bf16 v[8:11], v[164:167], v[132:135], v[8:11]
    s_waitcnt vmcnt(12)
    s_barrier
    s_add_u32 m0, s58, 98304
    s_nop 0
    buffer_load_dwordx4 v100, s[64:67], s56 offen lds
    s_add_u32 m0, s58, 102400
    s_nop 0
    buffer_load_dwordx4 v101, s[64:67], s56 offen lds
    s_add_u32 s58, s58, 8192
    s_and_b32 s58, s58, 0xffff
    s_add_u32 s56, s56, 393216
    s_cmp_ge_u32 s56, 6291456
    s_cselect_b32 s56, 0, s56
    s_add_u32 m0, s57, 0
    s_nop 0
    buffer_load_dwordx4 v88, s[60:63], s54 offen lds
    s_add_u32 m0, s57, 4096
    s_nop 0
    buffer_load_dwordx4 v89, s[60:63], s54 offen lds
    s_add_u32 m0, s57, 8192
    s_nop 0
    buffer_load_dwordx4 v90, s[60:63], s54 offen lds
    s_add_u32 m0, s57, 12288
    s_nop 0
    buffer_load_dwordx4 v91, s[60:63], s54 offen lds
    s_add_u32 m0, s57, 16384
    s_nop 0
    buffer_load_dwordx4 v92, s[60:63], s54 offen lds
    s_add_u32 m0, s57, 20480
    s_nop 0
    buffer_load_dwordx4 v93, s[60:63], s54 offen lds
    s_add_u32 m0, s57, 24576
    s_nop 0
    buffer_load_dwordx4 v94, s[60:63], s54 offen lds
    s_add_u32 m0, s57, 28672
    s_nop 0
    buffer_load_dwordx4 v95, s[60:63], s54 offen lds
    s_add_u32 s54, s54, 128
    s_cmp_ge_u32 s54, 2048
    s_cselect_b32 s54, 0, s54
    s_add_u32 s57, s57, 32768
    s_cmp_ge_u32 s57, 98304
    s_cselect_b32 s59, 98304, 0
    s_sub_u32 s57, s57, s59
    s_add_u32 m0, s58, 98304
    s_nop 0
    buffer_load_dwordx4 v96, s[64:67], s55 offen lds
    s_add_u32 m0, s58, 102400
    s_nop 0
    buffer_load_dwordx4 v97, s[64:67], s55 offen lds
    s_add_u32 s58, s58, 8192
    s_and_b32 s58, s58, 0xffff
    s_add_u32 m0, s58, 98304
    s_nop 0
    buffer_load_dwordx4 v98, s[64:67], s55 offen lds
    s_add_u32 m0, s58, 102400
    s_nop 0
    buffer_load_dwordx4 v99, s[64:67], s55 offen lds
    s_add_u32 s58, s58, 8192
    s_and_b32 s58, s58, 0xffff
    s_add_u32 s55, s55, 393216
    s_cmp_ge_u32 s55, 6291456
    s_cselect_b32 s55, 0, s55
    ds_read_b128 v[116:119], v104 offset:0
    v_mfma_f32_16x16x32_bf16 v[12:15], v[168:171], v[132:135], v[12:15]
    ds_read_b128 v[120:123], v104 offset:2048
    v_mfma_f32_16x16x32_bf16 v[16:19], v[172:175], v[132:135], v[16:19]
    ds_read_b128 v[124:127], v104 offset:4096
    v_mfma_f32_16x16x32_bf16 v[20:23], v[176:179], v[132:135], v[20:23]
    ds_read_b128 v[128:131], v104 offset:6144
    v_mfma_f32_16x16x32_bf16 v[24:27], v[164:167], v[136:139], v[24:27]
    ds_read_b64_tr_b16 v[148:149], v110 offset:0
    v_mfma_f32_16x16x32_bf16 v[28:31], v[168:171], v[136:139], v[28:31]
    ds_read_b64_tr_b16 v[150:151], v110 offset:512
    v_mfma_f32_16x16x32_bf16 v[32:35], v[172:175], v[136:139], v[32:35]
    ds_read_b64_tr_b16 v[152:153], v111 offset:0
    v_mfma_f32_16x16x32_bf16 v[36:39], v[176:179], v[136:139], v[36:39]
    ds_read_b64_tr_b16 v[154:155], v111 offset:512
    v_mfma_f32_16x16x32_bf16 v[40:43], v[164:167], v[140:143], v[40:43]
    ds_read_b64_tr_b16 v[156:157], v112 offset:0
    v_mfma_f32_16x16x32_bf16 v[44:47], v[168:171], v[140:143], v[44:47]
    ds_read_b64_tr_b16 v[158:159], v112 offset:512
    v_mfma_f32_16x16x32_bf16 v[48:51], v[172:175], v[140:143], v[48:51]
    ds_read_b64_tr_b16 v[160:161], v113 offset:0
    v_mfma_f32_16x16x32_bf16 v[52:55], v[176:179], v[140:143], v[52:55]
    ds_read_b64_tr_b16 v[162:163], v113 offset:512
    v_mfma_f32_16x16x32_bf16 v[56:59], v[164:167], v[144:147], v[56:59]
    v_mfma_f32_16x16x32_bf16 v[60:63], v[168:171], v[144:147], v[60:63]
    v_mfma_f32_16x16x32_bf16 v[64:67], v[172:175], v[144:147], v[64:67]
    v_mfma_f32_16x16x32_bf16 v[68:71], v[176:179], v[144:147], v[68:71]
    s_add_u32 s50, s50, 1
    s_cmp_lt_u32 s50, 13
    s_cbranch_scc1 Lmm_40
    s_waitcnt lgkmcnt(0)
    v_mfma_f32_16x16x32_bf16 v[8:11], v[148:151], v[116:119], v[8:11]
    ds_read_b128 v[132:135], v105 offset:0
    ds_read_b128 v[136:139], v105 offset:2048
    v_mfma_f32_16x16x32_bf16 v[12:15], v[152:155], v[116:119], v[12:15]
    ds_read_b128 v[140:143], v105 offset:4096
    ds_read_b128 v[144:147], v105 offset:6144
    v_mfma_f32_16x16x32_bf16 v[16:19], v[156:159], v[116:119], v[16:19]
    ds_read_b64_tr_b16 v[164:165], v110 offset:4096
    ds_read_b64_tr_b16 v[166:167], v110 offset:4608
    v_mfma_f32_16x16x32_bf16 v[20:23], v[160:163], v[116:119], v[20:23]
    ds_read_b64_tr_b16 v[168:169], v111 offset:4096
    ds_read_b64_tr_b16 v[170:171], v111 offset:4608
    v_mfma_f32_16x16x32_bf16 v[24:27], v[148:151], v[120:123], v[24:27]
    ds_read_b64_tr_b16 v[172:173], v112 offset:4096
    ds_read_b64_tr_b16 v[174:175], v112 offset:4608
    v_mfma_f32_16x16x32_bf16 v[28:31], v[152:155], v[120:123], v[28:31]
    ds_read_b64_tr_b16 v[176:177], v113 offset:4096
    ds_read_b64_tr_b16 v[178:179], v113 offset:4608
    v_mfma_f32_16x16x32_bf16 v[32:35], v[156:159], v[120:123], v[32:35]
    s_add_u32 s48, s48, 32768
    s_cmp_ge_u32 s48, 98304
    s_cselect_b32 s48, 0, s48
    s_add_u32 s49, s49, 24576
    s_and_b32 s49, s49, 0xffff
    v_add_u32 v104, s48, v102
    v_mfma_f32_16x16x32_bf16 v[36:39], v[160:163], v[120:123], v[36:39]
    v_add_u32 v105, s48, v103
    v_add_u32 v110, s49, v106
    v_mfma_f32_16x16x32_bf16 v[40:43], v[148:151], v[124:127], v[40:43]
    v_add_u32 v111, s49, v107
    v_add_u32 v112, s49, v108
    v_mfma_f32_16x16x32_bf16 v[44:47], v[152:155], v[124:127], v[44:47]
    v_add_u32 v113, s49, v109
    v_mfma_f32_16x16x32_bf16 v[48:51], v[156:159], v[124:127], v[48:51]
    v_mfma_f32_16x16x32_bf16 v[52:55], v[160:163], v[124:127], v[52:55]
    v_mfma_f32_16x16x32_bf16 v[56:59], v[148:151], v[128:131], v[56:59]
    v_mfma_f32_16x16x32_bf16 v[60:63], v[152:155], v[128:131], v[60:63]
    v_mfma_f32_16x16x32_bf16 v[64:67], v[156:159], v[128:131], v[64:67]
    v_mfma_f32_16x16x32_bf16 v[68:71], v[160:163], v[128:131], v[68:71]
    s_waitcnt lgkmcnt(0)
    v_mfma_f32_16x16x32_bf16 v[8:11], v[164:167], v[132:135], v[8:11]
    s_waitcnt vmcnt(12)
    s_barrier
    s_add_u32 m0, s58, 98304
    s_nop 0
    buffer_load_dwordx4 v100, s[64:67], s56 offen lds
    s_add_u32 m0, s58, 102400
    s_nop 0
    buffer_load_dwordx4 v101, s[64:67], s56 offen lds
    s_add_u32 s58, s58, 8192
    s_and_b32 s58, s58, 0xffff
    s_add_u32 s56, s56, 393216
    s_cmp_ge_u32 s56, 6291456
    s_cselect_b32 s56, 0, s56
    buffer_load_dwordx2 v[72:73], v180, s[68:71], 0 offen offset:0
    buffer_load_dwordx2 v[74:75], v180, s[68:71], 0 offen offset:1024
    buffer_load_dwordx2 v[76:77], v180, s[68:71], 0 offen offset:32
    buffer_load_dwordx2 v[78:79], v180, s[68:71], 0 offen offset:1056
    buffer_load_dwordx2 v[80:81], v180, s[68:71], 0 offen offset:2048
    buffer_load_dwordx2 v[82:83], v180, s[68:71], 0 offen offset:3072
    buffer_load_dwordx2 v[84:85], v180, s[68:71], 0 offen offset:2080
    buffer_load_dwordx2 v[86:87], v180, s[68:71], 0 offen offset:3104
    s_add_u32 s73, s72, 0
    buffer_load_dwordx4 v[184:187], v181, s[76:79], s73 offen
    s_add_u32 s73, s72, 8192
    buffer_load_dwordx4 v[188:191], v181, s[76:79], s73 offen
    s_add_u32 s73, s72, 16384
    buffer_load_dwordx4 v[192:195], v181, s[76:79], s73 offen
    s_add_u32 s73, s72, 24576
    buffer_load_dwordx4 v[196:199], v181, s[76:79], s73 offen
    s_add_u32 s73, s72, 32768
    buffer_load_dwordx4 v[184:187], v181, s[76:79], s73 offen
    s_add_u32 s73, s72, 40960
    buffer_load_dwordx4 v[188:191], v181, s[76:79], s73 offen
    s_add_u32 s73, s72, 49152
    buffer_load_dwordx4 v[192:195], v181, s[76:79], s73 offen
    s_add_u32 s73, s72, 57344
    buffer_load_dwordx4 v[196:199], v181, s[76:79], s73 offen
    ds_read_b128 v[116:119], v104 offset:0
    v_mfma_f32_16x16x32_bf16 v[12:15], v[168:171], v[132:135], v[12:15]
    ds_read_b128 v[120:123], v104 offset:2048
    v_mfma_f32_16x16x32_bf16 v[16:19], v[172:175], v[132:135], v[16:19]
    ds_read_b128 v[124:127], v104 offset:4096
    v_mfma_f32_16x16x32_bf16 v[20:23], v[176:179], v[132:135], v[20:23]
    ds_read_b128 v[128:131], v104 offset:6144
    v_mfma_f32_16x16x32_bf16 v[24:27], v[164:167], v[136:139], v[24:27]
    ds_read_b64_tr_b16 v[148:149], v110 offset:0
    v_mfma_f32_16x16x32_bf16 v[28:31], v[168:171], v[136:139], v[28:31]
    ds_read_b64_tr_b16 v[150:151], v110 offset:512
    v_mfma_f32_16x16x32_bf16 v[32:35], v[172:175], v[136:139], v[32:35]
    ds_read_b64_tr_b16 v[152:153], v111 offset:0
    v_mfma_f32_16x16x32_bf16 v[36:39], v[176:179], v[136:139], v[36:39]
    ds_read_b64_tr_b16 v[154:155], v111 offset:512
    v_mfma_f32_16x16x32_bf16 v[40:43], v[164:167], v[140:143], v[40:43]
    ds_read_b64_tr_b16 v[156:157], v112 offset:0
    v_mfma_f32_16x16x32_bf16 v[44:47], v[168:171], v[140:143], v[44:47]
    ds_read_b64_tr_b16 v[158:159], v112 offset:512
    v_mfma_f32_16x16x32_bf16 v[48:51], v[172:175], v[140:143], v[48:51]
    ds_read_b64_tr_b16 v[160:161], v113 offset:0
    v_mfma_f32_16x16x32_bf16 v[52:55], v[176:179], v[140:143], v[52:55]
    ds_read_b64_tr_b16 v[162:163], v113 offset:512
    v_mfma_f32_16x16x32_bf16 v[56:59], v[164:167], v[144:147], v[56:59]
    v_mfma_f32_16x16x32_bf16 v[60:63], v[168:171], v[144:147], v[60:63]
    v_mfma_f32_16x16x32_bf16 v[64:67], v[172:175], v[144:147], v[64:67]
    v_mfma_f32_16x16x32_bf16 v[68:71], v[176:179], v[144:147], v[68:71]
    s_waitcnt lgkmcnt(0)
    v_mfma_f32_16x16x32_bf16 v[8:11], v[148:151], v[116:119], v[8:11]
    ds_read_b128 v[132:135], v105 offset:0
    ds_read_b128 v[136:139], v105 offset:2048
    v_mfma_f32_16x16x32_bf16 v[12:15], v[152:155], v[116:119], v[12:15]
    ds_read_b128 v[140:143], v105 offset:4096
    ds_read_b128 v[144:147], v105 offset:6144
    v_mfma_f32_16x16x32_bf16 v[16:19], v[156:159], v[116:119], v[16:19]
    ds_read_b64_tr_b16 v[164:165], v110 offset:4096
    ds_read_b64_tr_b16 v[166:167], v110 offset:4608
    v_mfma_f32_16x16x32_bf16 v[20:23], v[160:163], v[116:119], v[20:23]
    ds_read_b64_tr_b16 v[168:169], v111 offset:4096
    ds_read_b64_tr_b16 v[170:171], v111 offset:4608
    v_mfma_f32_16x16x32_bf16 v[24:27], v[148:151], v[120:123], v[24:27]
    ds_read_b64_tr_b16 v[172:173], v112 offset:4096
    ds_read_b64_tr_b16 v[174:175], v112 offset:4608
    v_mfma_f32_16x16x32_bf16 v[28:31], v[152:155], v[120:123], v[28:31]
    ds_read_b64_tr_b16 v[176:177], v113 offset:4096
    ds_read_b64_tr_b16 v[178:179], v113 offset:4608
    v_mfma_f32_16x16x32_bf16 v[32:35], v[156:159], v[120:123], v[32:35]
    s_add_u32 s48, s48, 32768
    s_cmp_ge_u32 s48, 98304
    s_cselect_b32 s48, 0, s48
    s_add_u32 s49, s49, 24576
    s_and_b32 s49, s49, 0xffff
    v_add_u32 v104, s48, v102
    v_mfma_f32_16x16x32_bf16 v[36:39], v[160:163], v[120:123], v[36:39]
    v_add_u32 v105, s48, v103
    v_add_u32 v110, s49, v106
    v_mfma_f32_16x16x32_bf16 v[40:43], v[148:151], v[124:127], v[40:43]
    v_add_u32 v111, s49, v107
    v_add_u32 v112, s49, v108
    v_mfma_f32_16x16x32_bf16 v[44:47], v[152:155], v[124:127], v[44:47]
    v_add_u32 v113, s49, v109
    v_mfma_f32_16x16x32_bf16 v[48:51], v[156:159], v[124:127], v[48:51]
    v_mfma_f32_16x16x32_bf16 v[52:55], v[160:163], v[124:127], v[52:55]
    v_mfma_f32_16x16x32_bf16 v[56:59], v[148:151], v[128:131], v[56:59]
    v_mfma_f32_16x16x32_bf16 v[60:63], v[152:155], v[128:131], v[60:63]
    v_mfma_f32_16x16x32_bf16 v[64:67], v[156:159], v[128:131], v[64:67]
    v_mfma_f32_16x16x32_bf16 v[68:71], v[160:163], v[128:131], v[68:71]
    s_waitcnt lgkmcnt(0)
    v_mfma_f32_16x16x32_bf16 v[8:11], v[164:167], v[132:135], v[8:11]
    s_waitcnt vmcnt(16)
    s_barrier
    ds_read_b128 v[116:119], v104 offset:0
    v_mfma_f32_16x16x32_bf16 v[12:15], v[168:171], v[132:135], v[12:15]
    ds_read_b128 v[120:123], v104 offset:2048
    v_mfma_f32_16x16x32_bf16 v[16:19], v[172:175], v[132:135], v[16:19]
    ds_read_b128 v[124:127], v104 offset:4096
    v_mfma_f32_16x16x32_bf16 v[20:23], v[176:179], v[132:135], v[20:23]
    ds_read_b128 v[128:131], v104 offset:6144
    v_mfma_f32_16x16x32_bf16 v[24:27], v[164:167], v[136:139], v[24:27]
    ds_read_b64_tr_b16 v[148:149], v110 offset:0
    v_mfma_f32_16x16x32_bf16 v[28:31], v[168:171], v[136:139], v[28:31]
    ds_read_b64_tr_b16 v[150:151], v110 offset:512
    v_mfma_f32_16x16x32_bf16 v[32:35], v[172:175], v[136:139], v[32:35]
    ds_read_b64_tr_b16 v[152:153], v111 offset:0
    v_mfma_f32_16x16x32_bf16 v[36:39], v[176:179], v[136:139], v[36:39]
    ds_read_b64_tr_b16 v[154:155], v111 offset:512
    v_mfma_f32_16x16x32_bf16 v[40:43], v[164:167], v[140:143], v[40:43]
    ds_read_b64_tr_b16 v[156:157], v112 offset:0
    v_mfma_f32_16x16x32_bf16 v[44:47], v[168:171], v[140:143], v[44:47]
    ds_read_b64_tr_b16 v[158:159], v112 offset:512
    v_mfma_f32_16x16x32_bf16 v[48:51], v[172:175], v[140:143], v[48:51]
    ds_read_b64_tr_b16 v[160:161], v113 offset:0
    v_mfma_f32_16x16x32_bf16 v[52:55], v[176:179], v[140:143], v[52:55]
    ds_read_b64_tr_b16 v[162:163], v113 offset:512
    v_mfma_f32_16x16x32_bf16 v[56:59], v[164:167], v[144:147], v[56:59]
    v_mfma_f32_16x16x32_bf16 v[60:63], v[168:171], v[144:147], v[60:63]
    v_mfma_f32_16x16x32_bf16 v[64:67], v[172:175], v[144:147], v[64:67]
    v_mfma_f32_16x16x32_bf16 v[68:71], v[176:179], v[144:147], v[68:71]
    s_waitcnt lgkmcnt(0)
    v_mfma_f32_16x16x32_bf16 v[8:11], v[148:151], v[116:119], v[8:11]
    ds_read_b128 v[132:135], v105 offset:0
    ds_read_b128 v[136:139], v105 offset:2048
    v_mfma_f32_16x16x32_bf16 v[12:15], v[152:155], v[116:119], v[12:15]
    ds_read_b128 v[140:143], v105 offset:4096
    ds_read_b128 v[144:147], v105 offset:6144
    v_mfma_f32_16x16x32_bf16 v[16:19], v[156:159], v[116:119], v[16:19]
    ds_read_b64_tr_b16 v[164:165], v110 offset:4096
    ds_read_b64_tr_b16 v[166:167], v110 offset:4608
    v_mfma_f32_16x16x32_bf16 v[20:23], v[160:163], v[116:119], v[20:23]
    ds_read_b64_tr_b16 v[168:169], v111 offset:4096
    ds_read_b64_tr_b16 v[170:171], v111 offset:4608
    v_mfma_f32_16x16x32_bf16 v[24:27], v[148:151], v[120:123], v[24:27]
    ds_read_b64_tr_b16 v[172:173], v112 offset:4096
    ds_read_b64_tr_b16 v[174:175], v112 offset:4608
    v_mfma_f32_16x16x32_bf16 v[28:31], v[152:155], v[120:123], v[28:31]
    ds_read_b64_tr_b16 v[176:177], v113 offset:4096
    ds_read_b64_tr_b16 v[178:179], v113 offset:4608
    v_mfma_f32_16x16x32_bf16 v[32:35], v[156:159], v[120:123], v[32:35]
    s_add_u32 s48, s48, 32768
    s_cmp_ge_u32 s48, 98304
    s_cselect_b32 s48, 0, s48
    s_add_u32 s49, s49, 24576
    s_and_b32 s49, s49, 0xffff
    v_add_u32 v104, s48, v102
    v_mfma_f32_16x16x32_bf16 v[36:39], v[160:163], v[120:123], v[36:39]
    v_add_u32 v105, s48, v103
    v_add_u32 v110, s49, v106
    v_mfma_f32_16x16x32_bf16 v[40:43], v[148:151], v[124:127], v[40:43]
    v_add_u32 v111, s49, v107
    v_add_u32 v112, s49, v108
    v_mfma_f32_16x16x32_bf16 v[44:47], v[152:155], v[124:127], v[44:47]
    v_add_u32 v113, s49, v109
    v_mfma_f32_16x16x32_bf16 v[48:51], v[156:159], v[124:127], v[48:51]
    v_mfma_f32_16x16x32_bf16 v[52:55], v[160:163], v[124:127], v[52:55]
    v_mfma_f32_16x16x32_bf16 v[56:59], v[148:151], v[128:131], v[56:59]
    v_mfma_f32_16x16x32_bf16 v[60:63], v[152:155], v[128:131], v[60:63]
    v_mfma_f32_16x16x32_bf16 v[64:67], v[156:159], v[128:131], v[64:67]
    v_mfma_f32_16x16x32_bf16 v[68:71], v[160:163], v[128:131], v[68:71]
    s_waitcnt lgkmcnt(0)
    v_mfma_f32_16x16x32_bf16 v[8:11], v[164:167], v[132:135], v[8:11]
    s_barrier
    ds_read_b128 v[116:119], v104 offset:0
    v_mfma_f32_16x16x32_bf16 v[12:15], v[168:171], v[132:135], v[12:15]
    ds_read_b128 v[120:123], v104 offset:2048
    v_mfma_f32_16x16x32_bf16 v[16:19], v[172:175], v[132:135], v[16:19]
    ds_read_b128 v[124:127], v104 offset:4096
    v_mfma_f32_16x16x32_bf16 v[20:23], v[176:179], v[132:135], v[20:23]
    ds_read_b128 v[128:131], v104 offset:6144
    v_mfma_f32_16x16x32_bf16 v[24:27], v[164:167], v[136:139], v[24:27]
    ds_read_b64_tr_b16 v[148:149], v110 offset:0
    v_mfma_f32_16x16x32_bf16 v[28:31], v[168:171], v[136:139], v[28:31]
    ds_read_b64_tr_b16 v[150:151], v110 offset:512
    v_mfma_f32_16x16x32_bf16 v[32:35], v[172:175], v[136:139], v[32:35]
    ds_read_b64_tr_b16 v[152:153], v111 offset:0
    v_mfma_f32_16x16x32_bf16 v[36:39], v[176:179], v[136:139], v[36:39]
    ds_read_b64_tr_b16 v[154:155], v111 offset:512
    v_mfma_f32_16x16x32_bf16 v[40:43], v[164:167], v[140:143], v[40:43]
    ds_read_b64_tr_b16 v[156:157], v112 offset:0
    v_mfma_f32_16x16x32_bf16 v[44:47], v[168:171], v[140:143], v[44:47]
    ds_read_b64_tr_b16 v[158:159], v112 offset:512
    v_mfma_f32_16x16x32_bf16 v[48:51], v[172:175], v[140:143], v[48:51]
    ds_read_b64_tr_b16 v[160:161], v113 offset:0
    v_mfma_f32_16x16x32_bf16 v[52:55], v[176:179], v[140:143], v[52:55]
    ds_read_b64_tr_b16 v[162:163], v113 offset:512
    v_mfma_f32_16x16x32_bf16 v[56:59], v[164:167], v[144:147], v[56:59]
    v_mfma_f32_16x16x32_bf16 v[60:63], v[168:171], v[144:147], v[60:63]
    v_mfma_f32_16x16x32_bf16 v[64:67], v[172:175], v[144:147], v[64:67]
    v_mfma_f32_16x16x32_bf16 v[68:71], v[176:179], v[144:147], v[68:71]
    s_waitcnt lgkmcnt(0)
    s_lshl_b32 s44, s42, 12
    s_add_u32 s44, s44, 65536
    v_lshlrev_b32 v2, 3, v1
    v_add_u32 v2, s44, v2
    s_waitcnt vmcnt(0)
    ds_write_b64 v2, v[72:73] offset:0
    ds_write_b64 v2, v[74:75] offset:512
    ds_write_b64 v2, v[76:77] offset:1024
    ds_write_b64 v2, v[78:79] offset:1536
    ds_write_b64 v2, v[80:81] offset:2048
    ds_write_b64 v2, v[82:83] offset:2560
    ds_write_b64 v2, v[84:85] offset:3072
    ds_write_b64 v2, v[86:87] offset:3584
    s_waitcnt lgkmcnt(0)
    ds_read_b64_tr_b16 v[72:73], v2 offset:0
    ds_read_b64_tr_b16 v[74:75], v2 offset:512
    ds_read_b64_tr_b16 v[76:77], v2 offset:1024
    ds_read_b64_tr_b16 v[78:79], v2 offset:1536
    ds_read_b64_tr_b16 v[80:81], v2 offset:2048
    ds_read_b64_tr_b16 v[82:83], v2 offset:2560
    ds_read_b64_tr_b16 v[84:85], v2 offset:3072
    ds_read_b64_tr_b16 v[86:87], v2 offset:3584
    s_waitcnt lgkmcnt(0)
    s_barrier
    v_cvt_pk_bf16_f32 v8, v8, v9
    v_cvt_pk_bf16_f32 v16, v16, v17
    v_cvt_pk_bf16_f32 v24, v24, v25
    v_cvt_pk_bf16_f32 v32, v32, v33
    v_cvt_pk_bf16_f32 v9, v10, v11
    v_cvt_pk_bf16_f32 v17, v18, v19
    v_cvt_pk_bf16_f32 v25, v26, v27
    v_cvt_pk_bf16_f32 v33, v34, v35
    v_cvt_pk_bf16_f32 v10, v12, v13
    v_cvt_pk_bf16_f32 v18, v20, v21
    v_cvt_pk_bf16_f32 v26, v28, v29
    v_cvt_pk_bf16_f32 v34, v36, v37
    v_cvt_pk_bf16_f32 v11, v14, v15
    v_cvt_pk_bf16_f32 v19, v22, v23
    v_cvt_pk_bf16_f32 v27, v30, v31
    v_cvt_pk_bf16_f32 v35, v38, v39
    v_mfma_f32_16x16x32_bf16 v[12:15], v[72:75], v[8:11], 0
    v_mfma_f32_16x16x32_bf16 v[20:23], v[80:83], v[16:19], 0
    v_mfma_f32_16x16x32_bf16 v[28:31], v[72:75], v[24:27], 0
    v_mfma_f32_16x16x32_bf16 v[36:39], v[80:83], v[32:35], 0
    v_mfma_f32_16x16x32_bf16 v[88:91], v[76:79], v[8:11], 0
    v_mfma_f32_16x16x32_bf16 v[112:115], v[84:87], v[16:19], 0
    v_mfma_f32_16x16x32_bf16 v[136:139], v[76:79], v[24:27], 0
    v_mfma_f32_16x16x32_bf16 v[160:163], v[84:87], v[32:35], 0
    s_nop 0
    v_cvt_pk_bf16_f32 v92, v12, v13
    v_cvt_pk_bf16_f32 v116, v20, v21
    v_cvt_pk_bf16_f32 v140, v28, v29
    v_cvt_pk_bf16_f32 v164, v36, v37
    v_cvt_pk_bf16_f32 v93, v14, v15
    v_cvt_pk_bf16_f32 v117, v22, v23
    v_cvt_pk_bf16_f32 v141, v30, v31
    v_cvt_pk_bf16_f32 v165, v38, v39
    v_cvt_pk_bf16_f32 v94, v88, v89
    v_cvt_pk_bf16_f32 v118, v112, v113
    v_cvt_pk_bf16_f32 v142, v136, v137
    v_cvt_pk_bf16_f32 v166, v160, v161
    v_cvt_pk_bf16_f32 v95, v90, v91
    v_cvt_pk_bf16_f32 v119, v114, v115
    v_cvt_pk_bf16_f32 v143, v138, v139
    v_cvt_pk_bf16_f32 v167, v162, v163
    v_lshlrev_b32 v12, 16, v92
    v_lshlrev_b32 v20, 16, v116
    v_lshlrev_b32 v28, 16, v140
    v_lshlrev_b32 v36, 16, v164
    v_and_b32 v13, 0xffff0000, v92
    v_and_b32 v21, 0xffff0000, v116
    v_and_b32 v29, 0xffff0000, v140
    v_and_b32 v37, 0xffff0000, v164
    v_lshlrev_b32 v14, 16, v93
    v_lshlrev_b32 v22, 16, v117
    v_lshlrev_b32 v30, 16, v141
    v_lshlrev_b32 v38, 16, v165
    v_and_b32 v15, 0xffff0000, v93
    v_and_b32 v23, 0xffff0000, v117
    v_and_b32 v31, 0xffff0000, v141
    v_and_b32 v39, 0xffff0000, v165
    v_lshlrev_b32 v88, 16, v94
    v_lshlrev_b32 v112, 16, v118
    v_lshlrev_b32 v136, 16, v142
    v_lshlrev_b32 v160, 16, v166
    v_and_b32 v89, 0xffff0000, v94
    v_and_b32 v113, 0xffff0000, v118
    v_and_b32 v137, 0xffff0000, v142
    v_and_b32 v161, 0xffff0000, v166
    v_lshlrev_b32 v90, 16, v95
    v_lshlrev_b32 v114, 16, v119
    v_lshlrev_b32 v138, 16, v143
    v_lshlrev_b32 v162, 16, v167
    v_and_b32 v91, 0xffff0000, v95
    v_and_b32 v115, 0xffff0000, v119
    v_and_b32 v139, 0xffff0000, v143
    v_and_b32 v163, 0xffff0000, v167
    v_max3_f32 v108, v12, v13, v14
    v_max3_f32 v132, v20, v21, v22
    v_max3_f32 v156, v28, v29, v30
    v_max3_f32 v180, v36, v37, v38
    v_max3_f32 v110, -v12, -v13, -v14
    v_max3_f32 v134, -v20, -v21, -v22
    v_max3_f32 v158, -v28, -v29, -v30
    v_max3_f32 v182, -v36, -v37, -v38
    v_max3_f32 v109, v15, v88, v89
    v_max3_f32 v133, v23, v112, v113
    v_max3_f32 v157, v31, v136, v137
    v_max3_f32 v181, v39, v160, v161
    v_max3_f32 v111, -v15, -v88, -v89
    v_max3_f32 v135, -v23, -v112, -v113
    v_max3_f32 v159, -v31, -v136, -v137
    v_max3_f32 v183, -v39, -v160, -v161
    v_max3_f32 v108, v108, v90, v91
    v_max3_f32 v132, v132, v114, v115
    v_max3_f32 v156, v156, v138, v139
    v_max3_f32 v180, v180, v162, v163
    v_max3_f32 v110, v110, -v90, -v91
    v_max3_f32 v134, v134, -v114, -v115
    v_max3_f32 v158, v158, -v138, -v139
    v_max3_f32 v182, v182, -v162, -v163
    v_max_f32 v108, v108, v109
    v_max_f32 v132, v132, v133
    v_max_f32 v156, v156, v157
    v_max_f32 v180, v180, v181
    v_max_f32 v110, v110, v111
    v_max_f32 v134, v134, v135
    v_max_f32 v158, v158, v159
    v_max_f32 v182, v182, v183
    v_permlane32_swap_b32 v108, v110
    v_permlane32_swap_b32 v132, v134
    v_permlane32_swap_b32 v156, v158
    v_permlane32_swap_b32 v180, v182
    v_max_f32 v108, v108, v110
    v_max_f32 v132, v132, v134
    v_max_f32 v156, v156, v158
    v_max_f32 v180, v180, v182
    v_mov_b32 v110, v108
    v_mov_b32 v134, v132
    v_mov_b32 v158, v156
    v_mov_b32 v182, v180
    v_permlane16_swap_b32 v108, v110
    v_permlane16_swap_b32 v132, v134
    v_permlane16_swap_b32 v156, v158
    v_permlane16_swap_b32 v180, v182
    v_max_f32 v108, v108, v110
    v_max_f32 v132, v132, v134
    v_max_f32 v156, v156, v158
    v_max_f32 v180, v180, v182
    v_mov_b32 v110, v108
    v_mov_b32 v134, v132
    v_mov_b32 v158, v156
    v_mov_b32 v182, v180
    v_permlane32_swap_b32 v108, v110
    v_permlane32_swap_b32 v132, v134
    v_permlane32_swap_b32 v156, v158
    v_permlane32_swap_b32 v180, v182
    v_mul_f32 v108, s52, v108
    v_mul_f32 v132, s52, v132
    v_mul_f32 v156, s52, v156
    v_mul_f32 v180, s52, v180
    v_mul_f32 v110, s52, v110
    v_mul_f32 v134, s52, v134
    v_mul_f32 v158, s52, v158
    v_mul_f32 v182, s52, v182
    v_pk_fma_f32 v[92:93], v[12:13], s[52:53], v[108:109] op_sel_hi:[1,1,0] neg_lo:[0,0,1] neg_hi:[0,0,1]
    v_pk_fma_f32 v[116:117], v[20:21], s[52:53], v[132:133] op_sel_hi:[1,1,0] neg_lo:[0,0,1] neg_hi:[0,0,1]
    v_pk_fma_f32 v[140:141], v[28:29], s[52:53], v[156:157] op_sel_hi:[1,1,0] neg_lo:[0,0,1] neg_hi:[0,0,1]
    v_pk_fma_f32 v[164:165], v[36:37], s[52:53], v[180:181] op_sel_hi:[1,1,0] neg_lo:[0,0,1] neg_hi:[0,0,1]
    v_pk_fma_f32 v[100:101], v[12:13], s[52:53], v[110:111] op_sel_hi:[1,1,0] neg_lo:[1,0,1] neg_hi:[1,0,1]
    v_pk_fma_f32 v[124:125], v[20:21], s[52:53], v[134:135] op_sel_hi:[1,1,0] neg_lo:[1,0,1] neg_hi:[1,0,1]
    v_pk_fma_f32 v[148:149], v[28:29], s[52:53], v[158:159] op_sel_hi:[1,1,0] neg_lo:[1,0,1] neg_hi:[1,0,1]
    v_pk_fma_f32 v[172:173], v[36:37], s[52:53], v[182:183] op_sel_hi:[1,1,0] neg_lo:[1,0,1] neg_hi:[1,0,1]
    v_pk_fma_f32 v[94:95], v[14:15], s[52:53], v[108:109] op_sel_hi:[1,1,0] neg_lo:[0,0,1] neg_hi:[0,0,1]
    v_pk_fma_f32 v[118:119], v[22:23], s[52:53], v[132:133] op_sel_hi:[1,1,0] neg_lo:[0,0,1] neg_hi:[0,0,1]
    v_pk_fma_f32 v[142:143], v[30:31], s[52:53], v[156:157] op_sel_hi:[1,1,0] neg_lo:[0,0,1] neg_hi:[0,0,1]
    v_pk_fma_f32 v[166:167], v[38:39], s[52:53], v[180:181] op_sel_hi:[1,1,0] neg_lo:[0,0,1] neg_hi:[0,0,1]
    v_pk_fma_f32 v[102:103], v[14:15], s[52:53], v[110:111] op_sel_hi:[1,1,0] neg_lo:[1,0,1] neg_hi:[1,0,1]
    v_pk_fma_f32 v[126:127], v[22:23], s[52:53], v[134:135] op_sel_hi:[1,1,0] neg_lo:[1,0,1] neg_hi:[1,0,1]
    v_pk_fma_f32 v[150:151], v[30:31], s[52:53], v[158:159] op_sel_hi:[1,1,0] neg_lo:[1,0,1] neg_hi:[1,0,1]
    v_pk_fma_f32 v[174:175], v[38:39], s[52:53], v[182:183] op_sel_hi:[1,1,0] neg_lo:[1,0,1] neg_hi:[1,0,1]
    v_pk_fma_f32 v[96:97], v[88:89], s[52:53], v[108:109] op_sel_hi:[1,1,0] neg_lo:[0,0,1] neg_hi:[0,0,1]
    v_pk_fma_f32 v[120:121], v[112:113], s[52:53], v[132:133] op_sel_hi:[1,1,0] neg_lo:[0,0,1] neg_hi:[0,0,1]
    v_pk_fma_f32 v[144:145], v[136:137], s[52:53], v[156:157] op_sel_hi:[1,1,0] neg_lo:[0,0,1] neg_hi:[0,0,1]
    v_pk_fma_f32 v[168:169], v[160:161], s[52:53], v[180:181] op_sel_hi:[1,1,0] neg_lo:[0,0,1] neg_hi:[0,0,1]
    v_pk_fma_f32 v[104:105], v[88:89], s[52:53], v[110:111] op_sel_hi:[1,1,0] neg_lo:[1,0,1] neg_hi:[1,0,1]
    v_pk_fma_f32 v[128:129], v[112:113], s[52:53], v[134:135] op_sel_hi:[1,1,0] neg_lo:[1,0,1] neg_hi:[1,0,1]
    v_pk_fma_f32 v[152:153], v[136:137], s[52:53], v[158:159] op_sel_hi:[1,1,0] neg_lo:[1,0,1] neg_hi:[1,0,1]
    v_pk_fma_f32 v[176:177], v[160:161], s[52:53], v[182:183] op_sel_hi:[1,1,0] neg_lo:[1,0,1] neg_hi:[1,0,1]
    v_pk_fma_f32 v[98:99], v[90:91], s[52:53], v[108:109] op_sel_hi:[1,1,0] neg_lo:[0,0,1] neg_hi:[0,0,1]
    v_pk_fma_f32 v[122:123], v[114:115], s[52:53], v[132:133] op_sel_hi:[1,1,0] neg_lo:[0,0,1] neg_hi:[0,0,1]
    v_pk_fma_f32 v[146:147], v[138:139], s[52:53], v[156:157] op_sel_hi:[1,1,0] neg_lo:[0,0,1] neg_hi:[0,0,1]
    v_pk_fma_f32 v[170:171], v[162:163], s[52:53], v[180:181] op_sel_hi:[1,1,0] neg_lo:[0,0,1] neg_hi:[0,0,1]
    v_pk_fma_f32 v[106:107], v[90:91], s[52:53], v[110:111] op_sel_hi:[1,1,0] neg_lo:[1,0,1] neg_hi:[1,0,1]
    v_pk_fma_f32 v[130:131], v[114:115], s[52:53], v[134:135] op_sel_hi:[1,1,0] neg_lo:[1,0,1] neg_hi:[1,0,1]
    v_pk_fma_f32 v[154:155], v[138:139], s[52:53], v[158:159] op_sel_hi:[1,1,0] neg_lo:[1,0,1] neg_hi:[1,0,1]
    v_pk_fma_f32 v[178:179], v[162:163], s[52:53], v[182:183] op_sel_hi:[1,1,0] neg_lo:[1,0,1] neg_hi:[1,0,1]
    v_exp_f32 v92, v92
    v_exp_f32 v116, v116
    v_exp_f32 v140, v140
    v_exp_f32 v164, v164
    v_exp_f32 v100, v100
    v_exp_f32 v124, v124
    v_exp_f32 v148, v148
    v_exp_f32 v172, v172
    v_exp_f32 v93, v93
    v_exp_f32 v117, v117
    v_exp_f32 v141, v141
    v_exp_f32 v165, v165
    v_exp_f32 v101, v101
    v_exp_f32 v125, v125
    v_exp_f32 v149, v149
    v_exp_f32 v173, v173
    v_exp_f32 v94, v94
    v_exp_f32 v118, v118
    v_exp_f32 v142, v142
    v_exp_f32 v166, v166
    v_exp_f32 v102, v102
    v_exp_f32 v126, v126
    v_exp_f32 v150, v150
    v_exp_f32 v174, v174
    v_exp_f32 v95, v95
    v_exp_f32 v119, v119
    v_exp_f32 v143, v143
    v_exp_f32 v167, v167
    v_exp_f32 v103, v103
    v_exp_f32 v127, v127
    v_exp_f32 v151, v151
    v_exp_f32 v175, v175
    v_exp_f32 v96, v96
    v_exp_f32 v120, v120
    v_exp_f32 v144, v144
    v_exp_f32 v168, v168
    v_exp_f32 v104, v104
    v_exp_f32 v128, v128
    v_exp_f32 v152, v152
    v_exp_f32 v176, v176
    v_exp_f32 v97, v97
    v_exp_f32 v121, v121
    v_exp_f32 v145, v145
    v_exp_f32 v169, v169
    v_exp_f32 v105, v105
    v_exp_f32 v129, v129
    v_exp_f32 v153, v153
    v_exp_f32 v177, v177
    v_exp_f32 v98, v98
    v_exp_f32 v122, v122
    v_exp_f32 v146, v146
    v_exp_f32 v170, v170
    v_exp_f32 v106, v106
    v_exp_f32 v130, v130
    v_exp_f32 v154, v154
    v_exp_f32 v178, v178
    v_exp_f32 v99, v99
    v_exp_f32 v123, v123
    v_exp_f32 v147, v147
    v_exp_f32 v171, v171
    v_exp_f32 v107, v107
    v_exp_f32 v131, v131
    v_exp_f32 v155, v155
    v_exp_f32 v179, v179
    v_pk_add_f32 v[88:89], v[92:93], v[94:95]
    v_pk_add_f32 v[112:113], v[116:117], v[118:119]
    v_pk_add_f32 v[136:137], v[140:141], v[142:143]
    v_pk_add_f32 v[160:161], v[164:165], v[166:167]
    v_pk_add_f32 v[90:91], v[96:97], v[98:99]
    v_pk_add_f32 v[114:115], v[120:121], v[122:123]
    v_pk_add_f32 v[138:139], v[144:145], v[146:147]
    v_pk_add_f32 v[162:163], v[168:169], v[170:171]
    v_pk_add_f32 v[12:13], v[100:101], v[102:103]
    v_pk_add_f32 v[20:21], v[124:125], v[126:127]
    v_pk_add_f32 v[28:29], v[148:149], v[150:151]
    v_pk_add_f32 v[36:37], v[172:173], v[174:175]
    v_pk_add_f32 v[14:15], v[104:105], v[106:107]
    v_pk_add_f32 v[22:23], v[128:129], v[130:131]
    v_pk_add_f32 v[30:31], v[152:153], v[154:155]
    v_pk_add_f32 v[38:39], v[176:177], v[178:179]
    v_pk_add_f32 v[88:89], v[88:89], v[90:91]
    v_pk_add_f32 v[112:113], v[112:113], v[114:115]
    v_pk_add_f32 v[136:137], v[136:137], v[138:139]
    v_pk_add_f32 v[160:161], v[160:161], v[162:163]
    v_pk_add_f32 v[12:13], v[12:13], v[14:15]
    v_pk_add_f32 v[20:21], v[20:21], v[22:23]
    v_pk_add_f32 v[28:29], v[28:29], v[30:31]
    v_pk_add_f32 v[36:37], v[36:37], v[38:39]
    v_add_f32 v108, v88, v89
    v_add_f32 v132, v112, v113
    v_add_f32 v156, v136, v137
    v_add_f32 v180, v160, v161
    v_add_f32 v110, v12, v13
    v_add_f32 v134, v20, v21
    v_add_f32 v158, v28, v29
    v_add_f32 v182, v36, v37
    v_permlane32_swap_b32 v108, v110
    v_permlane32_swap_b32 v132, v134
    v_permlane32_swap_b32 v156, v158
    v_permlane32_swap_b32 v180, v182
    v_add_f32 v108, v108, v110
    v_add_f32 v132, v132, v134
    v_add_f32 v156, v156, v158
    v_add_f32 v180, v180, v182
    v_mov_b32 v110, v108
    v_mov_b32 v134, v132
    v_mov_b32 v158, v156
    v_mov_b32 v182, v180
    v_permlane16_swap_b32 v108, v110
    v_permlane16_swap_b32 v132, v134
    v_permlane16_swap_b32 v156, v158
    v_permlane16_swap_b32 v180, v182
    v_add_f32 v108, v108, v110
    v_add_f32 v132, v132, v134
    v_add_f32 v156, v156, v158
    v_add_f32 v180, v180, v182
    v_mov_b32 v110, v108
    v_mov_b32 v134, v132
    v_mov_b32 v158, v156
    v_mov_b32 v182, v180
    v_permlane32_swap_b32 v108, v110
    v_permlane32_swap_b32 v132, v134
    v_permlane32_swap_b32 v156, v158
    v_permlane32_swap_b32 v180, v182
    v_rcp_f32 v108, v108
    v_rcp_f32 v132, v132
    v_rcp_f32 v156, v156
    v_rcp_f32 v180, v180
    v_rcp_f32 v110, v110
    v_rcp_f32 v134, v134
    v_rcp_f32 v158, v158
    v_rcp_f32 v182, v182
    v_pk_mul_f32 v[92:93], v[92:93], v[108:109] op_sel_hi:[1,0]
    v_pk_mul_f32 v[116:117], v[116:117], v[132:133] op_sel_hi:[1,0]
    v_pk_mul_f32 v[140:141], v[140:141], v[156:157] op_sel_hi:[1,0]
    v_pk_mul_f32 v[164:165], v[164:165], v[180:181] op_sel_hi:[1,0]
    v_pk_mul_f32 v[100:101], v[100:101], v[110:111] op_sel_hi:[1,0]
    v_pk_mul_f32 v[124:125], v[124:125], v[134:135] op_sel_hi:[1,0]
    v_pk_mul_f32 v[148:149], v[148:149], v[158:159] op_sel_hi:[1,0]
    v_pk_mul_f32 v[172:173], v[172:173], v[182:183] op_sel_hi:[1,0]
    v_pk_mul_f32 v[94:95], v[94:95], v[108:109] op_sel_hi:[1,0]
    v_pk_mul_f32 v[118:119], v[118:119], v[132:133] op_sel_hi:[1,0]
    v_pk_mul_f32 v[142:143], v[142:143], v[156:157] op_sel_hi:[1,0]
    v_pk_mul_f32 v[166:167], v[166:167], v[180:181] op_sel_hi:[1,0]
    v_pk_mul_f32 v[102:103], v[102:103], v[110:111] op_sel_hi:[1,0]
    v_pk_mul_f32 v[126:127], v[126:127], v[134:135] op_sel_hi:[1,0]
    v_pk_mul_f32 v[150:151], v[150:151], v[158:159] op_sel_hi:[1,0]
    v_pk_mul_f32 v[174:175], v[174:175], v[182:183] op_sel_hi:[1,0]
    v_pk_mul_f32 v[96:97], v[96:97], v[108:109] op_sel_hi:[1,0]
    v_pk_mul_f32 v[120:121], v[120:121], v[132:133] op_sel_hi:[1,0]
    v_pk_mul_f32 v[144:145], v[144:145], v[156:157] op_sel_hi:[1,0]
    v_pk_mul_f32 v[168:169], v[168:169], v[180:181] op_sel_hi:[1,0]
    v_pk_mul_f32 v[104:105], v[104:105], v[110:111] op_sel_hi:[1,0]
    v_pk_mul_f32 v[128:129], v[128:129], v[134:135] op_sel_hi:[1,0]
    v_pk_mul_f32 v[152:153], v[152:153], v[158:159] op_sel_hi:[1,0]
    v_pk_mul_f32 v[176:177], v[176:177], v[182:183] op_sel_hi:[1,0]
    v_pk_mul_f32 v[98:99], v[98:99], v[108:109] op_sel_hi:[1,0]
    v_pk_mul_f32 v[122:123], v[122:123], v[132:133] op_sel_hi:[1,0]
    v_pk_mul_f32 v[146:147], v[146:147], v[156:157] op_sel_hi:[1,0]
    v_pk_mul_f32 v[170:171], v[170:171], v[180:181] op_sel_hi:[1,0]
    v_pk_mul_f32 v[106:107], v[106:107], v[110:111] op_sel_hi:[1,0]
    v_pk_mul_f32 v[130:131], v[130:131], v[134:135] op_sel_hi:[1,0]
    v_pk_mul_f32 v[154:155], v[154:155], v[158:159] op_sel_hi:[1,0]
    v_pk_mul_f32 v[178:179], v[178:179], v[182:183] op_sel_hi:[1,0]
    v_cvt_pk_bf16_f32 v8, v92, v93
    v_cvt_pk_bf16_f32 v16, v116, v117
    v_cvt_pk_bf16_f32 v24, v140, v141
    v_cvt_pk_bf16_f32 v32, v164, v165
    v_cvt_pk_bf16_f32 v12, v100, v101
    v_cvt_pk_bf16_f32 v20, v124, v125
    v_cvt_pk_bf16_f32 v28, v148, v149
    v_cvt_pk_bf16_f32 v36, v172, v173
    v_cvt_pk_bf16_f32 v9, v94, v95
    v_cvt_pk_bf16_f32 v17, v118, v119
    v_cvt_pk_bf16_f32 v25, v142, v143
    v_cvt_pk_bf16_f32 v33, v166, v167
    v_cvt_pk_bf16_f32 v13, v102, v103
    v_cvt_pk_bf16_f32 v21, v126, v127
    v_cvt_pk_bf16_f32 v29, v150, v151
    v_cvt_pk_bf16_f32 v37, v174, v175
    v_cvt_pk_bf16_f32 v10, v96, v97
    v_cvt_pk_bf16_f32 v18, v120, v121
    v_cvt_pk_bf16_f32 v26, v144, v145
    v_cvt_pk_bf16_f32 v34, v168, v169
    v_cvt_pk_bf16_f32 v14, v104, v105
    v_cvt_pk_bf16_f32 v22, v128, v129
    v_cvt_pk_bf16_f32 v30, v152, v153
    v_cvt_pk_bf16_f32 v38, v176, v177
    v_cvt_pk_bf16_f32 v11, v98, v99
    v_cvt_pk_bf16_f32 v19, v122, v123
    v_cvt_pk_bf16_f32 v27, v146, v147
    v_cvt_pk_bf16_f32 v35, v170, v171
    v_cvt_pk_bf16_f32 v15, v106, v107
    v_cvt_pk_bf16_f32 v23, v130, v131
    v_cvt_pk_bf16_f32 v31, v154, v155
    v_cvt_pk_bf16_f32 v39, v178, v179
    v_cvt_pk_bf16_f32 v40, v40, v41
    v_cvt_pk_bf16_f32 v48, v48, v49
    v_cvt_pk_bf16_f32 v56, v56, v57
    v_cvt_pk_bf16_f32 v64, v64, v65
    v_cvt_pk_bf16_f32 v41, v42, v43
    v_cvt_pk_bf16_f32 v49, v50, v51
    v_cvt_pk_bf16_f32 v57, v58, v59
    v_cvt_pk_bf16_f32 v65, v66, v67
    v_cvt_pk_bf16_f32 v42, v44, v45
    v_cvt_pk_bf16_f32 v50, v52, v53
    v_cvt_pk_bf16_f32 v58, v60, v61
    v_cvt_pk_bf16_f32 v66, v68, v69
    v_cvt_pk_bf16_f32 v43, v46, v47
    v_cvt_pk_bf16_f32 v51, v54, v55
    v_cvt_pk_bf16_f32 v59, v62, v63
    v_cvt_pk_bf16_f32 v67, v70, v71
    v_mfma_f32_16x16x32_bf16 v[44:47], v[72:75], v[40:43], 0
    v_mfma_f32_16x16x32_bf16 v[52:55], v[80:83], v[48:51], 0
    v_mfma_f32_16x16x32_bf16 v[60:63], v[72:75], v[56:59], 0
    v_mfma_f32_16x16x32_bf16 v[68:71], v[80:83], v[64:67], 0
    v_mfma_f32_16x16x32_bf16 v[88:91], v[76:79], v[40:43], 0
    v_mfma_f32_16x16x32_bf16 v[112:115], v[84:87], v[48:51], 0
    v_mfma_f32_16x16x32_bf16 v[136:139], v[76:79], v[56:59], 0
    v_mfma_f32_16x16x32_bf16 v[160:163], v[84:87], v[64:67], 0
    s_nop 0
    v_cvt_pk_bf16_f32 v92, v44, v45
    v_cvt_pk_bf16_f32 v116, v52, v53
    v_cvt_pk_bf16_f32 v140, v60, v61
    v_cvt_pk_bf16_f32 v164, v68, v69
    v_cvt_pk_bf16_f32 v93, v46, v47
    v_cvt_pk_bf16_f32 v117, v54, v55
    v_cvt_pk_bf16_f32 v141, v62, v63
    v_cvt_pk_bf16_f32 v165, v70, v71
    v_cvt_pk_bf16_f32 v94, v88, v89
    v_cvt_pk_bf16_f32 v118, v112, v113
    v_cvt_pk_bf16_f32 v142, v136, v137
    v_cvt_pk_bf16_f32 v166, v160, v161
    v_cvt_pk_bf16_f32 v95, v90, v91
    v_cvt_pk_bf16_f32 v119, v114, v115
    v_cvt_pk_bf16_f32 v143, v138, v139
    v_cvt_pk_bf16_f32 v167, v162, v163
    v_lshlrev_b32 v44, 16, v92
    v_lshlrev_b32 v52, 16, v116
    v_lshlrev_b32 v60, 16, v140
    v_lshlrev_b32 v68, 16, v164
    v_and_b32 v45, 0xffff0000, v92
    v_and_b32 v53, 0xffff0000, v116
    v_and_b32 v61, 0xffff0000, v140
    v_and_b32 v69, 0xffff0000, v164
    v_lshlrev_b32 v46, 16, v93
    v_lshlrev_b32 v54, 16, v117
    v_lshlrev_b32 v62, 16, v141
    v_lshlrev_b32 v70, 16, v165
    v_and_b32 v47, 0xffff0000, v93
    v_and_b32 v55, 0xffff0000, v117
    v_and_b32 v63, 0xffff0000, v141
    v_and_b32 v71, 0xffff0000, v165
    v_lshlrev_b32 v88, 16, v94
    v_lshlrev_b32 v112, 16, v118
    v_lshlrev_b32 v136, 16, v142
    v_lshlrev_b32 v160, 16, v166
    v_and_b32 v89, 0xffff0000, v94
    v_and_b32 v113, 0xffff0000, v118
    v_and_b32 v137, 0xffff0000, v142
    v_and_b32 v161, 0xffff0000, v166
    v_lshlrev_b32 v90, 16, v95
    v_lshlrev_b32 v114, 16, v119
    v_lshlrev_b32 v138, 16, v143
    v_lshlrev_b32 v162, 16, v167
    v_and_b32 v91, 0xffff0000, v95
    v_and_b32 v115, 0xffff0000, v119
    v_and_b32 v139, 0xffff0000, v143
    v_and_b32 v163, 0xffff0000, v167
    v_max3_f32 v108, v44, v45, v46
    v_max3_f32 v132, v52, v53, v54
    v_max3_f32 v156, v60, v61, v62
    v_max3_f32 v180, v68, v69, v70
    v_max3_f32 v110, -v44, -v45, -v46
    v_max3_f32 v134, -v52, -v53, -v54
    v_max3_f32 v158, -v60, -v61, -v62
    v_max3_f32 v182, -v68, -v69, -v70
    v_max3_f32 v109, v47, v88, v89
    v_max3_f32 v133, v55, v112, v113
    v_max3_f32 v157, v63, v136, v137
    v_max3_f32 v181, v71, v160, v161
    v_max3_f32 v111, -v47, -v88, -v89
    v_max3_f32 v135, -v55, -v112, -v113
    v_max3_f32 v159, -v63, -v136, -v137
    v_max3_f32 v183, -v71, -v160, -v161
    v_max3_f32 v108, v108, v90, v91
    v_max3_f32 v132, v132, v114, v115
    v_max3_f32 v156, v156, v138, v139
    v_max3_f32 v180, v180, v162, v163
    v_max3_f32 v110, v110, -v90, -v91
    v_max3_f32 v134, v134, -v114, -v115
    v_max3_f32 v158, v158, -v138, -v139
    v_max3_f32 v182, v182, -v162, -v163
    v_max_f32 v108, v108, v109
    v_max_f32 v132, v132, v133
    v_max_f32 v156, v156, v157
    v_max_f32 v180, v180, v181
    v_max_f32 v110, v110, v111
    v_max_f32 v134, v134, v135
    v_max_f32 v158, v158, v159
    v_max_f32 v182, v182, v183
    v_permlane32_swap_b32 v108, v110
    v_permlane32_swap_b32 v132, v134
    v_permlane32_swap_b32 v156, v158
    v_permlane32_swap_b32 v180, v182
    v_max_f32 v108, v108, v110
    v_max_f32 v132, v132, v134
    v_max_f32 v156, v156, v158
    v_max_f32 v180, v180, v182
    v_mov_b32 v110, v108
    v_mov_b32 v134, v132
    v_mov_b32 v158, v156
    v_mov_b32 v182, v180
    v_permlane16_swap_b32 v108, v110
    v_permlane16_swap_b32 v132, v134
    v_permlane16_swap_b32 v156, v158
    v_permlane16_swap_b32 v180, v182
    v_max_f32 v108, v108, v110
    v_max_f32 v132, v132, v134
    v_max_f32 v156, v156, v158
    v_max_f32 v180, v180, v182
    v_mov_b32 v110, v108
    v_mov_b32 v134, v132
    v_mov_b32 v158, v156
    v_mov_b32 v182, v180
    v_permlane32_swap_b32 v108, v110
    v_permlane32_swap_b32 v132, v134
    v_permlane32_swap_b32 v156, v158
    v_permlane32_swap_b32 v180, v182
    v_mul_f32 v108, s52, v108
    v_mul_f32 v132, s52, v132
    v_mul_f32 v156, s52, v156
    v_mul_f32 v180, s52, v180
    v_mul_f32 v110, s52, v110
    v_mul_f32 v134, s52, v134
    v_mul_f32 v158, s52, v158
    v_mul_f32 v182, s52, v182
    v_pk_fma_f32 v[92:93], v[44:45], s[52:53], v[108:109] op_sel_hi:[1,1,0] neg_lo:[0,0,1] neg_hi:[0,0,1]
    v_pk_fma_f32 v[116:117], v[52:53], s[52:53], v[132:133] op_sel_hi:[1,1,0] neg_lo:[0,0,1] neg_hi:[0,0,1]
    v_pk_fma_f32 v[140:141], v[60:61], s[52:53], v[156:157] op_sel_hi:[1,1,0] neg_lo:[0,0,1] neg_hi:[0,0,1]
    v_pk_fma_f32 v[164:165], v[68:69], s[52:53], v[180:181] op_sel_hi:[1,1,0] neg_lo:[0,0,1] neg_hi:[0,0,1]
    v_pk_fma_f32 v[100:101], v[44:45], s[52:53], v[110:111] op_sel_hi:[1,1,0] neg_lo:[1,0,1] neg_hi:[1,0,1]
    v_pk_fma_f32 v[124:125], v[52:53], s[52:53], v[134:135] op_sel_hi:[1,1,0] neg_lo:[1,0,1] neg_hi:[1,0,1]
    v_pk_fma_f32 v[148:149], v[60:61], s[52:53], v[158:159] op_sel_hi:[1,1,0] neg_lo:[1,0,1] neg_hi:[1,0,1]
    v_pk_fma_f32 v[172:173], v[68:69], s[52:53], v[182:183] op_sel_hi:[1,1,0] neg_lo:[1,0,1] neg_hi:[1,0,1]
    v_pk_fma_f32 v[94:95], v[46:47], s[52:53], v[108:109] op_sel_hi:[1,1,0] neg_lo:[0,0,1] neg_hi:[0,0,1]
    v_pk_fma_f32 v[118:119], v[54:55], s[52:53], v[132:133] op_sel_hi:[1,1,0] neg_lo:[0,0,1] neg_hi:[0,0,1]
    v_pk_fma_f32 v[142:143], v[62:63], s[52:53], v[156:157] op_sel_hi:[1,1,0] neg_lo:[0,0,1] neg_hi:[0,0,1]
    v_pk_fma_f32 v[166:167], v[70:71], s[52:53], v[180:181] op_sel_hi:[1,1,0] neg_lo:[0,0,1] neg_hi:[0,0,1]
    v_pk_fma_f32 v[102:103], v[46:47], s[52:53], v[110:111] op_sel_hi:[1,1,0] neg_lo:[1,0,1] neg_hi:[1,0,1]
    v_pk_fma_f32 v[126:127], v[54:55], s[52:53], v[134:135] op_sel_hi:[1,1,0] neg_lo:[1,0,1] neg_hi:[1,0,1]
    v_pk_fma_f32 v[150:151], v[62:63], s[52:53], v[158:159] op_sel_hi:[1,1,0] neg_lo:[1,0,1] neg_hi:[1,0,1]
    v_pk_fma_f32 v[174:175], v[70:71], s[52:53], v[182:183] op_sel_hi:[1,1,0] neg_lo:[1,0,1] neg_hi:[1,0,1]
    v_pk_fma_f32 v[96:97], v[88:89], s[52:53], v[108:109] op_sel_hi:[1,1,0] neg_lo:[0,0,1] neg_hi:[0,0,1]
    v_pk_fma_f32 v[120:121], v[112:113], s[52:53], v[132:133] op_sel_hi:[1,1,0] neg_lo:[0,0,1] neg_hi:[0,0,1]
    v_pk_fma_f32 v[144:145], v[136:137], s[52:53], v[156:157] op_sel_hi:[1,1,0] neg_lo:[0,0,1] neg_hi:[0,0,1]
    v_pk_fma_f32 v[168:169], v[160:161], s[52:53], v[180:181] op_sel_hi:[1,1,0] neg_lo:[0,0,1] neg_hi:[0,0,1]
    v_pk_fma_f32 v[104:105], v[88:89], s[52:53], v[110:111] op_sel_hi:[1,1,0] neg_lo:[1,0,1] neg_hi:[1,0,1]
    v_pk_fma_f32 v[128:129], v[112:113], s[52:53], v[134:135] op_sel_hi:[1,1,0] neg_lo:[1,0,1] neg_hi:[1,0,1]
    v_pk_fma_f32 v[152:153], v[136:137], s[52:53], v[158:159] op_sel_hi:[1,1,0] neg_lo:[1,0,1] neg_hi:[1,0,1]
    v_pk_fma_f32 v[176:177], v[160:161], s[52:53], v[182:183] op_sel_hi:[1,1,0] neg_lo:[1,0,1] neg_hi:[1,0,1]
    v_pk_fma_f32 v[98:99], v[90:91], s[52:53], v[108:109] op_sel_hi:[1,1,0] neg_lo:[0,0,1] neg_hi:[0,0,1]
    v_pk_fma_f32 v[122:123], v[114:115], s[52:53], v[132:133] op_sel_hi:[1,1,0] neg_lo:[0,0,1] neg_hi:[0,0,1]
    v_pk_fma_f32 v[146:147], v[138:139], s[52:53], v[156:157] op_sel_hi:[1,1,0] neg_lo:[0,0,1] neg_hi:[0,0,1]
    v_pk_fma_f32 v[170:171], v[162:163], s[52:53], v[180:181] op_sel_hi:[1,1,0] neg_lo:[0,0,1] neg_hi:[0,0,1]
    v_pk_fma_f32 v[106:107], v[90:91], s[52:53], v[110:111] op_sel_hi:[1,1,0] neg_lo:[1,0,1] neg_hi:[1,0,1]
    v_pk_fma_f32 v[130:131], v[114:115], s[52:53], v[134:135] op_sel_hi:[1,1,0] neg_lo:[1,0,1] neg_hi:[1,0,1]
    v_pk_fma_f32 v[154:155], v[138:139], s[52:53], v[158:159] op_sel_hi:[1,1,0] neg_lo:[1,0,1] neg_hi:[1,0,1]
    v_pk_fma_f32 v[178:179], v[162:163], s[52:53], v[182:183] op_sel_hi:[1,1,0] neg_lo:[1,0,1] neg_hi:[1,0,1]
    v_exp_f32 v92, v92
    v_exp_f32 v116, v116
    v_exp_f32 v140, v140
    v_exp_f32 v164, v164
    v_exp_f32 v100, v100
    v_exp_f32 v124, v124
    v_exp_f32 v148, v148
    v_exp_f32 v172, v172
    v_exp_f32 v93, v93
    v_exp_f32 v117, v117
    v_exp_f32 v141, v141
    v_exp_f32 v165, v165
    v_exp_f32 v101, v101
    v_exp_f32 v125, v125
    v_exp_f32 v149, v149
    v_exp_f32 v173, v173
    v_exp_f32 v94, v94
    v_exp_f32 v118, v118
    v_exp_f32 v142, v142
    v_exp_f32 v166, v166
    v_exp_f32 v102, v102
    v_exp_f32 v126, v126
    v_exp_f32 v150, v150
    v_exp_f32 v174, v174
    v_exp_f32 v95, v95
    v_exp_f32 v119, v119
    v_exp_f32 v143, v143
    v_exp_f32 v167, v167
    v_exp_f32 v103, v103
    v_exp_f32 v127, v127
    v_exp_f32 v151, v151
    v_exp_f32 v175, v175
    v_exp_f32 v96, v96
    v_exp_f32 v120, v120
    v_exp_f32 v144, v144
    v_exp_f32 v168, v168
    v_exp_f32 v104, v104
    v_exp_f32 v128, v128
    v_exp_f32 v152, v152
    v_exp_f32 v176, v176
    v_exp_f32 v97, v97
    v_exp_f32 v121, v121
    v_exp_f32 v145, v145
    v_exp_f32 v169, v169
    v_exp_f32 v105, v105
    v_exp_f32 v129, v129
    v_exp_f32 v153, v153
    v_exp_f32 v177, v177
    v_exp_f32 v98, v98
    v_exp_f32 v122, v122
    v_exp_f32 v146, v146
    v_exp_f32 v170, v170
    v_exp_f32 v106, v106
    v_exp_f32 v130, v130
    v_exp_f32 v154, v154
    v_exp_f32 v178, v178
    v_exp_f32 v99, v99
    v_exp_f32 v123, v123
    v_exp_f32 v147, v147
    v_exp_f32 v171, v171
    v_exp_f32 v107, v107
    v_exp_f32 v131, v131
    v_exp_f32 v155, v155
    v_exp_f32 v179, v179
    v_pk_add_f32 v[88:89], v[92:93], v[94:95]
    v_pk_add_f32 v[112:113], v[116:117], v[118:119]
    v_pk_add_f32 v[136:137], v[140:141], v[142:143]
    v_pk_add_f32 v[160:161], v[164:165], v[166:167]
    v_pk_add_f32 v[90:91], v[96:97], v[98:99]
    v_pk_add_f32 v[114:115], v[120:121], v[122:123]
    v_pk_add_f32 v[138:139], v[144:145], v[146:147]
    v_pk_add_f32 v[162:163], v[168:169], v[170:171]
    v_pk_add_f32 v[44:45], v[100:101], v[102:103]
    v_pk_add_f32 v[52:53], v[124:125], v[126:127]
    v_pk_add_f32 v[60:61], v[148:149], v[150:151]
    v_pk_add_f32 v[68:69], v[172:173], v[174:175]
    v_pk_add_f32 v[46:47], v[104:105], v[106:107]
    v_pk_add_f32 v[54:55], v[128:129], v[130:131]
    v_pk_add_f32 v[62:63], v[152:153], v[154:155]
    v_pk_add_f32 v[70:71], v[176:177], v[178:179]
    v_pk_add_f32 v[88:89], v[88:89], v[90:91]
    v_pk_add_f32 v[112:113], v[112:113], v[114:115]
    v_pk_add_f32 v[136:137], v[136:137], v[138:139]
    v_pk_add_f32 v[160:161], v[160:161], v[162:163]
    v_pk_add_f32 v[44:45], v[44:45], v[46:47]
    v_pk_add_f32 v[52:53], v[52:53], v[54:55]
    v_pk_add_f32 v[60:61], v[60:61], v[62:63]
    v_pk_add_f32 v[68:69], v[68:69], v[70:71]
    v_add_f32 v108, v88, v89
    v_add_f32 v132, v112, v113
    v_add_f32 v156, v136, v137
    v_add_f32 v180, v160, v161
    v_add_f32 v110, v44, v45
    v_add_f32 v134, v52, v53
    v_add_f32 v158, v60, v61
    v_add_f32 v182, v68, v69
    v_permlane32_swap_b32 v108, v110
    v_permlane32_swap_b32 v132, v134
    v_permlane32_swap_b32 v156, v158
    v_permlane32_swap_b32 v180, v182
    v_add_f32 v108, v108, v110
    v_add_f32 v132, v132, v134
    v_add_f32 v156, v156, v158
    v_add_f32 v180, v180, v182
    v_mov_b32 v110, v108
    v_mov_b32 v134, v132
    v_mov_b32 v158, v156
    v_mov_b32 v182, v180
    v_permlane16_swap_b32 v108, v110
    v_permlane16_swap_b32 v132, v134
    v_permlane16_swap_b32 v156, v158
    v_permlane16_swap_b32 v180, v182
    v_add_f32 v108, v108, v110
    v_add_f32 v132, v132, v134
    v_add_f32 v156, v156, v158
    v_add_f32 v180, v180, v182
    v_mov_b32 v110, v108
    v_mov_b32 v134, v132
    v_mov_b32 v158, v156
    v_mov_b32 v182, v180
    v_permlane32_swap_b32 v108, v110
    v_permlane32_swap_b32 v132, v134
    v_permlane32_swap_b32 v156, v158
    v_permlane32_swap_b32 v180, v182
    v_rcp_f32 v108, v108
    v_rcp_f32 v132, v132
    v_rcp_f32 v156, v156
    v_rcp_f32 v180, v180
    v_rcp_f32 v110, v110
    v_rcp_f32 v134, v134
    v_rcp_f32 v158, v158
    v_rcp_f32 v182, v182
    v_pk_mul_f32 v[92:93], v[92:93], v[108:109] op_sel_hi:[1,0]
    v_pk_mul_f32 v[116:117], v[116:117], v[132:133] op_sel_hi:[1,0]
    v_pk_mul_f32 v[140:141], v[140:141], v[156:157] op_sel_hi:[1,0]
    v_pk_mul_f32 v[164:165], v[164:165], v[180:181] op_sel_hi:[1,0]
    v_pk_mul_f32 v[100:101], v[100:101], v[110:111] op_sel_hi:[1,0]
    v_pk_mul_f32 v[124:125], v[124:125], v[134:135] op_sel_hi:[1,0]
    v_pk_mul_f32 v[148:149], v[148:149], v[158:159] op_sel_hi:[1,0]
    v_pk_mul_f32 v[172:173], v[172:173], v[182:183] op_sel_hi:[1,0]
    v_pk_mul_f32 v[94:95], v[94:95], v[108:109] op_sel_hi:[1,0]
    v_pk_mul_f32 v[118:119], v[118:119], v[132:133] op_sel_hi:[1,0]
    v_pk_mul_f32 v[142:143], v[142:143], v[156:157] op_sel_hi:[1,0]
    v_pk_mul_f32 v[166:167], v[166:167], v[180:181] op_sel_hi:[1,0]
    v_pk_mul_f32 v[102:103], v[102:103], v[110:111] op_sel_hi:[1,0]
    v_pk_mul_f32 v[126:127], v[126:127], v[134:135] op_sel_hi:[1,0]
    v_pk_mul_f32 v[150:151], v[150:151], v[158:159] op_sel_hi:[1,0]
    v_pk_mul_f32 v[174:175], v[174:175], v[182:183] op_sel_hi:[1,0]
    v_pk_mul_f32 v[96:97], v[96:97], v[108:109] op_sel_hi:[1,0]
    v_pk_mul_f32 v[120:121], v[120:121], v[132:133] op_sel_hi:[1,0]
    v_pk_mul_f32 v[144:145], v[144:145], v[156:157] op_sel_hi:[1,0]
    v_pk_mul_f32 v[168:169], v[168:169], v[180:181] op_sel_hi:[1,0]
    v_pk_mul_f32 v[104:105], v[104:105], v[110:111] op_sel_hi:[1,0]
    v_pk_mul_f32 v[128:129], v[128:129], v[134:135] op_sel_hi:[1,0]
    v_pk_mul_f32 v[152:153], v[152:153], v[158:159] op_sel_hi:[1,0]
    v_pk_mul_f32 v[176:177], v[176:177], v[182:183] op_sel_hi:[1,0]
    v_pk_mul_f32 v[98:99], v[98:99], v[108:109] op_sel_hi:[1,0]
    v_pk_mul_f32 v[122:123], v[122:123], v[132:133] op_sel_hi:[1,0]
    v_pk_mul_f32 v[146:147], v[146:147], v[156:157] op_sel_hi:[1,0]
    v_pk_mul_f32 v[170:171], v[170:171], v[180:181] op_sel_hi:[1,0]
    v_pk_mul_f32 v[106:107], v[106:107], v[110:111] op_sel_hi:[1,0]
    v_pk_mul_f32 v[130:131], v[130:131], v[134:135] op_sel_hi:[1,0]
    v_pk_mul_f32 v[154:155], v[154:155], v[158:159] op_sel_hi:[1,0]
    v_pk_mul_f32 v[178:179], v[178:179], v[182:183] op_sel_hi:[1,0]
    v_cvt_pk_bf16_f32 v40, v92, v93
    v_cvt_pk_bf16_f32 v48, v116, v117
    v_cvt_pk_bf16_f32 v56, v140, v141
    v_cvt_pk_bf16_f32 v64, v164, v165
    v_cvt_pk_bf16_f32 v44, v100, v101
    v_cvt_pk_bf16_f32 v52, v124, v125
    v_cvt_pk_bf16_f32 v60, v148, v149
    v_cvt_pk_bf16_f32 v68, v172, v173
    v_cvt_pk_bf16_f32 v41, v94, v95
    v_cvt_pk_bf16_f32 v49, v118, v119
    v_cvt_pk_bf16_f32 v57, v142, v143
    v_cvt_pk_bf16_f32 v65, v166, v167
    v_cvt_pk_bf16_f32 v45, v102, v103
    v_cvt_pk_bf16_f32 v53, v126, v127
    v_cvt_pk_bf16_f32 v61, v150, v151
    v_cvt_pk_bf16_f32 v69, v174, v175
    v_cvt_pk_bf16_f32 v42, v96, v97
    v_cvt_pk_bf16_f32 v50, v120, v121
    v_cvt_pk_bf16_f32 v58, v144, v145
    v_cvt_pk_bf16_f32 v66, v168, v169
    v_cvt_pk_bf16_f32 v46, v104, v105
    v_cvt_pk_bf16_f32 v54, v128, v129
    v_cvt_pk_bf16_f32 v62, v152, v153
    v_cvt_pk_bf16_f32 v70, v176, v177
    v_cvt_pk_bf16_f32 v43, v98, v99
    v_cvt_pk_bf16_f32 v51, v122, v123
    v_cvt_pk_bf16_f32 v59, v146, v147
    v_cvt_pk_bf16_f32 v67, v170, v171
    v_cvt_pk_bf16_f32 v47, v106, v107
    v_cvt_pk_bf16_f32 v55, v130, v131
    v_cvt_pk_bf16_f32 v63, v154, v155
    v_cvt_pk_bf16_f32 v71, v178, v179
    s_waitcnt vmcnt(0)
    v_mov_b32 v88, 153616
    ds_read_b32 v88, v88
    s_waitcnt lgkmcnt(0)
    v_readfirstlane_b32 s43, v88
    s_barrier
    v_lshlrev_b32 v2, 4, v1
    v_add_u32 v2, 65536, v2
    ds_read_b128 v[88:91], v2 offset:0
    ds_read_b128 v[92:95], v2 offset:1024
    ds_read_b128 v[96:99], v2 offset:2048
    ds_read_b128 v[100:103], v2 offset:3072
    ds_read_b128 v[104:107], v2 offset:4096
    ds_read_b128 v[108:111], v2 offset:5120
    ds_read_b128 v[112:115], v2 offset:6144
    ds_read_b128 v[116:119], v2 offset:7168
    ds_read_b128 v[120:123], v2 offset:8192
    ds_read_b128 v[124:127], v2 offset:9216
    ds_read_b128 v[128:131], v2 offset:10240
    ds_read_b128 v[132:135], v2 offset:11264
    v_and_b32 v3, 15, v1
    v_lshlrev_b32 v3, 7, v3
    v_lshrrev_b32 v4, 5, v1
    v_xor_b32 v4, v4, v1
    v_and_b32 v4, 7, v4
    v_lshl_add_u32 v3, v4, 4, v3
    v_bfe_u32 v4, v1, 4, 1
    v_lshl_add_u32 v3, v4, 3, v3
    s_lshl_b32 s44, s42, 13
    v_add_u32 v3, s44, v3
    v_xor_b32 v136, 0, v3
    v_xor_b32 v137, 32, v3
    v_xor_b32 v138, 64, v3
    v_xor_b32 v139, 96, v3
    s_mov_b32 s45, 0x358637bd
    s_waitcnt lgkmcnt(0)
    v_mfma_f32_16x16x32_bf16 v[140:143], v[88:91], v[8:11], 0
    v_mfma_f32_16x16x32_bf16 v[160:163], v[112:115], v[16:19], 0
    v_mfma_f32_16x16x32_bf16 v[180:183], v[88:91], v[24:27], 0
    v_mfma_f32_16x16x32_bf16 v[200:203], v[112:115], v[32:35], 0
    v_mfma_f32_16x16x32_bf16 v[144:147], v[92:95], v[8:11], 0
    v_mfma_f32_16x16x32_bf16 v[164:167], v[116:119], v[16:19], 0
    v_mfma_f32_16x16x32_bf16 v[184:187], v[92:95], v[24:27], 0
    v_mfma_f32_16x16x32_bf16 v[204:207], v[116:119], v[32:35], 0
    v_mfma_f32_16x16x32_bf16 v[148:151], v[104:107], v[8:11], 0
    v_mfma_f32_16x16x32_bf16 v[168:171], v[128:131], v[16:19], 0
    v_mfma_f32_16x16x32_bf16 v[188:191], v[104:107], v[24:27], 0
    v_mfma_f32_16x16x32_bf16 v[208:211], v[128:131], v[32:35], 0
    v_mfma_f32_16x16x32_bf16 v[140:143], v[96:99], v[12:15], v[140:143]
    v_mfma_f32_16x16x32_bf16 v[160:163], v[120:123], v[20:23], v[160:163]
    v_mfma_f32_16x16x32_bf16 v[180:183], v[96:99], v[28:31], v[180:183]
    v_mfma_f32_16x16x32_bf16 v[200:203], v[120:123], v[36:39], v[200:203]
    v_mfma_f32_16x16x32_bf16 v[144:147], v[100:103], v[12:15], v[144:147]
    v_mfma_f32_16x16x32_bf16 v[164:167], v[124:127], v[20:23], v[164:167]
    v_mfma_f32_16x16x32_bf16 v[184:187], v[100:103], v[28:31], v[184:187]
    v_mfma_f32_16x16x32_bf16 v[204:207], v[124:127], v[36:39], v[204:207]
    v_mfma_f32_16x16x32_bf16 v[148:151], v[108:111], v[12:15], v[148:151]
    v_mfma_f32_16x16x32_bf16 v[168:171], v[132:135], v[20:23], v[168:171]
    v_mfma_f32_16x16x32_bf16 v[188:191], v[108:111], v[28:31], v[188:191]
    v_mfma_f32_16x16x32_bf16 v[208:211], v[132:135], v[36:39], v[208:211]
    v_cvt_pk_bf16_f32 v156, v140, v141
    v_cvt_pk_bf16_f32 v176, v160, v161
    v_cvt_pk_bf16_f32 v196, v180, v181
    v_cvt_pk_bf16_f32 v216, v200, v201
    v_cvt_pk_bf16_f32 v157, v142, v143
    v_cvt_pk_bf16_f32 v177, v162, v163
    v_cvt_pk_bf16_f32 v197, v182, v183
    v_cvt_pk_bf16_f32 v217, v202, v203
    v_cvt_pk_bf16_f32 v158, v144, v145
    v_cvt_pk_bf16_f32 v178, v164, v165
    v_cvt_pk_bf16_f32 v198, v184, v185
    v_cvt_pk_bf16_f32 v218, v204, v205
    v_cvt_pk_bf16_f32 v159, v146, v147
    v_cvt_pk_bf16_f32 v179, v166, v167
    v_cvt_pk_bf16_f32 v199, v186, v187
    v_cvt_pk_bf16_f32 v219, v206, v207
    v_cvt_pk_bf16_f32 v152, v148, v148
    v_cvt_pk_bf16_f32 v172, v168, v168
    v_cvt_pk_bf16_f32 v192, v188, v188
    v_cvt_pk_bf16_f32 v212, v208, v208
    v_lshlrev_b32 v140, 16, v156
    v_lshlrev_b32 v160, 16, v176
    v_lshlrev_b32 v180, 16, v196
    v_lshlrev_b32 v200, 16, v216
    v_and_b32 v141, 0xffff0000, v156
    v_and_b32 v161, 0xffff0000, v176
    v_and_b32 v181, 0xffff0000, v196
    v_and_b32 v201, 0xffff0000, v216
    v_lshlrev_b32 v142, 16, v157
    v_lshlrev_b32 v162, 16, v177
    v_lshlrev_b32 v182, 16, v197
    v_lshlrev_b32 v202, 16, v217
    v_and_b32 v143, 0xffff0000, v157
    v_and_b32 v163, 0xffff0000, v177
    v_and_b32 v183, 0xffff0000, v197
    v_and_b32 v203, 0xffff0000, v217
    v_lshlrev_b32 v144, 16, v158
    v_lshlrev_b32 v164, 16, v178
    v_lshlrev_b32 v184, 16, v198
    v_lshlrev_b32 v204, 16, v218
    v_and_b32 v145, 0xffff0000, v158
    v_and_b32 v165, 0xffff0000, v178
    v_and_b32 v185, 0xffff0000, v198
    v_and_b32 v205, 0xffff0000, v218
    v_lshlrev_b32 v146, 16, v159
    v_lshlrev_b32 v166, 16, v179
    v_lshlrev_b32 v186, 16, v199
    v_lshlrev_b32 v206, 16, v219
    v_and_b32 v147, 0xffff0000, v159
    v_and_b32 v167, 0xffff0000, v179
    v_and_b32 v187, 0xffff0000, v199
    v_and_b32 v207, 0xffff0000, v219
    v_and_b32 v152, 0xffff0000, v152
    v_and_b32 v172, 0xffff0000, v172
    v_and_b32 v192, 0xffff0000, v192
    v_and_b32 v212, 0xffff0000, v212
    v_add_f32 v152, s45, v152
    v_add_f32 v172, s45, v172
    v_add_f32 v192, s45, v192
    v_add_f32 v212, s45, v212
    v_cvt_pk_bf16_f32 v152, v152, v152
    v_cvt_pk_bf16_f32 v172, v172, v172
    v_cvt_pk_bf16_f32 v192, v192, v192
    v_cvt_pk_bf16_f32 v212, v212, v212
    v_and_b32 v152, 0xffff0000, v152
    v_and_b32 v172, 0xffff0000, v172
    v_and_b32 v192, 0xffff0000, v192
    v_and_b32 v212, 0xffff0000, v212
    v_rcp_f32 v152, v152
    v_rcp_f32 v172, v172
    v_rcp_f32 v192, v192
    v_rcp_f32 v212, v212
    v_pk_mul_f32 v[140:141], v[140:141], v[152:153] op_sel_hi:[1,0]
    v_pk_mul_f32 v[160:161], v[160:161], v[172:173] op_sel_hi:[1,0]
    v_pk_mul_f32 v[180:181], v[180:181], v[192:193] op_sel_hi:[1,0]
    v_pk_mul_f32 v[200:201], v[200:201], v[212:213] op_sel_hi:[1,0]
    v_pk_mul_f32 v[142:143], v[142:143], v[152:153] op_sel_hi:[1,0]
    v_pk_mul_f32 v[162:163], v[162:163], v[172:173] op_sel_hi:[1,0]
    v_pk_mul_f32 v[182:183], v[182:183], v[192:193] op_sel_hi:[1,0]
    v_pk_mul_f32 v[202:203], v[202:203], v[212:213] op_sel_hi:[1,0]
    v_pk_mul_f32 v[144:145], v[144:145], v[152:153] op_sel_hi:[1,0]
    v_pk_mul_f32 v[164:165], v[164:165], v[172:173] op_sel_hi:[1,0]
    v_pk_mul_f32 v[184:185], v[184:185], v[192:193] op_sel_hi:[1,0]
    v_pk_mul_f32 v[204:205], v[204:205], v[212:213] op_sel_hi:[1,0]
    v_pk_mul_f32 v[146:147], v[146:147], v[152:153] op_sel_hi:[1,0]
    v_pk_mul_f32 v[166:167], v[166:167], v[172:173] op_sel_hi:[1,0]
    v_pk_mul_f32 v[186:187], v[186:187], v[192:193] op_sel_hi:[1,0]
    v_pk_mul_f32 v[206:207], v[206:207], v[212:213] op_sel_hi:[1,0]
    v_cvt_pk_bf16_f32 v156, v140, v141
    v_cvt_pk_bf16_f32 v176, v160, v161
    v_cvt_pk_bf16_f32 v196, v180, v181
    v_cvt_pk_bf16_f32 v216, v200, v201
    v_cvt_pk_bf16_f32 v157, v142, v143
    v_cvt_pk_bf16_f32 v177, v162, v163
    v_cvt_pk_bf16_f32 v197, v182, v183
    v_cvt_pk_bf16_f32 v217, v202, v203
    v_cvt_pk_bf16_f32 v158, v144, v145
    v_cvt_pk_bf16_f32 v178, v164, v165
    v_cvt_pk_bf16_f32 v198, v184, v185
    v_cvt_pk_bf16_f32 v218, v204, v205
    v_cvt_pk_bf16_f32 v159, v146, v147
    v_cvt_pk_bf16_f32 v179, v166, v167
    v_cvt_pk_bf16_f32 v199, v186, v187
    v_cvt_pk_bf16_f32 v219, v206, v207
    ds_write_b64 v136, v[156:157] offset:0
    ds_write_b64 v138, v[176:177] offset:0
    ds_write_b64 v136, v[196:197] offset:2048
    ds_write_b64 v138, v[216:217] offset:2048
    ds_write_b64 v137, v[158:159] offset:0
    ds_write_b64 v139, v[178:179] offset:0
    ds_write_b64 v137, v[198:199] offset:2048
    ds_write_b64 v139, v[218:219] offset:2048
    v_mfma_f32_16x16x32_bf16 v[140:143], v[88:91], v[40:43], 0
    v_mfma_f32_16x16x32_bf16 v[160:163], v[112:115], v[48:51], 0
    v_mfma_f32_16x16x32_bf16 v[180:183], v[88:91], v[56:59], 0
    v_mfma_f32_16x16x32_bf16 v[200:203], v[112:115], v[64:67], 0
    v_mfma_f32_16x16x32_bf16 v[144:147], v[92:95], v[40:43], 0
    v_mfma_f32_16x16x32_bf16 v[164:167], v[116:119], v[48:51], 0
    v_mfma_f32_16x16x32_bf16 v[184:187], v[92:95], v[56:59], 0
    v_mfma_f32_16x16x32_bf16 v[204:207], v[116:119], v[64:67], 0
    v_mfma_f32_16x16x32_bf16 v[148:151], v[104:107], v[40:43], 0
    v_mfma_f32_16x16x32_bf16 v[168:171], v[128:131], v[48:51], 0
    v_mfma_f32_16x16x32_bf16 v[188:191], v[104:107], v[56:59], 0
    v_mfma_f32_16x16x32_bf16 v[208:211], v[128:131], v[64:67], 0
    v_mfma_f32_16x16x32_bf16 v[140:143], v[96:99], v[44:47], v[140:143]
    v_mfma_f32_16x16x32_bf16 v[160:163], v[120:123], v[52:55], v[160:163]
    v_mfma_f32_16x16x32_bf16 v[180:183], v[96:99], v[60:63], v[180:183]
    v_mfma_f32_16x16x32_bf16 v[200:203], v[120:123], v[68:71], v[200:203]
    v_mfma_f32_16x16x32_bf16 v[144:147], v[100:103], v[44:47], v[144:147]
    v_mfma_f32_16x16x32_bf16 v[164:167], v[124:127], v[52:55], v[164:167]
    v_mfma_f32_16x16x32_bf16 v[184:187], v[100:103], v[60:63], v[184:187]
    v_mfma_f32_16x16x32_bf16 v[204:207], v[124:127], v[68:71], v[204:207]
    v_mfma_f32_16x16x32_bf16 v[148:151], v[108:111], v[44:47], v[148:151]
    v_mfma_f32_16x16x32_bf16 v[168:171], v[132:135], v[52:55], v[168:171]
    v_mfma_f32_16x16x32_bf16 v[188:191], v[108:111], v[60:63], v[188:191]
    v_mfma_f32_16x16x32_bf16 v[208:211], v[132:135], v[68:71], v[208:211]
    v_cvt_pk_bf16_f32 v156, v140, v141
    v_cvt_pk_bf16_f32 v176, v160, v161
    v_cvt_pk_bf16_f32 v196, v180, v181
    v_cvt_pk_bf16_f32 v216, v200, v201
    v_cvt_pk_bf16_f32 v157, v142, v143
    v_cvt_pk_bf16_f32 v177, v162, v163
    v_cvt_pk_bf16_f32 v197, v182, v183
    v_cvt_pk_bf16_f32 v217, v202, v203
    v_cvt_pk_bf16_f32 v158, v144, v145
    v_cvt_pk_bf16_f32 v178, v164, v165
    v_cvt_pk_bf16_f32 v198, v184, v185
    v_cvt_pk_bf16_f32 v218, v204, v205
    v_cvt_pk_bf16_f32 v159, v146, v147
    v_cvt_pk_bf16_f32 v179, v166, v167
    v_cvt_pk_bf16_f32 v199, v186, v187
    v_cvt_pk_bf16_f32 v219, v206, v207
    v_cvt_pk_bf16_f32 v152, v148, v148
    v_cvt_pk_bf16_f32 v172, v168, v168
    v_cvt_pk_bf16_f32 v192, v188, v188
    v_cvt_pk_bf16_f32 v212, v208, v208
    v_lshlrev_b32 v140, 16, v156
    v_lshlrev_b32 v160, 16, v176
    v_lshlrev_b32 v180, 16, v196
    v_lshlrev_b32 v200, 16, v216
    v_and_b32 v141, 0xffff0000, v156
    v_and_b32 v161, 0xffff0000, v176
    v_and_b32 v181, 0xffff0000, v196
    v_and_b32 v201, 0xffff0000, v216
    v_lshlrev_b32 v142, 16, v157
    v_lshlrev_b32 v162, 16, v177
    v_lshlrev_b32 v182, 16, v197
    v_lshlrev_b32 v202, 16, v217
    v_and_b32 v143, 0xffff0000, v157
    v_and_b32 v163, 0xffff0000, v177
    v_and_b32 v183, 0xffff0000, v197
    v_and_b32 v203, 0xffff0000, v217
    v_lshlrev_b32 v144, 16, v158
    v_lshlrev_b32 v164, 16, v178
    v_lshlrev_b32 v184, 16, v198
    v_lshlrev_b32 v204, 16, v218
    v_and_b32 v145, 0xffff0000, v158
    v_and_b32 v165, 0xffff0000, v178
    v_and_b32 v185, 0xffff0000, v198
    v_and_b32 v205, 0xffff0000, v218
    v_lshlrev_b32 v146, 16, v159
    v_lshlrev_b32 v166, 16, v179
    v_lshlrev_b32 v186, 16, v199
    v_lshlrev_b32 v206, 16, v219
    v_and_b32 v147, 0xffff0000, v159
    v_and_b32 v167, 0xffff0000, v179
    v_and_b32 v187, 0xffff0000, v199
    v_and_b32 v207, 0xffff0000, v219
    v_and_b32 v152, 0xffff0000, v152
    v_and_b32 v172, 0xffff0000, v172
    v_and_b32 v192, 0xffff0000, v192
    v_and_b32 v212, 0xffff0000, v212
    v_add_f32 v152, s45, v152
    v_add_f32 v172, s45, v172
    v_add_f32 v192, s45, v192
    v_add_f32 v212, s45, v212
    v_cvt_pk_bf16_f32 v152, v152, v152
    v_cvt_pk_bf16_f32 v172, v172, v172
    v_cvt_pk_bf16_f32 v192, v192, v192
    v_cvt_pk_bf16_f32 v212, v212, v212
    v_and_b32 v152, 0xffff0000, v152
    v_and_b32 v172, 0xffff0000, v172
    v_and_b32 v192, 0xffff0000, v192
    v_and_b32 v212, 0xffff0000, v212
    v_rcp_f32 v152, v152
    v_rcp_f32 v172, v172
    v_rcp_f32 v192, v192
    v_rcp_f32 v212, v212
    v_pk_mul_f32 v[140:141], v[140:141], v[152:153] op_sel_hi:[1,0]
    v_pk_mul_f32 v[160:161], v[160:161], v[172:173] op_sel_hi:[1,0]
    v_pk_mul_f32 v[180:181], v[180:181], v[192:193] op_sel_hi:[1,0]
    v_pk_mul_f32 v[200:201], v[200:201], v[212:213] op_sel_hi:[1,0]
    v_pk_mul_f32 v[142:143], v[142:143], v[152:153] op_sel_hi:[1,0]
    v_pk_mul_f32 v[162:163], v[162:163], v[172:173] op_sel_hi:[1,0]
    v_pk_mul_f32 v[182:183], v[182:183], v[192:193] op_sel_hi:[1,0]
    v_pk_mul_f32 v[202:203], v[202:203], v[212:213] op_sel_hi:[1,0]
    v_pk_mul_f32 v[144:145], v[144:145], v[152:153] op_sel_hi:[1,0]
    v_pk_mul_f32 v[164:165], v[164:165], v[172:173] op_sel_hi:[1,0]
    v_pk_mul_f32 v[184:185], v[184:185], v[192:193] op_sel_hi:[1,0]
    v_pk_mul_f32 v[204:205], v[204:205], v[212:213] op_sel_hi:[1,0]
    v_pk_mul_f32 v[146:147], v[146:147], v[152:153] op_sel_hi:[1,0]
    v_pk_mul_f32 v[166:167], v[166:167], v[172:173] op_sel_hi:[1,0]
    v_pk_mul_f32 v[186:187], v[186:187], v[192:193] op_sel_hi:[1,0]
    v_pk_mul_f32 v[206:207], v[206:207], v[212:213] op_sel_hi:[1,0]
    v_cvt_pk_bf16_f32 v156, v140, v141
    v_cvt_pk_bf16_f32 v176, v160, v161
    v_cvt_pk_bf16_f32 v196, v180, v181
    v_cvt_pk_bf16_f32 v216, v200, v201
    v_cvt_pk_bf16_f32 v157, v142, v143
    v_cvt_pk_bf16_f32 v177, v162, v163
    v_cvt_pk_bf16_f32 v197, v182, v183
    v_cvt_pk_bf16_f32 v217, v202, v203
    v_cvt_pk_bf16_f32 v158, v144, v145
    v_cvt_pk_bf16_f32 v178, v164, v165
    v_cvt_pk_bf16_f32 v198, v184, v185
    v_cvt_pk_bf16_f32 v218, v204, v205
    v_cvt_pk_bf16_f32 v159, v146, v147
    v_cvt_pk_bf16_f32 v179, v166, v167
    v_cvt_pk_bf16_f32 v199, v186, v187
    v_cvt_pk_bf16_f32 v219, v206, v207
    ds_write_b64 v136, v[156:157] offset:4096
    ds_write_b64 v138, v[176:177] offset:4096
    ds_write_b64 v136, v[196:197] offset:6144
    ds_write_b64 v138, v[216:217] offset:6144
    ds_write_b64 v137, v[158:159] offset:4096
    ds_write_b64 v139, v[178:179] offset:4096
    ds_write_b64 v137, v[198:199] offset:6144
    ds_write_b64 v139, v[218:219] offset:6144
    s_add_u32 s56, s34, 4194304
    s_addc_u32 s57, s35, 0
    s_mov_b32 s58, 4194304
    s_mov_b32 s59, 0x20000
    v_lshrrev_b32 v2, 3, v1
    v_xor_b32 v4, v2, v1
    v_and_b32 v4, 7, v4
    v_lshlrev_b32 v3, 7, v2
    v_lshl_add_u32 v3, v4, 4, v3
    v_add_u32 v3, s44, v3
    v_lshlrev_b32 v4, 11, v2
    v_and_b32 v5, 7, v1
    v_lshl_add_u32 v4, v5, 4, v4
    s_lshl_b32 s46, s37, 2
    s_add_u32 s46, s46, s42
    s_lshl_b32 s46, s46, 17
    s_lshl_b32 s47, s38, 7
    s_add_u32 s46, s46, s47
    v_add_u32 v4, s46, v4
    s_waitcnt lgkmcnt(0)
    ds_read_b128 v[8:11], v3 offset:0
    ds_read_b128 v[12:15], v3 offset:1024
    ds_read_b128 v[16:19], v3 offset:2048
    ds_read_b128 v[20:23], v3 offset:3072
    ds_read_b128 v[24:27], v3 offset:4096
    ds_read_b128 v[28:31], v3 offset:5120
    ds_read_b128 v[32:35], v3 offset:6144
    ds_read_b128 v[36:39], v3 offset:7168
    s_waitcnt lgkmcnt(7)
    s_mov_b32 s47, 0
    buffer_store_dwordx4 v[8:11], v4, s[56:59], s47 offen sc1
    s_waitcnt lgkmcnt(6)
    s_mov_b32 s47, 16384
    buffer_store_dwordx4 v[12:15], v4, s[56:59], s47 offen sc1
    s_waitcnt lgkmcnt(5)
    s_mov_b32 s47, 32768
    buffer_store_dwordx4 v[16:19], v4, s[56:59], s47 offen sc1
    s_waitcnt lgkmcnt(4)
    s_mov_b32 s47, 49152
    buffer_store_dwordx4 v[20:23], v4, s[56:59], s47 offen sc1
    s_waitcnt lgkmcnt(3)
    s_mov_b32 s47, 65536
    buffer_store_dwordx4 v[24:27], v4, s[56:59], s47 offen sc1
    s_waitcnt lgkmcnt(2)
    s_mov_b32 s47, 81920
    buffer_store_dwordx4 v[28:31], v4, s[56:59], s47 offen sc1
    s_waitcnt lgkmcnt(1)
    s_mov_b32 s47, 98304
    buffer_store_dwordx4 v[32:35], v4, s[56:59], s47 offen sc1
    s_waitcnt lgkmcnt(0)
    s_mov_b32 s47, 114688
    buffer_store_dwordx4 v[36:39], v4, s[56:59], s47 offen sc1
    s_waitcnt vmcnt(0)
    s_barrier
    s_cmp_eq_u32 s42, 0
    s_cbranch_scc0 Lsig_41
    s_add_u32 s60, s34, 10485760
    s_addc_u32 s61, s35, 0
    s_mov_b32 s62, 65536
    s_mov_b32 s63, 0x20000
    v_lshlrev_b32 v220, 7, v1
    s_lshl_b32 s64, s37, 11
    s_lshl_b32 s65, s38, 3
    s_add_u32 s64, s64, s65
    s_add_u32 s64, s64, 32768
    v_add_u32 v220, s64, v220
    v_mov_b32 v222, s43
    v_xor_b32 v223, 1540483477, v222
    s_mov_b64 s[64:65], exec
    s_mov_b64 exec, 65535
    buffer_store_dwordx2 v[222:223], v220, s[60:63], 0 offen sc1
    s_mov_b64 exec, s[64:65]
Lsig_41:
    s_lshl_b32 s50, s42, 10
    s_add_u32 s51, s50, 131072
    s_lshl_b32 s54, s37, 8
    s_and_b32 s44, s38, 1
    s_lshl_b32 s44, s44, 7
    s_add_u32 s54, s54, s44
    s_lshr_b32 s55, s2, 3
    s_and_b32 s55, s55, 3
    s_mul_i32 s55, s55, 4
    s_and_b32 s44, s2, 3
    s_mul_i32 s44, s44, 1
    s_add_u32 s55, s55, s44
    s_and_b32 s55, s55, 15
    s_lshl_b32 s48, s55, 7
    s_lshl_b32 s49, s55, 17
    s_add_u32 s56, s34, 4194304
    s_addc_u32 s57, s35, 0
    s_mov_b32 s58, 4194304
    s_mov_b32 s59, 0x20000
    v_lshrrev_b32 v5, 3, v1
    s_mov_b32 s44, 2048
    v_mul_lo_u32 v5, v5, s44
    v_lshrrev_b32 v2, 4, v1
    v_xor_b32 v2, v2, v1
    v_and_b32 v2, 7, v2
    s_and_b32 s44, s42, 1
    s_lshl_b32 s44, s44, 2
    v_xor_b32 v2, s44, v2
    v_lshl_add_u32 v5, v2, 4, v5
    s_mul_i32 s44, s42, 16384
    v_add_u32 v5, s44, v5
    s_add_u32 s44, s54, 0
    s_mul_i32 s44, s44, 2048
    v_add_u32 v6, s44, v5
    s_add_u32 s44, s54, 32
    s_mul_i32 s44, s44, 2048
    v_add_u32 v7, s44, v5
    s_add_u32 s44, s54, 64
    s_mul_i32 s44, s44, 2048
    v_add_u32 v8, s44, v5
    s_add_u32 s44, s54, 96
    s_mul_i32 s44, s44, 2048
    v_add_u32 v9, s44, v5
    s_mov_b32 s60, s10
    s_mov_b32 s61, s11
    s_mov_b32 s62, 2097152
    s_mov_b32 s63, 0x20000
    v_lshrrev_b32 v5, 3, v1
    s_lshl_b32 s44, s42, 3
    v_add_u32 v5, s44, v5
    s_mov_b32 s44, 2048
    v_mul_lo_u32 v5, v5, s44
    v_lshrrev_b32 v2, 3, v1
    v_and_b32 v2, 2, v2
    v_xor_b32 v2, v2, v1
    v_and_b32 v2, 7, v2
    s_and_b32 s44, s42, 1
    s_lshl_b32 s44, s44, 2
    v_xor_b32 v2, s44, v2
    v_lshl_add_u32 v5, v2, 4, v5
    s_lshr_b32 s44, s38, 1
    s_lshl_b32 s44, s44, 8
    s_add_u32 s44, s44, 0
    v_add_u32 v10, s44, v5
    s_lshr_b32 s44, s38, 1
    s_lshl_b32 s44, s44, 8
    s_add_u32 s44, s44, 65536
    v_add_u32 v11, s44, v5
    s_lshr_b32 s44, s38, 1
    s_lshl_b32 s44, s44, 8
    s_add_u32 s44, s44, 128
    v_add_u32 v12, s44, v5
    s_lshr_b32 s44, s38, 1
    s_lshl_b32 s44, s44, 8
    s_add_u32 s44, s44, 65664
    v_add_u32 v13, s44, v5
    v_mov_b32 v15, 131136
    s_cmp_eq_u32 s42, 0
    s_cbranch_scc0 Lq_42
    s_add_u32 s68, s34, 10485760
    s_addc_u32 s69, s35, 0
    s_mov_b32 s70, 65536
    s_mov_b32 s71, 0x20000
    s_lshl_b32 s72, s37, 11
    s_lshl_b32 s73, s38, 7
    s_add_u32 s72, s72, s73
    s_add_u32 s72, s72, 32768
    v_add_u32 v14, s55, v1
    v_and_b32 v14, 15, v14
    v_lshl_add_u32 v18, v14, 3, s72
    s_xor_b32 s75, s43, 1540483477
    s_mov_b32 s74, 0
Lpoll_43:
    buffer_load_dwordx2 v[16:17], v18, s[68:71], 0 offen sc1
    s_waitcnt vmcnt(0)
    v_cmp_eq_u32 vcc, s43, v16
    v_cmp_eq_u32 s[72:73], s75, v17
    s_nop 0
    s_and_b32 s72, s72, vcc_lo
    s_and_b32 s72, s72, 0xffff
    s_bcnt1_i32_b32 s65, s72
    s_cmp_ge_u32 s65, 12
    s_cbranch_scc1 Lpolld_44
    s_sleep 2
    s_add_u32 s74, s74, 1
    s_cmp_lt_u32 s74, 0x40000
    s_cbranch_scc1 Lpoll_43
Lpolld_44:
    s_mov_b32 s73, 0
    v_mbcnt_lo_u32_b32 v16, s72, 0
    v_sub_u32 v17, v1, v16
    v_add_u32 v17, s65, v17
    v_cndmask_b32 v16, v17, v16, s[72:73]
    v_lshlrev_b32 v16, 2, v16
    v_add_u32 v16, 131072, v16
    s_mov_b64 s[72:73], exec
    s_mov_b64 exec, 0xffff
    ds_write_b32 v16, v14
    s_mov_b64 exec, s[72:73]
    v_mov_b32 v16, s65
    v_mov_b32 v17, 0
    ds_write_b64 v15, v[16:17]
    s_waitcnt lgkmcnt(0)
Lq_42:
    s_barrier
    v_and_b32 v18, 15, v1
    v_lshlrev_b32 v18, 2, v18
    v_add_u32 v18, 131072, v18
    ds_read_b32 v14, v18
    ds_read_b32 v16, v15
    s_waitcnt lgkmcnt(0)
    v_readfirstlane_b32 s65, v16
    s_mov_b32 s64, 0
    v_readlane_b32 s67, v14, s64
    s_nop 0
    s_lshl_b32 s48, s67, 7
    s_lshl_b32 s49, s67, 17
    s_add_u32 s64, s64, 1
    s_add_u32 m0, s50, 0
    s_nop 0
    buffer_load_dwordx4 v6, s[56:59], s48 offen lds
    s_add_u32 m0, s50, 4096
    s_nop 0
    buffer_load_dwordx4 v7, s[56:59], s48 offen lds
    s_add_u32 m0, s50, 8192
    s_nop 0
    buffer_load_dwordx4 v8, s[56:59], s48 offen lds
    s_add_u32 m0, s50, 12288
    s_nop 0
    buffer_load_dwordx4 v9, s[56:59], s48 offen lds
    s_add_u32 m0, s50, 16384
    s_nop 0
    buffer_load_dwordx4 v10, s[60:63], s49 offen lds
    s_add_u32 m0, s50, 20480
    s_nop 0
    buffer_load_dwordx4 v11, s[60:63], s49 offen lds
    s_add_u32 m0, s50, 24576
    s_nop 0
    buffer_load_dwordx4 v12, s[60:63], s49 offen lds
    s_add_u32 m0, s50, 28672
    s_nop 0
    buffer_load_dwordx4 v13, s[60:63], s49 offen lds
    s_add_u32 s50, s50, 32768
    s_cmp_ge_u32 s50, s51
    s_cselect_b32 s52, 131072, 0
    s_sub_u32 s50, s50, s52
    v_readlane_b32 s67, v14, s64
    s_nop 0
    s_lshl_b32 s48, s67, 7
    s_lshl_b32 s49, s67, 17
    s_add_u32 s64, s64, 1
    s_add_u32 m0, s50, 0
    s_nop 0
    buffer_load_dwordx4 v6, s[56:59], s48 offen lds
    s_add_u32 m0, s50, 4096
    s_nop 0
    buffer_load_dwordx4 v7, s[56:59], s48 offen lds
    s_add_u32 m0, s50, 8192
    s_nop 0
    buffer_load_dwordx4 v8, s[56:59], s48 offen lds
    s_add_u32 m0, s50, 12288
    s_nop 0
    buffer_load_dwordx4 v9, s[56:59], s48 offen lds
    s_add_u32 m0, s50, 16384
    s_nop 0
    buffer_load_dwordx4 v10, s[60:63], s49 offen lds
    s_add_u32 m0, s50, 20480
    s_nop 0
    buffer_load_dwordx4 v11, s[60:63], s49 offen lds
    s_add_u32 m0, s50, 24576
    s_nop 0
    buffer_load_dwordx4 v12, s[60:63], s49 offen lds
    s_add_u32 m0, s50, 28672
    s_nop 0
    buffer_load_dwordx4 v13, s[60:63], s49 offen lds
    s_add_u32 s50, s50, 32768
    s_cmp_ge_u32 s50, s51
    s_cselect_b32 s52, 131072, 0
    s_sub_u32 s50, s50, s52
    v_readlane_b32 s67, v14, s64
    s_nop 0
    s_lshl_b32 s48, s67, 7
    s_lshl_b32 s49, s67, 17
    s_add_u32 s64, s64, 1
    s_add_u32 m0, s50, 0
    s_nop 0
    buffer_load_dwordx4 v6, s[56:59], s48 offen lds
    s_add_u32 m0, s50, 4096
    s_nop 0
    buffer_load_dwordx4 v7, s[56:59], s48 offen lds
    s_add_u32 m0, s50, 8192
    s_nop 0
    buffer_load_dwordx4 v8, s[56:59], s48 offen lds
    s_add_u32 m0, s50, 12288
    s_nop 0
    buffer_load_dwordx4 v9, s[56:59], s48 offen lds
    s_add_u32 m0, s50, 16384
    s_nop 0
    buffer_load_dwordx4 v10, s[60:63], s49 offen lds
    s_add_u32 m0, s50, 20480
    s_nop 0
    buffer_load_dwordx4 v11, s[60:63], s49 offen lds
    s_add_u32 m0, s50, 24576
    s_nop 0
    buffer_load_dwordx4 v12, s[60:63], s49 offen lds
    s_add_u32 m0, s50, 28672
    s_nop 0
    buffer_load_dwordx4 v13, s[60:63], s49 offen lds
    s_add_u32 s50, s50, 32768
    s_cmp_ge_u32 s50, s51
    s_cselect_b32 s52, 131072, 0
    s_sub_u32 s50, s50, s52
    s_waitcnt vmcnt(16)
    s_barrier
    s_mov_b32 s53, 0
Lld_45:
    s_cmp_lg_u32 s64, s65
    s_cbranch_scc1 Lsk_46
    s_cmp_eq_u32 s42, 0
    s_cbranch_scc0 Lw_47
    s_add_u32 s68, s34, 10485760
    s_addc_u32 s69, s35, 0
    s_mov_b32 s70, 65536
    s_mov_b32 s71, 0x20000
    s_lshl_b32 s72, s37, 11
    s_lshl_b32 s73, s38, 7
    s_add_u32 s72, s72, s73
    s_add_u32 s72, s72, 32768
    v_and_b32 v19, 15, v1
    v_lshlrev_b32 v19, 3, v19
    v_add_u32 v19, s72, v19
    s_xor_b32 s75, s43, 1540483477
    s_mov_b32 s76, 65535
    s_mov_b32 s74, 0
Lpoll_48:
    buffer_load_dwordx2 v[20:21], v19, s[68:71], 0 offen sc1
    s_waitcnt vmcnt(0)
    v_cmp_eq_u32 vcc, s43, v20
    v_cmp_eq_u32 s[72:73], s75, v21
    s_nop 0
    s_and_b32 s72, s72, vcc_lo
    s_and_b32 s72, s72, s76
    s_cmp_eq_u32 s72, s76
    s_cbranch_scc1 Lpolld_49
    s_sleep 3
    s_add_u32 s74, s74, 1
    s_cmp_lt_u32 s74, 0x40000
    s_cbranch_scc1 Lpoll_48
Lpolld_49:
    v_mov_b32 v16, 1
    ds_write_b32 v15, v16 offset:4
    s_waitcnt lgkmcnt(0)
    s_branch Lsk_46
Lw_47:
    ds_read_b32 v16, v15 offset:4
    s_waitcnt lgkmcnt(0)
    v_readfirstlane_b32 s67, v16
    s_nop 0
    s_cmp_eq_u32 s67, 1
    s_cbranch_scc1 Lsk_46
    s_sleep 1
    s_branch Lw_47
Lsk_46:
    v_readlane_b32 s67, v14, s64
    s_nop 0
    s_lshl_b32 s48, s67, 7
    s_lshl_b32 s49, s67, 17
    s_add_u32 s64, s64, 1
    s_add_u32 m0, s50, 0
    s_nop 0
    buffer_load_dwordx4 v6, s[56:59], s48 offen lds
    s_add_u32 m0, s50, 4096
    s_nop 0
    buffer_load_dwordx4 v7, s[56:59], s48 offen lds
    s_add_u32 m0, s50, 8192
    s_nop 0
    buffer_load_dwordx4 v8, s[56:59], s48 offen lds
    s_add_u32 m0, s50, 12288
    s_nop 0
    buffer_load_dwordx4 v9, s[56:59], s48 offen lds
    s_add_u32 m0, s50, 16384
    s_nop 0
    buffer_load_dwordx4 v10, s[60:63], s49 offen lds
    s_add_u32 m0, s50, 20480
    s_nop 0
    buffer_load_dwordx4 v11, s[60:63], s49 offen lds
    s_add_u32 m0, s50, 24576
    s_nop 0
    buffer_load_dwordx4 v12, s[60:63], s49 offen lds
    s_add_u32 m0, s50, 28672
    s_nop 0
    buffer_load_dwordx4 v13, s[60:63], s49 offen lds
    s_add_u32 s50, s50, 32768
    s_cmp_ge_u32 s50, s51
    s_cselect_b32 s52, 131072, 0
    s_sub_u32 s50, s50, s52
    s_waitcnt vmcnt(16)
    s_barrier
    s_add_u32 s53, s53, 1
    s_cmp_lt_u32 s53, 13
    s_cbranch_scc1 Lld_45
    s_waitcnt vmcnt(8)
    s_barrier
    s_waitcnt vmcnt(0)
    s_barrier
    s_barrier
    s_waitcnt vmcnt(0)
    s_endpgm
LsBl_71:
    s_lshl_b32 s50, s42, 10
    s_add_u32 s51, s50, 147456
    s_lshl_b32 s54, s37, 8
    s_lshl_b32 s48, s39, 7
    s_mov_b32 s49, s48
    s_mov_b32 s56, s12
    s_mov_b32 s57, s13
    s_mov_b32 s58, 4194304
    s_mov_b32 s59, 0x20000
    v_lshrrev_b32 v5, 3, v1
    s_mov_b32 s44, 2048
    v_mul_lo_u32 v5, v5, s44
    v_lshrrev_b32 v2, 4, v1
    v_xor_b32 v2, v2, v1
    v_and_b32 v2, 7, v2
    s_and_b32 s44, s42, 1
    s_lshl_b32 s44, s44, 2
    v_xor_b32 v2, s44, v2
    v_lshl_add_u32 v5, v2, 4, v5
    s_mul_i32 s44, s42, 16384
    v_add_u32 v5, s44, v5
    s_add_u32 s44, s54, 0
    s_mul_i32 s44, s44, 2048
    v_add_u32 v6, s44, v5
    s_add_u32 s44, s54, 32
    s_mul_i32 s44, s44, 2048
    v_add_u32 v7, s44, v5
    s_add_u32 s44, s54, 64
    s_mul_i32 s44, s44, 2048
    v_add_u32 v8, s44, v5
    s_add_u32 s44, s54, 96
    s_mul_i32 s44, s44, 2048
    v_add_u32 v9, s44, v5
    s_add_u32 s44, s54, 128
    s_mul_i32 s44, s44, 2048
    v_add_u32 v10, s44, v5
    s_add_u32 s44, s54, 160
    s_mul_i32 s44, s44, 2048
    v_add_u32 v11, s44, v5
    s_add_u32 s44, s54, 192
    s_mul_i32 s44, s44, 2048
    v_add_u32 v12, s44, v5
    s_add_u32 s44, s54, 224
    s_mul_i32 s44, s44, 2048
    v_add_u32 v13, s44, v5
    s_mov_b32 s60, s18
    s_mov_b32 s61, s19
    s_mov_b32 s62, 2097152
    s_mov_b32 s63, 0x20000
    s_mov_b32 s64, s20
    s_mov_b32 s65, s21
    s_mov_b32 s66, 2097152
    s_mov_b32 s67, 0x20000
    s_lshl_b32 s44, s38, 6
    s_add_u32 s44, s44, 0
    s_lshl_b32 s44, s44, 11
    v_add_u32 v14, s44, v5
    s_lshl_b32 s44, s38, 6
    s_add_u32 s44, s44, 0
    s_lshl_b32 s44, s44, 11
    v_add_u32 v15, s44, v5
    s_lshl_b32 s44, s38, 6
    s_add_u32 s44, s44, 32
    s_lshl_b32 s44, s44, 11
    v_add_u32 v16, s44, v5
    s_lshl_b32 s44, s38, 6
    s_add_u32 s44, s44, 32
    s_lshl_b32 s44, s44, 11
    v_add_u32 v17, s44, v5
    s_add_u32 m0, s50, 0
    s_nop 0
    buffer_load_dwordx4 v6, s[56:59], s48 offen lds
    s_add_u32 m0, s50, 4096
    s_nop 0
    buffer_load_dwordx4 v7, s[56:59], s48 offen lds
    s_add_u32 m0, s50, 8192
    s_nop 0
    buffer_load_dwordx4 v8, s[56:59], s48 offen lds
    s_add_u32 m0, s50, 12288
    s_nop 0
    buffer_load_dwordx4 v9, s[56:59], s48 offen lds
    s_add_u32 m0, s50, 16384
    s_nop 0
    buffer_load_dwordx4 v10, s[56:59], s48 offen lds
    s_add_u32 m0, s50, 20480
    s_nop 0
    buffer_load_dwordx4 v11, s[56:59], s48 offen lds
    s_add_u32 m0, s50, 24576
    s_nop 0
    buffer_load_dwordx4 v12, s[56:59], s48 offen lds
    s_add_u32 m0, s50, 28672
    s_nop 0
    buffer_load_dwordx4 v13, s[56:59], s48 offen lds
    s_add_u32 m0, s50, 32768
    s_nop 0
    buffer_load_dwordx4 v14, s[60:63], s49 offen lds
    s_add_u32 m0, s50, 36864
    s_nop 0
    buffer_load_dwordx4 v15, s[64:67], s49 offen lds
    s_add_u32 m0, s50, 40960
    s_nop 0
    buffer_load_dwordx4 v16, s[60:63], s49 offen lds
    s_add_u32 m0, s50, 45056
    s_nop 0
    buffer_load_dwordx4 v17, s[64:67], s49 offen lds
    s_add_u32 s48, s48, 128
    s_add_u32 s49, s49, 128
    s_cmp_ge_u32 s48, 2048
    s_cselect_b32 s48, 0, s48
    s_cselect_b32 s49, 0, s49
    s_add_u32 s50, s50, 49152
    s_cmp_ge_u32 s50, s51
    s_cselect_b32 s52, 147456, 0
    s_sub_u32 s50, s50, s52
    s_add_u32 m0, s50, 0
    s_nop 0
    buffer_load_dwordx4 v6, s[56:59], s48 offen lds
    s_add_u32 m0, s50, 4096
    s_nop 0
    buffer_load_dwordx4 v7, s[56:59], s48 offen lds
    s_add_u32 m0, s50, 8192
    s_nop 0
    buffer_load_dwordx4 v8, s[56:59], s48 offen lds
    s_add_u32 m0, s50, 12288
    s_nop 0
    buffer_load_dwordx4 v9, s[56:59], s48 offen lds
    s_add_u32 m0, s50, 16384
    s_nop 0
    buffer_load_dwordx4 v10, s[56:59], s48 offen lds
    s_add_u32 m0, s50, 20480
    s_nop 0
    buffer_load_dwordx4 v11, s[56:59], s48 offen lds
    s_add_u32 m0, s50, 24576
    s_nop 0
    buffer_load_dwordx4 v12, s[56:59], s48 offen lds
    s_add_u32 m0, s50, 28672
    s_nop 0
    buffer_load_dwordx4 v13, s[56:59], s48 offen lds
    s_add_u32 m0, s50, 32768
    s_nop 0
    buffer_load_dwordx4 v14, s[60:63], s49 offen lds
    s_add_u32 m0, s50, 36864
    s_nop 0
    buffer_load_dwordx4 v15, s[64:67], s49 offen lds
    s_add_u32 m0, s50, 40960
    s_nop 0
    buffer_load_dwordx4 v16, s[60:63], s49 offen lds
    s_add_u32 m0, s50, 45056
    s_nop 0
    buffer_load_dwordx4 v17, s[64:67], s49 offen lds
    s_add_u32 s48, s48, 128
    s_add_u32 s49, s49, 128
    s_cmp_ge_u32 s48, 2048
    s_cselect_b32 s48, 0, s48
    s_cselect_b32 s49, 0, s49
    s_add_u32 s50, s50, 49152
    s_cmp_ge_u32 s50, s51
    s_cselect_b32 s52, 147456, 0
    s_sub_u32 s50, s50, s52
    s_waitcnt vmcnt(12)
    s_barrier
    s_mov_b32 s53, 0
Lld_58:
    s_add_u32 m0, s50, 0
    s_nop 0
    buffer_load_dwordx4 v6, s[56:59], s48 offen lds
    s_add_u32 m0, s50, 4096
    s_nop 0
    buffer_load_dwordx4 v7, s[56:59], s48 offen lds
    s_add_u32 m0, s50, 8192
    s_nop 0
    buffer_load_dwordx4 v8, s[56:59], s48 offen lds
    s_add_u32 m0, s50, 12288
    s_nop 0
    buffer_load_dwordx4 v9, s[56:59], s48 offen lds
    s_add_u32 m0, s50, 16384
    s_nop 0
    buffer_load_dwordx4 v10, s[56:59], s48 offen lds
    s_add_u32 m0, s50, 20480
    s_nop 0
    buffer_load_dwordx4 v11, s[56:59], s48 offen lds
    s_add_u32 m0, s50, 24576
    s_nop 0
    buffer_load_dwordx4 v12, s[56:59], s48 offen lds
    s_add_u32 m0, s50, 28672
    s_nop 0
    buffer_load_dwordx4 v13, s[56:59], s48 offen lds
    s_add_u32 m0, s50, 32768
    s_nop 0
    buffer_load_dwordx4 v14, s[60:63], s49 offen lds
    s_add_u32 m0, s50, 36864
    s_nop 0
    buffer_load_dwordx4 v15, s[64:67], s49 offen lds
    s_add_u32 m0, s50, 40960
    s_nop 0
    buffer_load_dwordx4 v16, s[60:63], s49 offen lds
    s_add_u32 m0, s50, 45056
    s_nop 0
    buffer_load_dwordx4 v17, s[64:67], s49 offen lds
    s_add_u32 s48, s48, 128
    s_add_u32 s49, s49, 128
    s_cmp_ge_u32 s48, 2048
    s_cselect_b32 s48, 0, s48
    s_cselect_b32 s49, 0, s49
    s_add_u32 s50, s50, 49152
    s_cmp_ge_u32 s50, s51
    s_cselect_b32 s52, 147456, 0
    s_sub_u32 s50, s50, s52
    s_waitcnt vmcnt(12)
    s_barrier
    s_add_u32 s53, s53, 1
    s_cmp_lt_u32 s53, 14
    s_cbranch_scc1 Lld_58
    s_waitcnt vmcnt(0)
    s_barrier
    s_barrier
    s_cmp_eq_u32 s42, 0
    s_cbranch_scc0 Linv_59
Linv_59:
    s_and_b32 s44, s37, 3
    s_lshl_b32 s44, s44, 1
    s_and_b32 s45, s38, 1
    s_add_u32 s44, s44, s45
    s_lshl_b32 s44, s44, 2
    s_add_u32 s44, s44, s42
    s_lshr_b32 s45, s38, 1
    s_lshl_b32 s45, s45, 18
    s_lshl_b32 s44, s44, 13
    s_add_u32 s44, s44, s45
    v_lshlrev_b32 v2, 4, v1
    s_mov_b32 s48, s22
    s_mov_b32 s49, s23
    s_mov_b32 s50, 2097152
    s_mov_b32 s51, 0x20000
    buffer_load_dwordx4 v[4:7], v2, s[48:51], s44 offen offset:0
    buffer_load_dwordx4 v[8:11], v2, s[48:51], s44 offen offset:1024
    buffer_load_dwordx4 v[12:15], v2, s[48:51], s44 offen offset:2048
    buffer_load_dwordx4 v[16:19], v2, s[48:51], s44 offen offset:3072
    s_add_u32 s45, s44, 4096
    buffer_load_dwordx4 v[4:7], v2, s[48:51], s45 offen offset:0
    buffer_load_dwordx4 v[8:11], v2, s[48:51], s45 offen offset:1024
    buffer_load_dwordx4 v[12:15], v2, s[48:51], s45 offen offset:2048
    buffer_load_dwordx4 v[16:19], v2, s[48:51], s45 offen offset:3072
    s_mov_b32 s52, s24
    s_mov_b32 s53, s25
    s_mov_b32 s54, 2097152
    s_mov_b32 s55, 0x20000
    buffer_load_dwordx4 v[4:7], v2, s[52:55], s44 offen offset:0
    buffer_load_dwordx4 v[8:11], v2, s[52:55], s44 offen offset:1024
    buffer_load_dwordx4 v[12:15], v2, s[52:55], s44 offen offset:2048
    buffer_load_dwordx4 v[16:19], v2, s[52:55], s44 offen offset:3072
    s_add_u32 s45, s44, 4096
    buffer_load_dwordx4 v[4:7], v2, s[52:55], s45 offen offset:0
    buffer_load_dwordx4 v[8:11], v2, s[52:55], s45 offen offset:1024
    buffer_load_dwordx4 v[12:15], v2, s[52:55], s45 offen offset:2048
    buffer_load_dwordx4 v[16:19], v2, s[52:55], s45 offen offset:3072
    s_barrier
    s_barrier
    s_barrier
    s_waitcnt vmcnt(0)
    v_mov_b32 v20, 153616
    ds_read_b32 v20, v20
    s_waitcnt lgkmcnt(0)
    v_readfirstlane_b32 s43, v20
    s_lshl_b32 s50, s42, 10
    s_add_u32 s51, s50, 131072
    s_lshl_b32 s54, s37, 8
    s_and_b32 s44, s38, 1
    s_lshl_b32 s44, s44, 7
    s_add_u32 s54, s54, s44
    s_lshr_b32 s55, s2, 3
    s_and_b32 s55, s55, 3
    s_mul_i32 s55, s55, 8
    s_and_b32 s44, s2, 3
    s_mul_i32 s44, s44, 2
    s_add_u32 s55, s55, s44
    s_and_b32 s55, s55, 31
    s_lshl_b32 s48, s55, 7
    s_add_u32 s56, s34, 16777216
    s_addc_u32 s57, s35, 0
    s_mov_b32 s58, 8388608
    s_mov_b32 s59, 0x20000
    v_lshrrev_b32 v5, 3, v1
    s_mov_b32 s44, 4096
    v_mul_lo_u32 v5, v5, s44
    v_lshrrev_b32 v2, 4, v1
    v_xor_b32 v2, v2, v1
    v_and_b32 v2, 7, v2
    s_and_b32 s44, s42, 1
    s_lshl_b32 s44, s44, 2
    v_xor_b32 v2, s44, v2
    v_lshl_add_u32 v5, v2, 4, v5
    s_mul_i32 s44, s42, 32768
    v_add_u32 v5, s44, v5
    s_add_u32 s44, s54, 0
    s_mul_i32 s44, s44, 4096
    v_add_u32 v6, s44, v5
    s_add_u32 s44, s54, 32
    s_mul_i32 s44, s44, 4096
    v_add_u32 v7, s44, v5
    s_add_u32 s44, s54, 64
    s_mul_i32 s44, s44, 4096
    v_add_u32 v8, s44, v5
    s_add_u32 s44, s54, 96
    s_mul_i32 s44, s44, 4096
    v_add_u32 v9, s44, v5
    s_mov_b32 s60, s22
    s_mov_b32 s61, s23
    s_mov_b32 s62, 2097152
    s_mov_b32 s63, 0x20000
    v_lshrrev_b32 v5, 3, v1
    s_mov_b32 s44, 2048
    v_mul_lo_u32 v5, v5, s44
    v_lshrrev_b32 v2, 4, v1
    v_xor_b32 v2, v2, v1
    v_and_b32 v2, 7, v2
    s_and_b32 s44, s42, 1
    s_lshl_b32 s44, s44, 2
    v_xor_b32 v2, s44, v2
    v_lshl_add_u32 v5, v2, 4, v5
    s_mul_i32 s44, s42, 16384
    v_add_u32 v5, s44, v5
    s_lshr_b32 s44, s38, 1
    s_lshl_b32 s44, s44, 7
    s_add_u32 s44, s44, 0
    s_lshl_b32 s44, s44, 11
    v_add_u32 v10, s44, v5
    s_lshr_b32 s44, s38, 1
    s_lshl_b32 s44, s44, 7
    s_add_u32 s44, s44, 32
    s_lshl_b32 s44, s44, 11
    v_add_u32 v11, s44, v5
    s_lshr_b32 s44, s38, 1
    s_lshl_b32 s44, s44, 7
    s_add_u32 s44, s44, 64
    s_lshl_b32 s44, s44, 11
    v_add_u32 v12, s44, v5
    s_lshr_b32 s44, s38, 1
    s_lshl_b32 s44, s44, 7
    s_add_u32 s44, s44, 96
    s_lshl_b32 s44, s44, 11
    v_add_u32 v13, s44, v5
    s_mov_b32 s64, s12
    s_mov_b32 s65, s13
    s_mov_b32 s66, 4194304
    s_mov_b32 s67, 0x20000
    v_lshrrev_b32 v2, 4, v1
    s_lshl_b32 s44, s42, 2
    v_add_u32 v2, s44, v2
    v_xor_b32 v3, v2, v1
    v_and_b32 v3, 15, v3
    v_add_u32 v2, s54, v2
    v_lshlrev_b32 v2, 11, v2
    v_lshl_add_u32 v2, v3, 4, v2
    s_lshr_b32 s44, s38, 1
    s_lshl_b32 s44, s44, 8
    v_add_u32 v2, s44, v2
    v_add_u32 v14, 0, v2
    v_add_u32 v15, 32768, v2
    v_add_u32 v16, 65536, v2
    v_add_u32 v17, 98304, v2
    v_add_u32 v18, 131072, v2
    v_add_u32 v19, 163840, v2
    v_add_u32 v20, 196608, v2
    v_add_u32 v21, 229376, v2
    s_and_b32 s49, s48, 2047
    s_cmp_lt_u32 s48, 2048
    s_cselect_b32 s60, s22, s24
    s_cselect_b32 s61, s23, s25
    v_mov_b32 v23, 131136
    s_cmp_eq_u32 s42, 0
    s_cbranch_scc0 Lq_60
    s_add_u32 s72, s34, 10485760
    s_addc_u32 s73, s35, 0
    s_mov_b32 s74, 65536
    s_mov_b32 s75, 0x20000
    s_lshl_b32 s76, s37, 11
    s_lshl_b32 s77, s38, 7
    s_add_u32 s76, s76, s77
    s_add_u32 s76, s76, 49152
    v_add_u32 v22, s55, v1
    v_and_b32 v22, 15, v22
    v_lshl_add_u32 v26, v22, 3, s76
    s_xor_b32 s79, s43, 1540483477
    s_mov_b32 s78, 0
Lpoll_61:
    buffer_load_dwordx2 v[24:25], v26, s[72:75], 0 offen sc1
    s_waitcnt vmcnt(0)
    v_cmp_eq_u32 vcc, s43, v24
    v_cmp_eq_u32 s[76:77], s79, v25
    s_nop 0
    s_and_b32 s76, s76, vcc_lo
    s_and_b32 s76, s76, 0xffff
    s_bcnt1_i32_b32 s69, s76
    s_cmp_ge_u32 s69, 12
    s_cbranch_scc1 Lpolld_62
    s_sleep 2
    s_add_u32 s78, s78, 1
    s_cmp_lt_u32 s78, 0x40000
    s_cbranch_scc1 Lpoll_61
Lpolld_62:
    s_mov_b32 s77, 0
    v_mbcnt_lo_u32_b32 v24, s76, 0
    v_sub_u32 v25, v1, v24
    v_add_u32 v25, s69, v25
    v_cndmask_b32 v24, v25, v24, s[76:77]
    v_lshlrev_b32 v24, 2, v24
    v_add_u32 v24, 131072, v24
    s_mov_b64 s[76:77], exec
    s_mov_b64 exec, 0xffff
    ds_write_b32 v24, v22
    s_mov_b64 exec, s[76:77]
    v_mov_b32 v24, s69
    v_mov_b32 v25, 0
    ds_write_b64 v23, v[24:25]
    s_waitcnt lgkmcnt(0)
Lq_60:
    s_barrier
    v_and_b32 v26, 15, v1
    v_lshlrev_b32 v26, 2, v26
    v_add_u32 v26, 131072, v26
    ds_read_b32 v22, v26
    ds_read_b32 v24, v23
    s_waitcnt lgkmcnt(0)
    v_readfirstlane_b32 s69, v24
    s_nop 0
    s_lshl_b32 s69, s69, 1
    s_mov_b32 s68, 0
    s_lshr_b32 s70, s68, 1
    v_readlane_b32 s71, v22, s70
    s_and_b32 s70, s68, 1
    s_lshl_b32 s70, s70, 11
    s_lshl_b32 s48, s71, 7
    s_add_u32 s48, s48, s70
    s_and_b32 s49, s48, 2047
    s_cmp_lt_u32 s48, 2048
    s_cselect_b32 s60, s22, s24
    s_cselect_b32 s61, s23, s25
    s_add_u32 s68, s68, 1
    s_add_u32 m0, s50, 0
    s_nop 0
    buffer_load_dwordx4 v6, s[56:59], s48 offen lds
    s_add_u32 m0, s50, 4096
    s_nop 0
    buffer_load_dwordx4 v7, s[56:59], s48 offen lds
    s_add_u32 m0, s50, 8192
    s_nop 0
    buffer_load_dwordx4 v8, s[56:59], s48 offen lds
    s_add_u32 m0, s50, 12288
    s_nop 0
    buffer_load_dwordx4 v9, s[56:59], s48 offen lds
    s_add_u32 m0, s50, 16384
    s_nop 0
    buffer_load_dwordx4 v10, s[60:63], s49 offen lds
    s_add_u32 m0, s50, 20480
    s_nop 0
    buffer_load_dwordx4 v11, s[60:63], s49 offen lds
    s_add_u32 m0, s50, 24576
    s_nop 0
    buffer_load_dwordx4 v12, s[60:63], s49 offen lds
    s_add_u32 m0, s50, 28672
    s_nop 0
    buffer_load_dwordx4 v13, s[60:63], s49 offen lds
    s_add_u32 s50, s50, 32768
    s_cmp_ge_u32 s50, s51
    s_cselect_b32 s52, 131072, 0
    s_sub_u32 s50, s50, s52
    s_lshr_b32 s70, s68, 1
    v_readlane_b32 s71, v22, s70
    s_and_b32 s70, s68, 1
    s_lshl_b32 s70, s70, 11
    s_lshl_b32 s48, s71, 7
    s_add_u32 s48, s48, s70
    s_and_b32 s49, s48, 2047
    s_cmp_lt_u32 s48, 2048
    s_cselect_b32 s60, s22, s24
    s_cselect_b32 s61, s23, s25
    s_add_u32 s68, s68, 1
    s_add_u32 m0, s50, 0
    s_nop 0
    buffer_load_dwordx4 v6, s[56:59], s48 offen lds
    s_add_u32 m0, s50, 4096
    s_nop 0
    buffer_load_dwordx4 v7, s[56:59], s48 offen lds
    s_add_u32 m0, s50, 8192
    s_nop 0
    buffer_load_dwordx4 v8, s[56:59], s48 offen lds
    s_add_u32 m0, s50, 12288
    s_nop 0
    buffer_load_dwordx4 v9, s[56:59], s48 offen lds
    s_add_u32 m0, s50, 16384
    s_nop 0
    buffer_load_dwordx4 v10, s[60:63], s49 offen lds
    s_add_u32 m0, s50, 20480
    s_nop 0
    buffer_load_dwordx4 v11, s[60:63], s49 offen lds
    s_add_u32 m0, s50, 24576
    s_nop 0
    buffer_load_dwordx4 v12, s[60:63], s49 offen lds
    s_add_u32 m0, s50, 28672
    s_nop 0
    buffer_load_dwordx4 v13, s[60:63], s49 offen lds
    s_add_u32 s50, s50, 32768
    s_cmp_ge_u32 s50, s51
    s_cselect_b32 s52, 131072, 0
    s_sub_u32 s50, s50, s52
    s_lshr_b32 s70, s68, 1
    v_readlane_b32 s71, v22, s70
    s_and_b32 s70, s68, 1
    s_lshl_b32 s70, s70, 11
    s_lshl_b32 s48, s71, 7
    s_add_u32 s48, s48, s70
    s_and_b32 s49, s48, 2047
    s_cmp_lt_u32 s48, 2048
    s_cselect_b32 s60, s22, s24
    s_cselect_b32 s61, s23, s25
    s_add_u32 s68, s68, 1
    s_add_u32 m0, s50, 0
    s_nop 0
    buffer_load_dwordx4 v6, s[56:59], s48 offen lds
    s_add_u32 m0, s50, 4096
    s_nop 0
    buffer_load_dwordx4 v7, s[56:59], s48 offen lds
    s_add_u32 m0, s50, 8192
    s_nop 0
    buffer_load_dwordx4 v8, s[56:59], s48 offen lds
    s_add_u32 m0, s50, 12288
    s_nop 0
    buffer_load_dwordx4 v9, s[56:59], s48 offen lds
    s_add_u32 m0, s50, 16384
    s_nop 0
    buffer_load_dwordx4 v10, s[60:63], s49 offen lds
    s_add_u32 m0, s50, 20480
    s_nop 0
    buffer_load_dwordx4 v11, s[60:63], s49 offen lds
    s_add_u32 m0, s50, 24576
    s_nop 0
    buffer_load_dwordx4 v12, s[60:63], s49 offen lds
    s_add_u32 m0, s50, 28672
    s_nop 0
    buffer_load_dwordx4 v13, s[60:63], s49 offen lds
    s_add_u32 s50, s50, 32768
    s_cmp_ge_u32 s50, s51
    s_cselect_b32 s52, 131072, 0
    s_sub_u32 s50, s50, s52
    s_waitcnt vmcnt(16)
    s_barrier
    s_mov_b32 s53, 0
Lld_63:
    s_cmp_lg_u32 s68, s69
    s_cbranch_scc1 Lsk_64
    s_cmp_eq_u32 s42, 0
    s_cbranch_scc0 Lw_65
    s_add_u32 s72, s34, 10485760
    s_addc_u32 s73, s35, 0
    s_mov_b32 s74, 65536
    s_mov_b32 s75, 0x20000
    s_lshl_b32 s76, s37, 11
    s_lshl_b32 s77, s38, 7
    s_add_u32 s76, s76, s77
    s_add_u32 s76, s76, 49152
    v_and_b32 v27, 15, v1
    v_lshlrev_b32 v27, 3, v27
    v_add_u32 v27, s76, v27
    s_xor_b32 s79, s43, 1540483477
    s_mov_b32 s80, 65535
    s_mov_b32 s78, 0
Lpoll_66:
    buffer_load_dwordx2 v[28:29], v27, s[72:75], 0 offen sc1
    s_waitcnt vmcnt(0)
    v_cmp_eq_u32 vcc, s43, v28
    v_cmp_eq_u32 s[76:77], s79, v29
    s_nop 0
    s_and_b32 s76, s76, vcc_lo
    s_and_b32 s76, s76, s80
    s_cmp_eq_u32 s76, s80
    s_cbranch_scc1 Lpolld_67
    s_sleep 3
    s_add_u32 s78, s78, 1
    s_cmp_lt_u32 s78, 0x40000
    s_cbranch_scc1 Lpoll_66
Lpolld_67:
    v_mov_b32 v24, 1
    ds_write_b32 v23, v24 offset:4
    s_waitcnt lgkmcnt(0)
    s_branch Lsk_64
Lw_65:
    ds_read_b32 v24, v23 offset:4
    s_waitcnt lgkmcnt(0)
    v_readfirstlane_b32 s71, v24
    s_nop 0
    s_cmp_eq_u32 s71, 1
    s_cbranch_scc1 Lsk_64
    s_sleep 1
    s_branch Lw_65
Lsk_64:
    s_lshr_b32 s70, s68, 1
    v_readlane_b32 s71, v22, s70
    s_and_b32 s70, s68, 1
    s_lshl_b32 s70, s70, 11
    s_lshl_b32 s48, s71, 7
    s_add_u32 s48, s48, s70
    s_and_b32 s49, s48, 2047
    s_cmp_lt_u32 s48, 2048
    s_cselect_b32 s60, s22, s24
    s_cselect_b32 s61, s23, s25
    s_add_u32 s68, s68, 1
    s_add_u32 m0, s50, 0
    s_nop 0
    buffer_load_dwordx4 v6, s[56:59], s48 offen lds
    s_add_u32 m0, s50, 4096
    s_nop 0
    buffer_load_dwordx4 v7, s[56:59], s48 offen lds
    s_add_u32 m0, s50, 8192
    s_nop 0
    buffer_load_dwordx4 v8, s[56:59], s48 offen lds
    s_add_u32 m0, s50, 12288
    s_nop 0
    buffer_load_dwordx4 v9, s[56:59], s48 offen lds
    s_add_u32 m0, s50, 16384
    s_nop 0
    buffer_load_dwordx4 v10, s[60:63], s49 offen lds
    s_add_u32 m0, s50, 20480
    s_nop 0
    buffer_load_dwordx4 v11, s[60:63], s49 offen lds
    s_add_u32 m0, s50, 24576
    s_nop 0
    buffer_load_dwordx4 v12, s[60:63], s49 offen lds
    s_add_u32 m0, s50, 28672
    s_nop 0
    buffer_load_dwordx4 v13, s[60:63], s49 offen lds
    s_add_u32 s50, s50, 32768
    s_cmp_ge_u32 s50, s51
    s_cselect_b32 s52, 131072, 0
    s_sub_u32 s50, s50, s52
    s_waitcnt vmcnt(16)
    s_barrier
    s_add_u32 s53, s53, 1
    s_cmp_lt_u32 s53, 29
    s_cbranch_scc1 Lld_63
    s_add_u32 m0, s50, 0
    s_nop 0
    buffer_load_dwordx4 v14, s[64:67], 0 offen lds
    s_add_u32 m0, s50, 4096
    s_nop 0
    buffer_load_dwordx4 v15, s[64:67], 0 offen lds
    s_add_u32 m0, s50, 8192
    s_nop 0
    buffer_load_dwordx4 v16, s[64:67], 0 offen lds
    s_add_u32 m0, s50, 12288
    s_nop 0
    buffer_load_dwordx4 v17, s[64:67], 0 offen lds
    s_add_u32 m0, s50, 16384
    s_nop 0
    buffer_load_dwordx4 v18, s[64:67], 0 offen lds
    s_add_u32 m0, s50, 20480
    s_nop 0
    buffer_load_dwordx4 v19, s[64:67], 0 offen lds
    s_add_u32 m0, s50, 24576
    s_nop 0
    buffer_load_dwordx4 v20, s[64:67], 0 offen lds
    s_add_u32 m0, s50, 28672
    s_nop 0
    buffer_load_dwordx4 v21, s[64:67], 0 offen lds
    s_waitcnt vmcnt(16)
    s_barrier
    s_waitcnt vmcnt(8)
    s_barrier
    s_waitcnt vmcnt(0)
    s_barrier
    s_waitcnt vmcnt(0)
    s_endpgm
LsAc_68:
    s_lshr_b32 s40, s36, 1
    s_and_b32 s41, s36, 1
    s_lshl_b32 s51, s38, 1
    s_add_u32 s51, s51, s41
    s_mov_b32 s52, 1069066811
    s_mov_b32 s53, 1069066811
    s_mov_b32 s56, s8
    s_mov_b32 s57, s9
    s_mov_b32 s58, 65536
    s_mov_b32 s59, 0x20000
    v_lshrrev_b32 v2, 4, v1
    v_lshlrev_b32 v2, 8, v2
    v_and_b32 v3, 15, v1
    v_lshl_add_u32 v2, v3, 1, v2
    s_lshl_b32 s44, s51, 11
    buffer_load_ushort v8, v2, s[56:59], s44 offen offset:0
    buffer_load_ushort v9, v2, s[56:59], s44 offen offset:64
    buffer_load_ushort v10, v2, s[56:59], s44 offen offset:128
    buffer_load_ushort v11, v2, s[56:59], s44 offen offset:192
    buffer_load_ushort v12, v2, s[56:59], s44 offen offset:1024
    buffer_load_ushort v13, v2, s[56:59], s44 offen offset:1088
    buffer_load_ushort v14, v2, s[56:59], s44 offen offset:1152
    buffer_load_ushort v15, v2, s[56:59], s44 offen offset:1216
    buffer_load_ushort v16, v2, s[56:59], s44 offen offset:32
    buffer_load_ushort v17, v2, s[56:59], s44 offen offset:96
    buffer_load_ushort v18, v2, s[56:59], s44 offen offset:160
    buffer_load_ushort v19, v2, s[56:59], s44 offen offset:224
    buffer_load_ushort v20, v2, s[56:59], s44 offen offset:1056
    buffer_load_ushort v21, v2, s[56:59], s44 offen offset:1120
    buffer_load_ushort v22, v2, s[56:59], s44 offen offset:1184
    buffer_load_ushort v23, v2, s[56:59], s44 offen offset:1248
    s_waitcnt vmcnt(0)
    v_lshl_or_b32 v136, v9, 16, v8
    v_lshl_or_b32 v137, v11, 16, v10
    v_lshl_or_b32 v138, v13, 16, v12
    v_lshl_or_b32 v139, v15, 16, v14
    v_lshl_or_b32 v140, v17, 16, v16
    v_lshl_or_b32 v141, v19, 16, v18
    v_lshl_or_b32 v142, v21, 16, v20
    v_lshl_or_b32 v143, v23, 16, v22
    s_lshl_b32 s44, s40, 14
    v_and_b32 v2, 15, v1
    v_lshlrev_b32 v2, 7, v2
    v_lshrrev_b32 v3, 4, v1
    v_bfe_u32 v4, v1, 1, 3
    v_xor_b32 v3, v3, v4
    v_lshl_add_u32 v2, v3, 4, v2
    v_add_u32 v2, s44, v2
    v_xor_b32 v144, 0, v2
    v_xor_b32 v145, 64, v2
    v_lshrrev_b32 v2, 4, v1
    v_lshlrev_b32 v2, 3, v2
    v_bfe_u32 v3, v1, 2, 2
    v_add_u32 v2, v2, v3
    v_lshlrev_b32 v2, 7, v2
    v_bfe_u32 v3, v1, 3, 2
    v_lshl_add_u32 v2, v3, 5, v2
    v_and_b32 v3, 3, v1
    v_lshl_add_u32 v2, v3, 3, v2
    v_add_u32 v2, 98304, v2
    v_xor_b32 v148, 0, v2
    v_xor_b32 v149, 32, v2
    v_xor_b32 v150, 64, v2
    v_xor_b32 v151, 96, v2
    v_mov_b32 v8, 0
    v_mov_b32 v9, 0
    v_mov_b32 v10, 0
    v_mov_b32 v11, 0
    v_mov_b32 v12, 0
    v_mov_b32 v13, 0
    v_mov_b32 v14, 0
    v_mov_b32 v15, 0
    v_mov_b32 v16, 0
    v_mov_b32 v17, 0
    v_mov_b32 v18, 0
    v_mov_b32 v19, 0
    v_mov_b32 v20, 0
    v_mov_b32 v21, 0
    v_mov_b32 v22, 0
    v_mov_b32 v23, 0
    v_mov_b32 v24, 0
    v_mov_b32 v25, 0
    v_mov_b32 v26, 0
    v_mov_b32 v27, 0
    v_mov_b32 v28, 0
    v_mov_b32 v29, 0
    v_mov_b32 v30, 0
    v_mov_b32 v31, 0
    v_mov_b32 v32, 0
    v_mov_b32 v33, 0
    v_mov_b32 v34, 0
    v_mov_b32 v35, 0
    v_mov_b32 v36, 0
    v_mov_b32 v37, 0
    v_mov_b32 v38, 0
    v_mov_b32 v39, 0
    v_mov_b32 v40, 0
    v_mov_b32 v41, 0
    v_mov_b32 v42, 0
    v_mov_b32 v43, 0
    v_mov_b32 v44, 0
    v_mov_b32 v45, 0
    v_mov_b32 v46, 0
    v_mov_b32 v47, 0
    v_mov_b32 v48, 0
    v_mov_b32 v49, 0
    v_mov_b32 v50, 0
    v_mov_b32 v51, 0
    v_mov_b32 v52, 0
    v_mov_b32 v53, 0
    v_mov_b32 v54, 0
    v_mov_b32 v55, 0
    v_mov_b32 v56, 0
    v_mov_b32 v57, 0
    v_mov_b32 v58, 0
    v_mov_b32 v59, 0
    v_mov_b32 v60, 0
    v_mov_b32 v61, 0
    v_mov_b32 v62, 0
    v_mov_b32 v63, 0
    v_mov_b32 v64, 0
    v_mov_b32 v65, 0
    v_mov_b32 v66, 0
    v_mov_b32 v67, 0
    v_mov_b32 v68, 0
    v_mov_b32 v69, 0
    v_mov_b32 v70, 0
    v_mov_b32 v71, 0
    v_mov_b32 v72, 0
    v_mov_b32 v73, 0
    v_mov_b32 v74, 0
    v_mov_b32 v75, 0
    v_mov_b32 v76, 0
    v_mov_b32 v77, 0
    v_mov_b32 v78, 0
    v_mov_b32 v79, 0
    v_mov_b32 v80, 0
    v_mov_b32 v81, 0
    v_mov_b32 v82, 0
    v_mov_b32 v83, 0
    v_mov_b32 v84, 0
    v_mov_b32 v85, 0
    v_mov_b32 v86, 0
    v_mov_b32 v87, 0
    v_mov_b32 v88, 0
    v_mov_b32 v89, 0
    v_mov_b32 v90, 0
    v_mov_b32 v91, 0
    v_mov_b32 v92, 0
    v_mov_b32 v93, 0
    v_mov_b32 v94, 0
    v_mov_b32 v95, 0
    v_mov_b32 v96, 0
    v_mov_b32 v97, 0
    v_mov_b32 v98, 0
    v_mov_b32 v99, 0
    v_mov_b32 v100, 0
    v_mov_b32 v101, 0
    v_mov_b32 v102, 0
    v_mov_b32 v103, 0
    v_mov_b32 v104, 0
    v_mov_b32 v105, 0
    v_mov_b32 v106, 0
    v_mov_b32 v107, 0
    v_mov_b32 v108, 0
    v_mov_b32 v109, 0
    v_mov_b32 v110, 0
    v_mov_b32 v111, 0
    v_mov_b32 v112, 0
    v_mov_b32 v113, 0
    v_mov_b32 v114, 0
    v_mov_b32 v115, 0
    v_mov_b32 v116, 0
    v_mov_b32 v117, 0
    v_mov_b32 v118, 0
    v_mov_b32 v119, 0
    v_mov_b32 v120, 0
    v_mov_b32 v121, 0
    v_mov_b32 v122, 0
    v_mov_b32 v123, 0
    v_mov_b32 v124, 0
    v_mov_b32 v125, 0
    v_mov_b32 v126, 0
    v_mov_b32 v127, 0
    v_mov_b32 v128, 0
    v_mov_b32 v129, 0
    v_mov_b32 v130, 0
    v_mov_b32 v131, 0
    v_mov_b32 v132, 0
    v_mov_b32 v133, 0
    v_mov_b32 v134, 0
    v_mov_b32 v135, 0
    s_mov_b32 s48, 0
    s_lshl_b32 s49, s41, 13
    v_add_u32 v146, s48, v144
    v_add_u32 v147, s48, v145
    v_add_u32 v152, s49, v148
    v_add_u32 v153, s49, v149
    v_add_u32 v154, s49, v150
    v_add_u32 v155, s49, v151
    s_cmp_eq_u32 s36, 0
    s_cbranch_scc0 Lni_4
    s_mov_b32 s56, s32
    s_mov_b32 s57, s33
    s_mov_b32 s58, 256
    s_mov_b32 s59, 0x20000
    s_memrealtime s[60:61]
    s_waitcnt lgkmcnt(0)
    s_or_b32 s43, s60, 1
    v_mov_b32 v2, s43
    v_mov_b32 v3, 0
    v_mov_b32 v4, 0
    s_mov_b64 s[60:61], exec
    s_mov_b64 exec, 1
    buffer_atomic_cmpswap v[2:3], v4, s[56:59], 0 offen sc0 sc1
    s_mov_b64 exec, s[60:61]
Lni_4:
    s_barrier
    ds_read_b128 v[156:159], v146 offset:0
    ds_read_b128 v[160:163], v146 offset:2048
    ds_read_b128 v[164:167], v146 offset:4096
    ds_read_b128 v[168:171], v146 offset:6144
    ds_read_b64_tr_b16 v[188:189], v152 offset:0
    ds_read_b64_tr_b16 v[190:191], v152 offset:512
    ds_read_b64_tr_b16 v[192:193], v153 offset:0
    ds_read_b64_tr_b16 v[194:195], v153 offset:512
    ds_read_b64_tr_b16 v[196:197], v154 offset:0
    ds_read_b64_tr_b16 v[198:199], v154 offset:512
    ds_read_b64_tr_b16 v[200:201], v155 offset:0
    ds_read_b64_tr_b16 v[202:203], v155 offset:512
    s_mov_b32 s50, 0
Lmm_5:
    s_waitcnt lgkmcnt(0)
    v_mfma_f32_16x16x32_bf16 v[8:11], v[188:191], v[156:159], v[8:11]
    ds_read_b128 v[172:175], v146 offset:8192
    v_mfma_f32_16x16x32_bf16 v[12:15], v[192:195], v[156:159], v[12:15]
    ds_read_b128 v[176:179], v146 offset:10240
    v_mfma_f32_16x16x32_bf16 v[16:19], v[156:159], v[196:199], v[16:19]
    ds_read_b128 v[180:183], v146 offset:12288
    v_mfma_f32_16x16x32_bf16 v[20:23], v[156:159], v[200:203], v[20:23]
    ds_read_b128 v[184:187], v146 offset:14336
    v_mfma_f32_16x16x32_bf16 v[24:27], v[188:191], v[160:163], v[24:27]
    v_mfma_f32_16x16x32_bf16 v[28:31], v[192:195], v[160:163], v[28:31]
    v_mfma_f32_16x16x32_bf16 v[32:35], v[160:163], v[196:199], v[32:35]
    v_mfma_f32_16x16x32_bf16 v[36:39], v[160:163], v[200:203], v[36:39]
    v_mfma_f32_16x16x32_bf16 v[40:43], v[188:191], v[164:167], v[40:43]
    v_mfma_f32_16x16x32_bf16 v[44:47], v[192:195], v[164:167], v[44:47]
    v_mfma_f32_16x16x32_bf16 v[48:51], v[164:167], v[196:199], v[48:51]
    v_mfma_f32_16x16x32_bf16 v[52:55], v[164:167], v[200:203], v[52:55]
    v_mfma_f32_16x16x32_bf16 v[56:59], v[188:191], v[168:171], v[56:59]
    v_mfma_f32_16x16x32_bf16 v[60:63], v[192:195], v[168:171], v[60:63]
    v_mfma_f32_16x16x32_bf16 v[64:67], v[168:171], v[196:199], v[64:67]
    v_mfma_f32_16x16x32_bf16 v[68:71], v[168:171], v[200:203], v[68:71]
    s_waitcnt lgkmcnt(0)
    v_mfma_f32_16x16x32_bf16 v[72:75], v[188:191], v[172:175], v[72:75]
    ds_read_b128 v[156:159], v147 offset:0
    v_mfma_f32_16x16x32_bf16 v[76:79], v[192:195], v[172:175], v[76:79]
    ds_read_b128 v[160:163], v147 offset:2048
    v_mfma_f32_16x16x32_bf16 v[80:83], v[172:175], v[196:199], v[80:83]
    ds_read_b128 v[164:167], v147 offset:4096
    v_mfma_f32_16x16x32_bf16 v[84:87], v[172:175], v[200:203], v[84:87]
    ds_read_b128 v[168:171], v147 offset:6144
    v_mfma_f32_16x16x32_bf16 v[88:91], v[188:191], v[176:179], v[88:91]
    ds_read_b64_tr_b16 v[204:205], v152 offset:4096
    v_mfma_f32_16x16x32_bf16 v[92:95], v[192:195], v[176:179], v[92:95]
    ds_read_b64_tr_b16 v[206:207], v152 offset:4608
    v_mfma_f32_16x16x32_bf16 v[96:99], v[176:179], v[196:199], v[96:99]
    ds_read_b64_tr_b16 v[208:209], v153 offset:4096
    v_mfma_f32_16x16x32_bf16 v[100:103], v[176:179], v[200:203], v[100:103]
    ds_read_b64_tr_b16 v[210:211], v153 offset:4608
    v_mfma_f32_16x16x32_bf16 v[104:107], v[188:191], v[180:183], v[104:107]
    ds_read_b64_tr_b16 v[212:213], v154 offset:4096
    v_mfma_f32_16x16x32_bf16 v[108:111], v[192:195], v[180:183], v[108:111]
    ds_read_b64_tr_b16 v[214:215], v154 offset:4608
    v_mfma_f32_16x16x32_bf16 v[112:115], v[180:183], v[196:199], v[112:115]
    ds_read_b64_tr_b16 v[216:217], v155 offset:4096
    v_mfma_f32_16x16x32_bf16 v[116:119], v[180:183], v[200:203], v[116:119]
    ds_read_b64_tr_b16 v[218:219], v155 offset:4608
    v_mfma_f32_16x16x32_bf16 v[120:123], v[188:191], v[184:187], v[120:123]
    v_mfma_f32_16x16x32_bf16 v[124:127], v[192:195], v[184:187], v[124:127]
    v_mfma_f32_16x16x32_bf16 v[128:131], v[184:187], v[196:199], v[128:131]
    v_mfma_f32_16x16x32_bf16 v[132:135], v[184:187], v[200:203], v[132:135]
    s_waitcnt lgkmcnt(0)
    v_mfma_f32_16x16x32_bf16 v[8:11], v[204:207], v[156:159], v[8:11]
    ds_read_b128 v[172:175], v147 offset:8192
    v_mfma_f32_16x16x32_bf16 v[12:15], v[208:211], v[156:159], v[12:15]
    ds_read_b128 v[176:179], v147 offset:10240
    v_mfma_f32_16x16x32_bf16 v[16:19], v[156:159], v[212:215], v[16:19]
    ds_read_b128 v[180:183], v147 offset:12288
    v_mfma_f32_16x16x32_bf16 v[20:23], v[156:159], v[216:219], v[20:23]
    ds_read_b128 v[184:187], v147 offset:14336
    v_mfma_f32_16x16x32_bf16 v[24:27], v[204:207], v[160:163], v[24:27]
    s_add_u32 s48, s48, 32768
    s_cmp_ge_u32 s48, 98304
    s_cselect_b32 s48, 0, s48
    s_add_u32 s49, s49, 24576
    s_and_b32 s49, s49, 0xffff
    v_mfma_f32_16x16x32_bf16 v[28:31], v[208:211], v[160:163], v[28:31]
    v_add_u32 v146, s48, v144
    v_mfma_f32_16x16x32_bf16 v[32:35], v[160:163], v[212:215], v[32:35]
    v_add_u32 v147, s48, v145
    v_mfma_f32_16x16x32_bf16 v[36:39], v[160:163], v[216:219], v[36:39]
    v_add_u32 v152, s49, v148
    v_mfma_f32_16x16x32_bf16 v[40:43], v[204:207], v[164:167], v[40:43]
    v_add_u32 v153, s49, v149
    v_mfma_f32_16x16x32_bf16 v[44:47], v[208:211], v[164:167], v[44:47]
    v_add_u32 v154, s49, v150
    v_mfma_f32_16x16x32_bf16 v[48:51], v[164:167], v[212:215], v[48:51]
    v_add_u32 v155, s49, v151
    v_mfma_f32_16x16x32_bf16 v[52:55], v[164:167], v[216:219], v[52:55]
    v_mfma_f32_16x16x32_bf16 v[56:59], v[204:207], v[168:171], v[56:59]
    v_mfma_f32_16x16x32_bf16 v[60:63], v[208:211], v[168:171], v[60:63]
    v_mfma_f32_16x16x32_bf16 v[64:67], v[168:171], v[212:215], v[64:67]
    v_mfma_f32_16x16x32_bf16 v[68:71], v[168:171], v[216:219], v[68:71]
    s_waitcnt lgkmcnt(0)
    v_mfma_f32_16x16x32_bf16 v[72:75], v[204:207], v[172:175], v[72:75]
    s_barrier
    ds_read_b128 v[156:159], v146 offset:0
    v_mfma_f32_16x16x32_bf16 v[76:79], v[208:211], v[172:175], v[76:79]
    ds_read_b128 v[160:163], v146 offset:2048
    v_mfma_f32_16x16x32_bf16 v[80:83], v[172:175], v[212:215], v[80:83]
    ds_read_b128 v[164:167], v146 offset:4096
    v_mfma_f32_16x16x32_bf16 v[84:87], v[172:175], v[216:219], v[84:87]
    ds_read_b128 v[168:171], v146 offset:6144
    v_mfma_f32_16x16x32_bf16 v[88:91], v[204:207], v[176:179], v[88:91]
    ds_read_b64_tr_b16 v[188:189], v152 offset:0
    v_mfma_f32_16x16x32_bf16 v[92:95], v[208:211], v[176:179], v[92:95]
    ds_read_b64_tr_b16 v[190:191], v152 offset:512
    v_mfma_f32_16x16x32_bf16 v[96:99], v[176:179], v[212:215], v[96:99]
    ds_read_b64_tr_b16 v[192:193], v153 offset:0
    v_mfma_f32_16x16x32_bf16 v[100:103], v[176:179], v[216:219], v[100:103]
    ds_read_b64_tr_b16 v[194:195], v153 offset:512
    v_mfma_f32_16x16x32_bf16 v[104:107], v[204:207], v[180:183], v[104:107]
    ds_read_b64_tr_b16 v[196:197], v154 offset:0
    v_mfma_f32_16x16x32_bf16 v[108:111], v[208:211], v[180:183], v[108:111]
    ds_read_b64_tr_b16 v[198:199], v154 offset:512
    v_mfma_f32_16x16x32_bf16 v[112:115], v[180:183], v[212:215], v[112:115]
    ds_read_b64_tr_b16 v[200:201], v155 offset:0
    v_mfma_f32_16x16x32_bf16 v[116:119], v[180:183], v[216:219], v[116:119]
    ds_read_b64_tr_b16 v[202:203], v155 offset:512
    v_mfma_f32_16x16x32_bf16 v[120:123], v[204:207], v[184:187], v[120:123]
    v_mfma_f32_16x16x32_bf16 v[124:127], v[208:211], v[184:187], v[124:127]
    v_mfma_f32_16x16x32_bf16 v[128:131], v[184:187], v[212:215], v[128:131]
    v_mfma_f32_16x16x32_bf16 v[132:135], v[184:187], v[216:219], v[132:135]
    s_add_u32 s50, s50, 1
    s_cmp_lt_u32 s50, 16
    s_cbranch_scc1 Lmm_5
    s_waitcnt lgkmcnt(0)
    s_cmp_eq_u32 s36, 0
    s_cbranch_scc0 Lnf_6
    s_waitcnt vmcnt(0)
    v_readfirstlane_b32 s54, v2
    s_nop 0
    s_cmp_eq_u32 s54, 0
    s_cselect_b32 s43, s43, s54
    v_mov_b32 v3, 153616
    v_mov_b32 v2, s43
    ds_write_b32 v3, v2
    s_waitcnt lgkmcnt(0)
Lnf_6:
    s_setprio 3
    v_and_b32 v2, 15, v1
    v_lshrrev_b32 v3, 4, v1
    v_lshlrev_b32 v3, 2, v3
    v_sub_u32 v2, v2, v3
    v_mov_b32 v4, 0x3f80
    v_mov_b32 v5, 0x3f800000
    v_cmp_eq_u32 vcc, 0, v2
    v_cmp_eq_u32 s[44:45], 1, v2
    s_nop 0
    v_cndmask_b32 v192, 0, v4, vcc
    v_cndmask_b32 v192, v192, v5, s[44:45]
    v_cmp_eq_u32 vcc, 2, v2
    v_cmp_eq_u32 s[44:45], 3, v2
    s_nop 0
    v_cndmask_b32 v193, 0, v4, vcc
    v_cndmask_b32 v193, v193, v5, s[44:45]
    v_mov_b32 v198, v192
    v_mov_b32 v194, 0
    v_mov_b32 v196, 0
    v_mov_b32 v199, v193
    v_mov_b32 v195, 0
    v_mov_b32 v197, 0
    v_mov_b32 v200, 0x3f803f80
    v_mov_b32 v201, 0x3f803f80
    v_mov_b32 v202, 0x3f803f80
    v_mov_b32 v203, 0x3f803f80
    v_cvt_pk_bf16_f32 v8, v8, v9
    v_cvt_pk_bf16_f32 v24, v24, v25
    v_cvt_pk_bf16_f32 v9, v10, v11
    v_cvt_pk_bf16_f32 v25, v26, v27
    v_cvt_pk_bf16_f32 v10, v12, v13
    v_cvt_pk_bf16_f32 v26, v28, v29
    v_cvt_pk_bf16_f32 v11, v14, v15
    v_cvt_pk_bf16_f32 v27, v30, v31
    s_nop 0
    v_mfma_f32_16x16x32_bf16 v[12:15], v[136:139], v[8:11], 0
    v_mfma_f32_16x16x32_bf16 v[28:31], v[136:139], v[24:27], 0
    v_mfma_f32_16x16x32_bf16 v[144:147], v[140:143], v[8:11], 0
    v_mfma_f32_16x16x32_bf16 v[168:171], v[140:143], v[24:27], 0
    s_nop 4
    v_cvt_pk_bf16_f32 v148, v12, v13
    v_cvt_pk_bf16_f32 v172, v28, v29
    v_cvt_pk_bf16_f32 v149, v14, v15
    v_cvt_pk_bf16_f32 v173, v30, v31
    v_cvt_pk_bf16_f32 v150, v144, v145
    v_cvt_pk_bf16_f32 v174, v168, v169
    v_cvt_pk_bf16_f32 v151, v146, v147
    v_cvt_pk_bf16_f32 v175, v170, v171
    v_lshlrev_b32 v12, 16, v148
    v_lshlrev_b32 v28, 16, v172
    v_and_b32 v13, 0xffff0000, v148
    v_and_b32 v29, 0xffff0000, v172
    v_lshlrev_b32 v14, 16, v149
    v_lshlrev_b32 v30, 16, v173
    v_and_b32 v15, 0xffff0000, v149
    v_and_b32 v31, 0xffff0000, v173
    v_lshlrev_b32 v144, 16, v150
    v_lshlrev_b32 v168, 16, v174
    v_and_b32 v145, 0xffff0000, v150
    v_and_b32 v169, 0xffff0000, v174
    v_lshlrev_b32 v146, 16, v151
    v_lshlrev_b32 v170, 16, v175
    v_and_b32 v147, 0xffff0000, v151
    v_and_b32 v171, 0xffff0000, v175
    v_max3_f32 v164, v12, v13, v14
    v_max3_f32 v188, v28, v29, v30
    v_max3_f32 v166, -v12, -v13, -v14
    v_max3_f32 v190, -v28, -v29, -v30
    v_max3_f32 v165, v15, v144, v145
    v_max3_f32 v189, v31, v168, v169
    v_max3_f32 v167, -v15, -v144, -v145
    v_max3_f32 v191, -v31, -v168, -v169
    v_max3_f32 v164, v164, v146, v147
    v_max3_f32 v188, v188, v170, v171
    v_max3_f32 v166, v166, -v146, -v147
    v_max3_f32 v190, v190, -v170, -v171
    v_max_f32 v164, v164, v165
    v_max_f32 v188, v188, v189
    v_max_f32 v166, v166, v167
    v_max_f32 v190, v190, v191
    s_nop 0
    v_permlane32_swap_b32 v164, v166
    v_permlane32_swap_b32 v188, v190
    v_max_f32 v164, v164, v166
    v_max_f32 v188, v188, v190
    v_mov_b32 v166, v164
    v_mov_b32 v190, v188
    s_nop 0
    v_permlane16_swap_b32 v164, v166
    v_permlane16_swap_b32 v188, v190
    v_max_f32 v164, v164, v166
    v_max_f32 v188, v188, v190
    v_mov_b32 v166, v164
    v_mov_b32 v190, v188
    s_nop 0
    v_permlane32_swap_b32 v164, v166
    v_permlane32_swap_b32 v188, v190
    v_mul_f32 v164, s52, v164
    v_mul_f32 v188, s52, v188
    v_mul_f32 v166, s52, v166
    v_mul_f32 v190, s52, v190
    v_pk_fma_f32 v[148:149], v[12:13], s[52:53], v[164:165] op_sel_hi:[1,1,0] neg_lo:[0,0,1] neg_hi:[0,0,1]
    v_pk_fma_f32 v[172:173], v[28:29], s[52:53], v[188:189] op_sel_hi:[1,1,0] neg_lo:[0,0,1] neg_hi:[0,0,1]
    v_pk_fma_f32 v[156:157], v[12:13], s[52:53], v[166:167] op_sel_hi:[1,1,0] neg_lo:[1,0,1] neg_hi:[1,0,1]
    v_pk_fma_f32 v[180:181], v[28:29], s[52:53], v[190:191] op_sel_hi:[1,1,0] neg_lo:[1,0,1] neg_hi:[1,0,1]
    v_pk_fma_f32 v[150:151], v[14:15], s[52:53], v[164:165] op_sel_hi:[1,1,0] neg_lo:[0,0,1] neg_hi:[0,0,1]
    v_pk_fma_f32 v[174:175], v[30:31], s[52:53], v[188:189] op_sel_hi:[1,1,0] neg_lo:[0,0,1] neg_hi:[0,0,1]
    v_pk_fma_f32 v[158:159], v[14:15], s[52:53], v[166:167] op_sel_hi:[1,1,0] neg_lo:[1,0,1] neg_hi:[1,0,1]
    v_pk_fma_f32 v[182:183], v[30:31], s[52:53], v[190:191] op_sel_hi:[1,1,0] neg_lo:[1,0,1] neg_hi:[1,0,1]
    v_pk_fma_f32 v[152:153], v[144:145], s[52:53], v[164:165] op_sel_hi:[1,1,0] neg_lo:[0,0,1] neg_hi:[0,0,1]
    v_pk_fma_f32 v[176:177], v[168:169], s[52:53], v[188:189] op_sel_hi:[1,1,0] neg_lo:[0,0,1] neg_hi:[0,0,1]
    v_pk_fma_f32 v[160:161], v[144:145], s[52:53], v[166:167] op_sel_hi:[1,1,0] neg_lo:[1,0,1] neg_hi:[1,0,1]
    v_pk_fma_f32 v[184:185], v[168:169], s[52:53], v[190:191] op_sel_hi:[1,1,0] neg_lo:[1,0,1] neg_hi:[1,0,1]
    v_pk_fma_f32 v[154:155], v[146:147], s[52:53], v[164:165] op_sel_hi:[1,1,0] neg_lo:[0,0,1] neg_hi:[0,0,1]
    v_pk_fma_f32 v[178:179], v[170:171], s[52:53], v[188:189] op_sel_hi:[1,1,0] neg_lo:[0,0,1] neg_hi:[0,0,1]
    v_pk_fma_f32 v[162:163], v[146:147], s[52:53], v[166:167] op_sel_hi:[1,1,0] neg_lo:[1,0,1] neg_hi:[1,0,1]
    v_pk_fma_f32 v[186:187], v[170:171], s[52:53], v[190:191] op_sel_hi:[1,1,0] neg_lo:[1,0,1] neg_hi:[1,0,1]
    v_exp_f32 v148, v148
    v_exp_f32 v172, v172
    v_exp_f32 v156, v156
    v_exp_f32 v180, v180
    v_exp_f32 v149, v149
    v_exp_f32 v173, v173
    v_exp_f32 v157, v157
    v_exp_f32 v181, v181
    v_exp_f32 v150, v150
    v_exp_f32 v174, v174
    v_exp_f32 v158, v158
    v_exp_f32 v182, v182
    v_exp_f32 v151, v151
    v_exp_f32 v175, v175
    v_exp_f32 v159, v159
    v_exp_f32 v183, v183
    v_exp_f32 v152, v152
    v_exp_f32 v176, v176
    v_exp_f32 v160, v160
    v_exp_f32 v184, v184
    v_exp_f32 v153, v153
    v_exp_f32 v177, v177
    v_exp_f32 v161, v161
    v_exp_f32 v185, v185
    v_exp_f32 v154, v154
    v_exp_f32 v178, v178
    v_exp_f32 v162, v162
    v_exp_f32 v186, v186
    v_exp_f32 v155, v155
    v_exp_f32 v179, v179
    v_exp_f32 v163, v163
    v_exp_f32 v187, v187
    v_pk_add_f32 v[144:145], v[148:149], v[150:151]
    v_pk_add_f32 v[168:169], v[172:173], v[174:175]
    v_pk_add_f32 v[146:147], v[152:153], v[154:155]
    v_pk_add_f32 v[170:171], v[176:177], v[178:179]
    v_pk_add_f32 v[12:13], v[156:157], v[158:159]
    v_pk_add_f32 v[28:29], v[180:181], v[182:183]
    v_pk_add_f32 v[14:15], v[160:161], v[162:163]
    v_pk_add_f32 v[30:31], v[184:185], v[186:187]
    v_pk_add_f32 v[144:145], v[144:145], v[146:147]
    v_pk_add_f32 v[168:169], v[168:169], v[170:171]
    v_pk_add_f32 v[12:13], v[12:13], v[14:15]
    v_pk_add_f32 v[28:29], v[28:29], v[30:31]
    v_add_f32 v164, v144, v145
    v_add_f32 v188, v168, v169
    v_add_f32 v166, v12, v13
    v_add_f32 v190, v28, v29
    s_nop 0
    v_permlane32_swap_b32 v164, v166
    v_permlane32_swap_b32 v188, v190
    v_add_f32 v164, v164, v166
    v_add_f32 v188, v188, v190
    v_mov_b32 v166, v164
    v_mov_b32 v190, v188
    s_nop 0
    v_permlane16_swap_b32 v164, v166
    v_permlane16_swap_b32 v188, v190
    v_add_f32 v164, v164, v166
    v_add_f32 v188, v188, v190
    v_mov_b32 v166, v164
    v_mov_b32 v190, v188
    s_nop 0
    v_permlane32_swap_b32 v164, v166
    v_permlane32_swap_b32 v188, v190
    v_rcp_f32 v164, v164
    v_rcp_f32 v188, v188
    v_rcp_f32 v166, v166
    v_rcp_f32 v190, v190
    v_pk_mul_f32 v[148:149], v[148:149], v[164:165] op_sel_hi:[1,0]
    v_pk_mul_f32 v[172:173], v[172:173], v[188:189] op_sel_hi:[1,0]
    v_pk_mul_f32 v[156:157], v[156:157], v[166:167] op_sel_hi:[1,0]
    v_pk_mul_f32 v[180:181], v[180:181], v[190:191] op_sel_hi:[1,0]
    v_pk_mul_f32 v[150:151], v[150:151], v[164:165] op_sel_hi:[1,0]
    v_pk_mul_f32 v[174:175], v[174:175], v[188:189] op_sel_hi:[1,0]
    v_pk_mul_f32 v[158:159], v[158:159], v[166:167] op_sel_hi:[1,0]
    v_pk_mul_f32 v[182:183], v[182:183], v[190:191] op_sel_hi:[1,0]
    v_pk_mul_f32 v[152:153], v[152:153], v[164:165] op_sel_hi:[1,0]
    v_pk_mul_f32 v[176:177], v[176:177], v[188:189] op_sel_hi:[1,0]
    v_pk_mul_f32 v[160:161], v[160:161], v[166:167] op_sel_hi:[1,0]
    v_pk_mul_f32 v[184:185], v[184:185], v[190:191] op_sel_hi:[1,0]
    v_pk_mul_f32 v[154:155], v[154:155], v[164:165] op_sel_hi:[1,0]
    v_pk_mul_f32 v[178:179], v[178:179], v[188:189] op_sel_hi:[1,0]
    v_pk_mul_f32 v[162:163], v[162:163], v[166:167] op_sel_hi:[1,0]
    v_pk_mul_f32 v[186:187], v[186:187], v[190:191] op_sel_hi:[1,0]
    v_cvt_pk_bf16_f32 v8, v148, v149
    v_cvt_pk_bf16_f32 v24, v172, v173
    v_cvt_pk_bf16_f32 v12, v156, v157
    v_cvt_pk_bf16_f32 v28, v180, v181
    v_cvt_pk_bf16_f32 v9, v150, v151
    v_cvt_pk_bf16_f32 v25, v174, v175
    v_cvt_pk_bf16_f32 v13, v158, v159
    v_cvt_pk_bf16_f32 v29, v182, v183
    v_cvt_pk_bf16_f32 v10, v152, v153
    v_cvt_pk_bf16_f32 v26, v176, v177
    v_cvt_pk_bf16_f32 v14, v160, v161
    v_cvt_pk_bf16_f32 v30, v184, v185
    v_cvt_pk_bf16_f32 v11, v154, v155
    v_cvt_pk_bf16_f32 v27, v178, v179
    v_cvt_pk_bf16_f32 v15, v162, v163
    v_cvt_pk_bf16_f32 v31, v186, v187
    v_cvt_pk_bf16_f32 v212, v16, v17
    v_cvt_pk_bf16_f32 v213, v18, v19
    v_cvt_pk_bf16_f32 v214, v32, v33
    v_cvt_pk_bf16_f32 v215, v34, v35
    v_cvt_pk_bf16_f32 v216, v20, v21
    v_cvt_pk_bf16_f32 v217, v22, v23
    v_cvt_pk_bf16_f32 v218, v36, v37
    v_cvt_pk_bf16_f32 v219, v38, v39
    v_mfma_f32_16x16x32_bf16 v[144:147], v[8:11], v[192:195], 0
    v_mfma_f32_16x16x32_bf16 v[168:171], v[24:27], v[192:195], 0
    v_mfma_f32_16x16x32_bf16 v[148:151], v[8:11], v[196:199], 0
    v_mfma_f32_16x16x32_bf16 v[172:175], v[24:27], v[196:199], 0
    v_mfma_f32_16x16x32_bf16 v[152:155], v[12:15], v[192:195], 0
    v_mfma_f32_16x16x32_bf16 v[176:179], v[28:31], v[192:195], 0
    v_mfma_f32_16x16x32_bf16 v[156:159], v[12:15], v[196:199], 0
    v_mfma_f32_16x16x32_bf16 v[180:183], v[28:31], v[196:199], 0
    s_nop 0
    v_cvt_pk_bf16_f32 v204, v144, v145
    v_cvt_pk_bf16_f32 v205, v146, v147
    v_cvt_pk_bf16_f32 v206, v168, v169
    v_cvt_pk_bf16_f32 v207, v170, v171
    s_nop 1
    v_mfma_f32_16x16x32_bf16 v[16:19], v[204:207], v[212:215], 0
    v_mfma_f32_16x16x32_bf16 v[20:23], v[204:207], v[216:219], 0
    v_mfma_f32_16x16x32_bf16 v[32:35], v[204:207], v[200:203], 0
    v_cvt_pk_bf16_f32 v208, v148, v149
    v_cvt_pk_bf16_f32 v209, v150, v151
    v_cvt_pk_bf16_f32 v210, v172, v173
    v_cvt_pk_bf16_f32 v211, v174, v175
    s_nop 1
    v_mfma_f32_16x16x32_bf16 v[36:39], v[208:211], v[212:215], 0
    v_mfma_f32_16x16x32_bf16 v[220:223], v[208:211], v[216:219], 0
    v_mfma_f32_16x16x32_bf16 v[224:227], v[208:211], v[200:203], 0
    v_cvt_pk_bf16_f32 v204, v152, v153
    v_cvt_pk_bf16_f32 v205, v154, v155
    v_cvt_pk_bf16_f32 v206, v176, v177
    v_cvt_pk_bf16_f32 v207, v178, v179
    s_nop 1
    v_mfma_f32_16x16x32_bf16 v[228:231], v[204:207], v[212:215], 0
    v_mfma_f32_16x16x32_bf16 v[232:235], v[204:207], v[216:219], 0
    v_mfma_f32_16x16x32_bf16 v[8:11], v[204:207], v[200:203], 0
    v_cvt_pk_bf16_f32 v208, v156, v157
    v_cvt_pk_bf16_f32 v209, v158, v159
    v_cvt_pk_bf16_f32 v210, v180, v181
    v_cvt_pk_bf16_f32 v211, v182, v183
    s_nop 1
    v_mfma_f32_16x16x32_bf16 v[12:15], v[208:211], v[212:215], 0
    v_mfma_f32_16x16x32_bf16 v[24:27], v[208:211], v[216:219], 0
    v_mfma_f32_16x16x32_bf16 v[28:31], v[208:211], v[200:203], 0
    v_cvt_pk_bf16_f32 v40, v40, v41
    v_cvt_pk_bf16_f32 v56, v56, v57
    v_cvt_pk_bf16_f32 v41, v42, v43
    v_cvt_pk_bf16_f32 v57, v58, v59
    v_cvt_pk_bf16_f32 v42, v44, v45
    v_cvt_pk_bf16_f32 v58, v60, v61
    v_cvt_pk_bf16_f32 v43, v46, v47
    v_cvt_pk_bf16_f32 v59, v62, v63
    s_nop 0
    v_mfma_f32_16x16x32_bf16 v[44:47], v[136:139], v[40:43], 0
    v_mfma_f32_16x16x32_bf16 v[60:63], v[136:139], v[56:59], 0
    v_mfma_f32_16x16x32_bf16 v[144:147], v[140:143], v[40:43], 0
    v_mfma_f32_16x16x32_bf16 v[168:171], v[140:143], v[56:59], 0
    s_nop 4
    v_cvt_pk_bf16_f32 v148, v44, v45
    v_cvt_pk_bf16_f32 v172, v60, v61
    v_cvt_pk_bf16_f32 v149, v46, v47
    v_cvt_pk_bf16_f32 v173, v62, v63
    v_cvt_pk_bf16_f32 v150, v144, v145
    v_cvt_pk_bf16_f32 v174, v168, v169
    v_cvt_pk_bf16_f32 v151, v146, v147
    v_cvt_pk_bf16_f32 v175, v170, v171
    v_lshlrev_b32 v44, 16, v148
    v_lshlrev_b32 v60, 16, v172
    v_and_b32 v45, 0xffff0000, v148
    v_and_b32 v61, 0xffff0000, v172
    v_lshlrev_b32 v46, 16, v149
    v_lshlrev_b32 v62, 16, v173
    v_and_b32 v47, 0xffff0000, v149
    v_and_b32 v63, 0xffff0000, v173
    v_lshlrev_b32 v144, 16, v150
    v_lshlrev_b32 v168, 16, v174
    v_and_b32 v145, 0xffff0000, v150
    v_and_b32 v169, 0xffff0000, v174
    v_lshlrev_b32 v146, 16, v151
    v_lshlrev_b32 v170, 16, v175
    v_and_b32 v147, 0xffff0000, v151
    v_and_b32 v171, 0xffff0000, v175
    v_max3_f32 v164, v44, v45, v46
    v_max3_f32 v188, v60, v61, v62
    v_max3_f32 v166, -v44, -v45, -v46
    v_max3_f32 v190, -v60, -v61, -v62
    v_max3_f32 v165, v47, v144, v145
    v_max3_f32 v189, v63, v168, v169
    v_max3_f32 v167, -v47, -v144, -v145
    v_max3_f32 v191, -v63, -v168, -v169
    v_max3_f32 v164, v164, v146, v147
    v_max3_f32 v188, v188, v170, v171
    v_max3_f32 v166, v166, -v146, -v147
    v_max3_f32 v190, v190, -v170, -v171
    v_max_f32 v164, v164, v165
    v_max_f32 v188, v188, v189
    v_max_f32 v166, v166, v167
    v_max_f32 v190, v190, v191
    s_nop 0
    v_permlane32_swap_b32 v164, v166
    v_permlane32_swap_b32 v188, v190
    v_max_f32 v164, v164, v166
    v_max_f32 v188, v188, v190
    v_mov_b32 v166, v164
    v_mov_b32 v190, v188
    s_nop 0
    v_permlane16_swap_b32 v164, v166
    v_permlane16_swap_b32 v188, v190
    v_max_f32 v164, v164, v166
    v_max_f32 v188, v188, v190
    v_mov_b32 v166, v164
    v_mov_b32 v190, v188
    s_nop 0
    v_permlane32_swap_b32 v164, v166
    v_permlane32_swap_b32 v188, v190
    v_mul_f32 v164, s52, v164
    v_mul_f32 v188, s52, v188
    v_mul_f32 v166, s52, v166
    v_mul_f32 v190, s52, v190
    v_pk_fma_f32 v[148:149], v[44:45], s[52:53], v[164:165] op_sel_hi:[1,1,0] neg_lo:[0,0,1] neg_hi:[0,0,1]
    v_pk_fma_f32 v[172:173], v[60:61], s[52:53], v[188:189] op_sel_hi:[1,1,0] neg_lo:[0,0,1] neg_hi:[0,0,1]
    v_pk_fma_f32 v[156:157], v[44:45], s[52:53], v[166:167] op_sel_hi:[1,1,0] neg_lo:[1,0,1] neg_hi:[1,0,1]
    v_pk_fma_f32 v[180:181], v[60:61], s[52:53], v[190:191] op_sel_hi:[1,1,0] neg_lo:[1,0,1] neg_hi:[1,0,1]
    v_pk_fma_f32 v[150:151], v[46:47], s[52:53], v[164:165] op_sel_hi:[1,1,0] neg_lo:[0,0,1] neg_hi:[0,0,1]
    v_pk_fma_f32 v[174:175], v[62:63], s[52:53], v[188:189] op_sel_hi:[1,1,0] neg_lo:[0,0,1] neg_hi:[0,0,1]
    v_pk_fma_f32 v[158:159], v[46:47], s[52:53], v[166:167] op_sel_hi:[1,1,0] neg_lo:[1,0,1] neg_hi:[1,0,1]
    v_pk_fma_f32 v[182:183], v[62:63], s[52:53], v[190:191] op_sel_hi:[1,1,0] neg_lo:[1,0,1] neg_hi:[1,0,1]
    v_pk_fma_f32 v[152:153], v[144:145], s[52:53], v[164:165] op_sel_hi:[1,1,0] neg_lo:[0,0,1] neg_hi:[0,0,1]
    v_pk_fma_f32 v[176:177], v[168:169], s[52:53], v[188:189] op_sel_hi:[1,1,0] neg_lo:[0,0,1] neg_hi:[0,0,1]
    v_pk_fma_f32 v[160:161], v[144:145], s[52:53], v[166:167] op_sel_hi:[1,1,0] neg_lo:[1,0,1] neg_hi:[1,0,1]
    v_pk_fma_f32 v[184:185], v[168:169], s[52:53], v[190:191] op_sel_hi:[1,1,0] neg_lo:[1,0,1] neg_hi:[1,0,1]
    v_pk_fma_f32 v[154:155], v[146:147], s[52:53], v[164:165] op_sel_hi:[1,1,0] neg_lo:[0,0,1] neg_hi:[0,0,1]
    v_pk_fma_f32 v[178:179], v[170:171], s[52:53], v[188:189] op_sel_hi:[1,1,0] neg_lo:[0,0,1] neg_hi:[0,0,1]
    v_pk_fma_f32 v[162:163], v[146:147], s[52:53], v[166:167] op_sel_hi:[1,1,0] neg_lo:[1,0,1] neg_hi:[1,0,1]
    v_pk_fma_f32 v[186:187], v[170:171], s[52:53], v[190:191] op_sel_hi:[1,1,0] neg_lo:[1,0,1] neg_hi:[1,0,1]
    v_exp_f32 v148, v148
    v_exp_f32 v172, v172
    v_exp_f32 v156, v156
    v_exp_f32 v180, v180
    v_exp_f32 v149, v149
    v_exp_f32 v173, v173
    v_exp_f32 v157, v157
    v_exp_f32 v181, v181
    v_exp_f32 v150, v150
    v_exp_f32 v174, v174
    v_exp_f32 v158, v158
    v_exp_f32 v182, v182
    v_exp_f32 v151, v151
    v_exp_f32 v175, v175
    v_exp_f32 v159, v159
    v_exp_f32 v183, v183
    v_exp_f32 v152, v152
    v_exp_f32 v176, v176
    v_exp_f32 v160, v160
    v_exp_f32 v184, v184
    v_exp_f32 v153, v153
    v_exp_f32 v177, v177
    v_exp_f32 v161, v161
    v_exp_f32 v185, v185
    v_exp_f32 v154, v154
    v_exp_f32 v178, v178
    v_exp_f32 v162, v162
    v_exp_f32 v186, v186
    v_exp_f32 v155, v155
    v_exp_f32 v179, v179
    v_exp_f32 v163, v163
    v_exp_f32 v187, v187
    v_pk_add_f32 v[144:145], v[148:149], v[150:151]
    v_pk_add_f32 v[168:169], v[172:173], v[174:175]
    v_pk_add_f32 v[146:147], v[152:153], v[154:155]
    v_pk_add_f32 v[170:171], v[176:177], v[178:179]
    v_pk_add_f32 v[44:45], v[156:157], v[158:159]
    v_pk_add_f32 v[60:61], v[180:181], v[182:183]
    v_pk_add_f32 v[46:47], v[160:161], v[162:163]
    v_pk_add_f32 v[62:63], v[184:185], v[186:187]
    v_pk_add_f32 v[144:145], v[144:145], v[146:147]
    v_pk_add_f32 v[168:169], v[168:169], v[170:171]
    v_pk_add_f32 v[44:45], v[44:45], v[46:47]
    v_pk_add_f32 v[60:61], v[60:61], v[62:63]
    v_add_f32 v164, v144, v145
    v_add_f32 v188, v168, v169
    v_add_f32 v166, v44, v45
    v_add_f32 v190, v60, v61
    s_nop 0
    v_permlane32_swap_b32 v164, v166
    v_permlane32_swap_b32 v188, v190
    v_add_f32 v164, v164, v166
    v_add_f32 v188, v188, v190
    v_mov_b32 v166, v164
    v_mov_b32 v190, v188
    s_nop 0
    v_permlane16_swap_b32 v164, v166
    v_permlane16_swap_b32 v188, v190
    v_add_f32 v164, v164, v166
    v_add_f32 v188, v188, v190
    v_mov_b32 v166, v164
    v_mov_b32 v190, v188
    s_nop 0
    v_permlane32_swap_b32 v164, v166
    v_permlane32_swap_b32 v188, v190
    v_rcp_f32 v164, v164
    v_rcp_f32 v188, v188
    v_rcp_f32 v166, v166
    v_rcp_f32 v190, v190
    v_pk_mul_f32 v[148:149], v[148:149], v[164:165] op_sel_hi:[1,0]
    v_pk_mul_f32 v[172:173], v[172:173], v[188:189] op_sel_hi:[1,0]
    v_pk_mul_f32 v[156:157], v[156:157], v[166:167] op_sel_hi:[1,0]
    v_pk_mul_f32 v[180:181], v[180:181], v[190:191] op_sel_hi:[1,0]
    v_pk_mul_f32 v[150:151], v[150:151], v[164:165] op_sel_hi:[1,0]
    v_pk_mul_f32 v[174:175], v[174:175], v[188:189] op_sel_hi:[1,0]
    v_pk_mul_f32 v[158:159], v[158:159], v[166:167] op_sel_hi:[1,0]
    v_pk_mul_f32 v[182:183], v[182:183], v[190:191] op_sel_hi:[1,0]
    v_pk_mul_f32 v[152:153], v[152:153], v[164:165] op_sel_hi:[1,0]
    v_pk_mul_f32 v[176:177], v[176:177], v[188:189] op_sel_hi:[1,0]
    v_pk_mul_f32 v[160:161], v[160:161], v[166:167] op_sel_hi:[1,0]
    v_pk_mul_f32 v[184:185], v[184:185], v[190:191] op_sel_hi:[1,0]
    v_pk_mul_f32 v[154:155], v[154:155], v[164:165] op_sel_hi:[1,0]
    v_pk_mul_f32 v[178:179], v[178:179], v[188:189] op_sel_hi:[1,0]
    v_pk_mul_f32 v[162:163], v[162:163], v[166:167] op_sel_hi:[1,0]
    v_pk_mul_f32 v[186:187], v[186:187], v[190:191] op_sel_hi:[1,0]
    v_cvt_pk_bf16_f32 v40, v148, v149
    v_cvt_pk_bf16_f32 v56, v172, v173
    v_cvt_pk_bf16_f32 v44, v156, v157
    v_cvt_pk_bf16_f32 v60, v180, v181
    v_cvt_pk_bf16_f32 v41, v150, v151
    v_cvt_pk_bf16_f32 v57, v174, v175
    v_cvt_pk_bf16_f32 v45, v158, v159
    v_cvt_pk_bf16_f32 v61, v182, v183
    v_cvt_pk_bf16_f32 v42, v152, v153
    v_cvt_pk_bf16_f32 v58, v176, v177
    v_cvt_pk_bf16_f32 v46, v160, v161
    v_cvt_pk_bf16_f32 v62, v184, v185
    v_cvt_pk_bf16_f32 v43, v154, v155
    v_cvt_pk_bf16_f32 v59, v178, v179
    v_cvt_pk_bf16_f32 v47, v162, v163
    v_cvt_pk_bf16_f32 v63, v186, v187
    v_cvt_pk_bf16_f32 v212, v48, v49
    v_cvt_pk_bf16_f32 v213, v50, v51
    v_cvt_pk_bf16_f32 v214, v64, v65
    v_cvt_pk_bf16_f32 v215, v66, v67
    v_cvt_pk_bf16_f32 v216, v52, v53
    v_cvt_pk_bf16_f32 v217, v54, v55
    v_cvt_pk_bf16_f32 v218, v68, v69
    v_cvt_pk_bf16_f32 v219, v70, v71
    v_mfma_f32_16x16x32_bf16 v[144:147], v[40:43], v[192:195], 0
    v_mfma_f32_16x16x32_bf16 v[168:171], v[56:59], v[192:195], 0
    v_mfma_f32_16x16x32_bf16 v[148:151], v[40:43], v[196:199], 0
    v_mfma_f32_16x16x32_bf16 v[172:175], v[56:59], v[196:199], 0
    v_mfma_f32_16x16x32_bf16 v[152:155], v[44:47], v[192:195], 0
    v_mfma_f32_16x16x32_bf16 v[176:179], v[60:63], v[192:195], 0
    v_mfma_f32_16x16x32_bf16 v[156:159], v[44:47], v[196:199], 0
    v_mfma_f32_16x16x32_bf16 v[180:183], v[60:63], v[196:199], 0
    s_nop 0
    v_cvt_pk_bf16_f32 v204, v144, v145
    v_cvt_pk_bf16_f32 v205, v146, v147
    v_cvt_pk_bf16_f32 v206, v168, v169
    v_cvt_pk_bf16_f32 v207, v170, v171
    s_nop 1
    v_mfma_f32_16x16x32_bf16 v[16:19], v[204:207], v[212:215], v[16:19]
    v_mfma_f32_16x16x32_bf16 v[20:23], v[204:207], v[216:219], v[20:23]
    v_mfma_f32_16x16x32_bf16 v[32:35], v[204:207], v[200:203], v[32:35]
    v_cvt_pk_bf16_f32 v208, v148, v149
    v_cvt_pk_bf16_f32 v209, v150, v151
    v_cvt_pk_bf16_f32 v210, v172, v173
    v_cvt_pk_bf16_f32 v211, v174, v175
    s_nop 1
    v_mfma_f32_16x16x32_bf16 v[36:39], v[208:211], v[212:215], v[36:39]
    v_mfma_f32_16x16x32_bf16 v[220:223], v[208:211], v[216:219], v[220:223]
    v_mfma_f32_16x16x32_bf16 v[224:227], v[208:211], v[200:203], v[224:227]
    v_cvt_pk_bf16_f32 v204, v152, v153
    v_cvt_pk_bf16_f32 v205, v154, v155
    v_cvt_pk_bf16_f32 v206, v176, v177
    v_cvt_pk_bf16_f32 v207, v178, v179
    s_nop 1
    v_mfma_f32_16x16x32_bf16 v[228:231], v[204:207], v[212:215], v[228:231]
    v_mfma_f32_16x16x32_bf16 v[232:235], v[204:207], v[216:219], v[232:235]
    v_mfma_f32_16x16x32_bf16 v[8:11], v[204:207], v[200:203], v[8:11]
    v_cvt_pk_bf16_f32 v208, v156, v157
    v_cvt_pk_bf16_f32 v209, v158, v159
    v_cvt_pk_bf16_f32 v210, v180, v181
    v_cvt_pk_bf16_f32 v211, v182, v183
    s_nop 1
    v_mfma_f32_16x16x32_bf16 v[12:15], v[208:211], v[212:215], v[12:15]
    v_mfma_f32_16x16x32_bf16 v[24:27], v[208:211], v[216:219], v[24:27]
    v_mfma_f32_16x16x32_bf16 v[28:31], v[208:211], v[200:203], v[28:31]
    v_cvt_pk_bf16_f32 v72, v72, v73
    v_cvt_pk_bf16_f32 v88, v88, v89
    v_cvt_pk_bf16_f32 v73, v74, v75
    v_cvt_pk_bf16_f32 v89, v90, v91
    v_cvt_pk_bf16_f32 v74, v76, v77
    v_cvt_pk_bf16_f32 v90, v92, v93
    v_cvt_pk_bf16_f32 v75, v78, v79
    v_cvt_pk_bf16_f32 v91, v94, v95
    s_nop 0
    v_mfma_f32_16x16x32_bf16 v[76:79], v[136:139], v[72:75], 0
    v_mfma_f32_16x16x32_bf16 v[92:95], v[136:139], v[88:91], 0
    v_mfma_f32_16x16x32_bf16 v[144:147], v[140:143], v[72:75], 0
    v_mfma_f32_16x16x32_bf16 v[168:171], v[140:143], v[88:91], 0
    s_nop 4
    v_cvt_pk_bf16_f32 v148, v76, v77
    v_cvt_pk_bf16_f32 v172, v92, v93
    v_cvt_pk_bf16_f32 v149, v78, v79
    v_cvt_pk_bf16_f32 v173, v94, v95
    v_cvt_pk_bf16_f32 v150, v144, v145
    v_cvt_pk_bf16_f32 v174, v168, v169
    v_cvt_pk_bf16_f32 v151, v146, v147
    v_cvt_pk_bf16_f32 v175, v170, v171
    v_lshlrev_b32 v76, 16, v148
    v_lshlrev_b32 v92, 16, v172
    v_and_b32 v77, 0xffff0000, v148
    v_and_b32 v93, 0xffff0000, v172
    v_lshlrev_b32 v78, 16, v149
    v_lshlrev_b32 v94, 16, v173
    v_and_b32 v79, 0xffff0000, v149
    v_and_b32 v95, 0xffff0000, v173
    v_lshlrev_b32 v144, 16, v150
    v_lshlrev_b32 v168, 16, v174
    v_and_b32 v145, 0xffff0000, v150
    v_and_b32 v169, 0xffff0000, v174
    v_lshlrev_b32 v146, 16, v151
    v_lshlrev_b32 v170, 16, v175
    v_and_b32 v147, 0xffff0000, v151
    v_and_b32 v171, 0xffff0000, v175
    v_max3_f32 v164, v76, v77, v78
    v_max3_f32 v188, v92, v93, v94
    v_max3_f32 v166, -v76, -v77, -v78
    v_max3_f32 v190, -v92, -v93, -v94
    v_max3_f32 v165, v79, v144, v145
    v_max3_f32 v189, v95, v168, v169
    v_max3_f32 v167, -v79, -v144, -v145
    v_max3_f32 v191, -v95, -v168, -v169
    v_max3_f32 v164, v164, v146, v147
    v_max3_f32 v188, v188, v170, v171
    v_max3_f32 v166, v166, -v146, -v147
    v_max3_f32 v190, v190, -v170, -v171
    v_max_f32 v164, v164, v165
    v_max_f32 v188, v188, v189
    v_max_f32 v166, v166, v167
    v_max_f32 v190, v190, v191
    s_nop 0
    v_permlane32_swap_b32 v164, v166
    v_permlane32_swap_b32 v188, v190
    v_max_f32 v164, v164, v166
    v_max_f32 v188, v188, v190
    v_mov_b32 v166, v164
    v_mov_b32 v190, v188
    s_nop 0
    v_permlane16_swap_b32 v164, v166
    v_permlane16_swap_b32 v188, v190
    v_max_f32 v164, v164, v166
    v_max_f32 v188, v188, v190
    v_mov_b32 v166, v164
    v_mov_b32 v190, v188
    s_nop 0
    v_permlane32_swap_b32 v164, v166
    v_permlane32_swap_b32 v188, v190
    v_mul_f32 v164, s52, v164
    v_mul_f32 v188, s52, v188
    v_mul_f32 v166, s52, v166
    v_mul_f32 v190, s52, v190
    v_pk_fma_f32 v[148:149], v[76:77], s[52:53], v[164:165] op_sel_hi:[1,1,0] neg_lo:[0,0,1] neg_hi:[0,0,1]
    v_pk_fma_f32 v[172:173], v[92:93], s[52:53], v[188:189] op_sel_hi:[1,1,0] neg_lo:[0,0,1] neg_hi:[0,0,1]
    v_pk_fma_f32 v[156:157], v[76:77], s[52:53], v[166:167] op_sel_hi:[1,1,0] neg_lo:[1,0,1] neg_hi:[1,0,1]
    v_pk_fma_f32 v[180:181], v[92:93], s[52:53], v[190:191] op_sel_hi:[1,1,0] neg_lo:[1,0,1] neg_hi:[1,0,1]
    v_pk_fma_f32 v[150:151], v[78:79], s[52:53], v[164:165] op_sel_hi:[1,1,0] neg_lo:[0,0,1] neg_hi:[0,0,1]
    v_pk_fma_f32 v[174:175], v[94:95], s[52:53], v[188:189] op_sel_hi:[1,1,0] neg_lo:[0,0,1] neg_hi:[0,0,1]
    v_pk_fma_f32 v[158:159], v[78:79], s[52:53], v[166:167] op_sel_hi:[1,1,0] neg_lo:[1,0,1] neg_hi:[1,0,1]
    v_pk_fma_f32 v[182:183], v[94:95], s[52:53], v[190:191] op_sel_hi:[1,1,0] neg_lo:[1,0,1] neg_hi:[1,0,1]
    v_pk_fma_f32 v[152:153], v[144:145], s[52:53], v[164:165] op_sel_hi:[1,1,0] neg_lo:[0,0,1] neg_hi:[0,0,1]
    v_pk_fma_f32 v[176:177], v[168:169], s[52:53], v[188:189] op_sel_hi:[1,1,0] neg_lo:[0,0,1] neg_hi:[0,0,1]
    v_pk_fma_f32 v[160:161], v[144:145], s[52:53], v[166:167] op_sel_hi:[1,1,0] neg_lo:[1,0,1] neg_hi:[1,0,1]
    v_pk_fma_f32 v[184:185], v[168:169], s[52:53], v[190:191] op_sel_hi:[1,1,0] neg_lo:[1,0,1] neg_hi:[1,0,1]
    v_pk_fma_f32 v[154:155], v[146:147], s[52:53], v[164:165] op_sel_hi:[1,1,0] neg_lo:[0,0,1] neg_hi:[0,0,1]
    v_pk_fma_f32 v[178:179], v[170:171], s[52:53], v[188:189] op_sel_hi:[1,1,0] neg_lo:[0,0,1] neg_hi:[0,0,1]
    v_pk_fma_f32 v[162:163], v[146:147], s[52:53], v[166:167] op_sel_hi:[1,1,0] neg_lo:[1,0,1] neg_hi:[1,0,1]
    v_pk_fma_f32 v[186:187], v[170:171], s[52:53], v[190:191] op_sel_hi:[1,1,0] neg_lo:[1,0,1] neg_hi:[1,0,1]
    v_exp_f32 v148, v148
    v_exp_f32 v172, v172
    v_exp_f32 v156, v156
    v_exp_f32 v180, v180
    v_exp_f32 v149, v149
    v_exp_f32 v173, v173
    v_exp_f32 v157, v157
    v_exp_f32 v181, v181
    v_exp_f32 v150, v150
    v_exp_f32 v174, v174
    v_exp_f32 v158, v158
    v_exp_f32 v182, v182
    v_exp_f32 v151, v151
    v_exp_f32 v175, v175
    v_exp_f32 v159, v159
    v_exp_f32 v183, v183
    v_exp_f32 v152, v152
    v_exp_f32 v176, v176
    v_exp_f32 v160, v160
    v_exp_f32 v184, v184
    v_exp_f32 v153, v153
    v_exp_f32 v177, v177
    v_exp_f32 v161, v161
    v_exp_f32 v185, v185
    v_exp_f32 v154, v154
    v_exp_f32 v178, v178
    v_exp_f32 v162, v162
    v_exp_f32 v186, v186
    v_exp_f32 v155, v155
    v_exp_f32 v179, v179
    v_exp_f32 v163, v163
    v_exp_f32 v187, v187
    v_pk_add_f32 v[144:145], v[148:149], v[150:151]
    v_pk_add_f32 v[168:169], v[172:173], v[174:175]
    v_pk_add_f32 v[146:147], v[152:153], v[154:155]
    v_pk_add_f32 v[170:171], v[176:177], v[178:179]
    v_pk_add_f32 v[76:77], v[156:157], v[158:159]
    v_pk_add_f32 v[92:93], v[180:181], v[182:183]
    v_pk_add_f32 v[78:79], v[160:161], v[162:163]
    v_pk_add_f32 v[94:95], v[184:185], v[186:187]
    v_pk_add_f32 v[144:145], v[144:145], v[146:147]
    v_pk_add_f32 v[168:169], v[168:169], v[170:171]
    v_pk_add_f32 v[76:77], v[76:77], v[78:79]
    v_pk_add_f32 v[92:93], v[92:93], v[94:95]
    v_add_f32 v164, v144, v145
    v_add_f32 v188, v168, v169
    v_add_f32 v166, v76, v77
    v_add_f32 v190, v92, v93
    s_nop 0
    v_permlane32_swap_b32 v164, v166
    v_permlane32_swap_b32 v188, v190
    v_add_f32 v164, v164, v166
    v_add_f32 v188, v188, v190
    v_mov_b32 v166, v164
    v_mov_b32 v190, v188
    s_nop 0
    v_permlane16_swap_b32 v164, v166
    v_permlane16_swap_b32 v188, v190
    v_add_f32 v164, v164, v166
    v_add_f32 v188, v188, v190
    v_mov_b32 v166, v164
    v_mov_b32 v190, v188
    s_nop 0
    v_permlane32_swap_b32 v164, v166
    v_permlane32_swap_b32 v188, v190
    v_rcp_f32 v164, v164
    v_rcp_f32 v188, v188
    v_rcp_f32 v166, v166
    v_rcp_f32 v190, v190
    v_pk_mul_f32 v[148:149], v[148:149], v[164:165] op_sel_hi:[1,0]
    v_pk_mul_f32 v[172:173], v[172:173], v[188:189] op_sel_hi:[1,0]
    v_pk_mul_f32 v[156:157], v[156:157], v[166:167] op_sel_hi:[1,0]
    v_pk_mul_f32 v[180:181], v[180:181], v[190:191] op_sel_hi:[1,0]
    v_pk_mul_f32 v[150:151], v[150:151], v[164:165] op_sel_hi:[1,0]
    v_pk_mul_f32 v[174:175], v[174:175], v[188:189] op_sel_hi:[1,0]
    v_pk_mul_f32 v[158:159], v[158:159], v[166:167] op_sel_hi:[1,0]
    v_pk_mul_f32 v[182:183], v[182:183], v[190:191] op_sel_hi:[1,0]
    v_pk_mul_f32 v[152:153], v[152:153], v[164:165] op_sel_hi:[1,0]
    v_pk_mul_f32 v[176:177], v[176:177], v[188:189] op_sel_hi:[1,0]
    v_pk_mul_f32 v[160:161], v[160:161], v[166:167] op_sel_hi:[1,0]
    v_pk_mul_f32 v[184:185], v[184:185], v[190:191] op_sel_hi:[1,0]
    v_pk_mul_f32 v[154:155], v[154:155], v[164:165] op_sel_hi:[1,0]
    v_pk_mul_f32 v[178:179], v[178:179], v[188:189] op_sel_hi:[1,0]
    v_pk_mul_f32 v[162:163], v[162:163], v[166:167] op_sel_hi:[1,0]
    v_pk_mul_f32 v[186:187], v[186:187], v[190:191] op_sel_hi:[1,0]
    v_cvt_pk_bf16_f32 v72, v148, v149
    v_cvt_pk_bf16_f32 v88, v172, v173
    v_cvt_pk_bf16_f32 v76, v156, v157
    v_cvt_pk_bf16_f32 v92, v180, v181
    v_cvt_pk_bf16_f32 v73, v150, v151
    v_cvt_pk_bf16_f32 v89, v174, v175
    v_cvt_pk_bf16_f32 v77, v158, v159
    v_cvt_pk_bf16_f32 v93, v182, v183
    v_cvt_pk_bf16_f32 v74, v152, v153
    v_cvt_pk_bf16_f32 v90, v176, v177
    v_cvt_pk_bf16_f32 v78, v160, v161
    v_cvt_pk_bf16_f32 v94, v184, v185
    v_cvt_pk_bf16_f32 v75, v154, v155
    v_cvt_pk_bf16_f32 v91, v178, v179
    v_cvt_pk_bf16_f32 v79, v162, v163
    v_cvt_pk_bf16_f32 v95, v186, v187
    v_cvt_pk_bf16_f32 v212, v80, v81
    v_cvt_pk_bf16_f32 v213, v82, v83
    v_cvt_pk_bf16_f32 v214, v96, v97
    v_cvt_pk_bf16_f32 v215, v98, v99
    v_cvt_pk_bf16_f32 v216, v84, v85
    v_cvt_pk_bf16_f32 v217, v86, v87
    v_cvt_pk_bf16_f32 v218, v100, v101
    v_cvt_pk_bf16_f32 v219, v102, v103
    v_mfma_f32_16x16x32_bf16 v[144:147], v[72:75], v[192:195], 0
    v_mfma_f32_16x16x32_bf16 v[168:171], v[88:91], v[192:195], 0
    v_mfma_f32_16x16x32_bf16 v[148:151], v[72:75], v[196:199], 0
    v_mfma_f32_16x16x32_bf16 v[172:175], v[88:91], v[196:199], 0
    v_mfma_f32_16x16x32_bf16 v[152:155], v[76:79], v[192:195], 0
    v_mfma_f32_16x16x32_bf16 v[176:179], v[92:95], v[192:195], 0
    v_mfma_f32_16x16x32_bf16 v[156:159], v[76:79], v[196:199], 0
    v_mfma_f32_16x16x32_bf16 v[180:183], v[92:95], v[196:199], 0
    s_nop 0
    v_cvt_pk_bf16_f32 v204, v144, v145
    v_cvt_pk_bf16_f32 v205, v146, v147
    v_cvt_pk_bf16_f32 v206, v168, v169
    v_cvt_pk_bf16_f32 v207, v170, v171
    s_nop 1
    v_mfma_f32_16x16x32_bf16 v[16:19], v[204:207], v[212:215], v[16:19]
    v_mfma_f32_16x16x32_bf16 v[20:23], v[204:207], v[216:219], v[20:23]
    v_mfma_f32_16x16x32_bf16 v[32:35], v[204:207], v[200:203], v[32:35]
    v_cvt_pk_bf16_f32 v208, v148, v149
    v_cvt_pk_bf16_f32 v209, v150, v151
    v_cvt_pk_bf16_f32 v210, v172, v173
    v_cvt_pk_bf16_f32 v211, v174, v175
    s_nop 1
    v_mfma_f32_16x16x32_bf16 v[36:39], v[208:211], v[212:215], v[36:39]
    v_mfma_f32_16x16x32_bf16 v[220:223], v[208:211], v[216:219], v[220:223]
    v_mfma_f32_16x16x32_bf16 v[224:227], v[208:211], v[200:203], v[224:227]
    v_cvt_pk_bf16_f32 v204, v152, v153
    v_cvt_pk_bf16_f32 v205, v154, v155
    v_cvt_pk_bf16_f32 v206, v176, v177
    v_cvt_pk_bf16_f32 v207, v178, v179
    s_nop 1
    v_mfma_f32_16x16x32_bf16 v[228:231], v[204:207], v[212:215], v[228:231]
    v_mfma_f32_16x16x32_bf16 v[232:235], v[204:207], v[216:219], v[232:235]
    v_mfma_f32_16x16x32_bf16 v[8:11], v[204:207], v[200:203], v[8:11]
    v_cvt_pk_bf16_f32 v208, v156, v157
    v_cvt_pk_bf16_f32 v209, v158, v159
    v_cvt_pk_bf16_f32 v210, v180, v181
    v_cvt_pk_bf16_f32 v211, v182, v183
    s_nop 1
    v_mfma_f32_16x16x32_bf16 v[12:15], v[208:211], v[212:215], v[12:15]
    v_mfma_f32_16x16x32_bf16 v[24:27], v[208:211], v[216:219], v[24:27]
    v_mfma_f32_16x16x32_bf16 v[28:31], v[208:211], v[200:203], v[28:31]
    v_cvt_pk_bf16_f32 v104, v104, v105
    v_cvt_pk_bf16_f32 v120, v120, v121
    v_cvt_pk_bf16_f32 v105, v106, v107
    v_cvt_pk_bf16_f32 v121, v122, v123
    v_cvt_pk_bf16_f32 v106, v108, v109
    v_cvt_pk_bf16_f32 v122, v124, v125
    v_cvt_pk_bf16_f32 v107, v110, v111
    v_cvt_pk_bf16_f32 v123, v126, v127
    s_nop 0
    v_mfma_f32_16x16x32_bf16 v[108:111], v[136:139], v[104:107], 0
    v_mfma_f32_16x16x32_bf16 v[124:127], v[136:139], v[120:123], 0
    v_mfma_f32_16x16x32_bf16 v[144:147], v[140:143], v[104:107], 0
    v_mfma_f32_16x16x32_bf16 v[168:171], v[140:143], v[120:123], 0
    s_nop 4
    v_cvt_pk_bf16_f32 v148, v108, v109
    v_cvt_pk_bf16_f32 v172, v124, v125
    v_cvt_pk_bf16_f32 v149, v110, v111
    v_cvt_pk_bf16_f32 v173, v126, v127
    v_cvt_pk_bf16_f32 v150, v144, v145
    v_cvt_pk_bf16_f32 v174, v168, v169
    v_cvt_pk_bf16_f32 v151, v146, v147
    v_cvt_pk_bf16_f32 v175, v170, v171
    v_lshlrev_b32 v108, 16, v148
    v_lshlrev_b32 v124, 16, v172
    v_and_b32 v109, 0xffff0000, v148
    v_and_b32 v125, 0xffff0000, v172
    v_lshlrev_b32 v110, 16, v149
    v_lshlrev_b32 v126, 16, v173
    v_and_b32 v111, 0xffff0000, v149
    v_and_b32 v127, 0xffff0000, v173
    v_lshlrev_b32 v144, 16, v150
    v_lshlrev_b32 v168, 16, v174
    v_and_b32 v145, 0xffff0000, v150
    v_and_b32 v169, 0xffff0000, v174
    v_lshlrev_b32 v146, 16, v151
    v_lshlrev_b32 v170, 16, v175
    v_and_b32 v147, 0xffff0000, v151
    v_and_b32 v171, 0xffff0000, v175
    v_max3_f32 v164, v108, v109, v110
    v_max3_f32 v188, v124, v125, v126
    v_max3_f32 v166, -v108, -v109, -v110
    v_max3_f32 v190, -v124, -v125, -v126
    v_max3_f32 v165, v111, v144, v145
    v_max3_f32 v189, v127, v168, v169
    v_max3_f32 v167, -v111, -v144, -v145
    v_max3_f32 v191, -v127, -v168, -v169
    v_max3_f32 v164, v164, v146, v147
    v_max3_f32 v188, v188, v170, v171
    v_max3_f32 v166, v166, -v146, -v147
    v_max3_f32 v190, v190, -v170, -v171
    v_max_f32 v164, v164, v165
    v_max_f32 v188, v188, v189
    v_max_f32 v166, v166, v167
    v_max_f32 v190, v190, v191
    s_nop 0
    v_permlane32_swap_b32 v164, v166
    v_permlane32_swap_b32 v188, v190
    v_max_f32 v164, v164, v166
    v_max_f32 v188, v188, v190
    v_mov_b32 v166, v164
    v_mov_b32 v190, v188
    s_nop 0
    v_permlane16_swap_b32 v164, v166
    v_permlane16_swap_b32 v188, v190
    v_max_f32 v164, v164, v166
    v_max_f32 v188, v188, v190
    v_mov_b32 v166, v164
    v_mov_b32 v190, v188
    s_nop 0
    v_permlane32_swap_b32 v164, v166
    v_permlane32_swap_b32 v188, v190
    v_mul_f32 v164, s52, v164
    v_mul_f32 v188, s52, v188
    v_mul_f32 v166, s52, v166
    v_mul_f32 v190, s52, v190
    v_pk_fma_f32 v[148:149], v[108:109], s[52:53], v[164:165] op_sel_hi:[1,1,0] neg_lo:[0,0,1] neg_hi:[0,0,1]
    v_pk_fma_f32 v[172:173], v[124:125], s[52:53], v[188:189] op_sel_hi:[1,1,0] neg_lo:[0,0,1] neg_hi:[0,0,1]
    v_pk_fma_f32 v[156:157], v[108:109], s[52:53], v[166:167] op_sel_hi:[1,1,0] neg_lo:[1,0,1] neg_hi:[1,0,1]
    v_pk_fma_f32 v[180:181], v[124:125], s[52:53], v[190:191] op_sel_hi:[1,1,0] neg_lo:[1,0,1] neg_hi:[1,0,1]
    v_pk_fma_f32 v[150:151], v[110:111], s[52:53], v[164:165] op_sel_hi:[1,1,0] neg_lo:[0,0,1] neg_hi:[0,0,1]
    v_pk_fma_f32 v[174:175], v[126:127], s[52:53], v[188:189] op_sel_hi:[1,1,0] neg_lo:[0,0,1] neg_hi:[0,0,1]
    v_pk_fma_f32 v[158:159], v[110:111], s[52:53], v[166:167] op_sel_hi:[1,1,0] neg_lo:[1,0,1] neg_hi:[1,0,1]
    v_pk_fma_f32 v[182:183], v[126:127], s[52:53], v[190:191] op_sel_hi:[1,1,0] neg_lo:[1,0,1] neg_hi:[1,0,1]
    v_pk_fma_f32 v[152:153], v[144:145], s[52:53], v[164:165] op_sel_hi:[1,1,0] neg_lo:[0,0,1] neg_hi:[0,0,1]
    v_pk_fma_f32 v[176:177], v[168:169], s[52:53], v[188:189] op_sel_hi:[1,1,0] neg_lo:[0,0,1] neg_hi:[0,0,1]
    v_pk_fma_f32 v[160:161], v[144:145], s[52:53], v[166:167] op_sel_hi:[1,1,0] neg_lo:[1,0,1] neg_hi:[1,0,1]
    v_pk_fma_f32 v[184:185], v[168:169], s[52:53], v[190:191] op_sel_hi:[1,1,0] neg_lo:[1,0,1] neg_hi:[1,0,1]
    v_pk_fma_f32 v[154:155], v[146:147], s[52:53], v[164:165] op_sel_hi:[1,1,0] neg_lo:[0,0,1] neg_hi:[0,0,1]
    v_pk_fma_f32 v[178:179], v[170:171], s[52:53], v[188:189] op_sel_hi:[1,1,0] neg_lo:[0,0,1] neg_hi:[0,0,1]
    v_pk_fma_f32 v[162:163], v[146:147], s[52:53], v[166:167] op_sel_hi:[1,1,0] neg_lo:[1,0,1] neg_hi:[1,0,1]
    v_pk_fma_f32 v[186:187], v[170:171], s[52:53], v[190:191] op_sel_hi:[1,1,0] neg_lo:[1,0,1] neg_hi:[1,0,1]
    v_exp_f32 v148, v148
    v_exp_f32 v172, v172
    v_exp_f32 v156, v156
    v_exp_f32 v180, v180
    v_exp_f32 v149, v149
    v_exp_f32 v173, v173
    v_exp_f32 v157, v157
    v_exp_f32 v181, v181
    v_exp_f32 v150, v150
    v_exp_f32 v174, v174
    v_exp_f32 v158, v158
    v_exp_f32 v182, v182
    v_exp_f32 v151, v151
    v_exp_f32 v175, v175
    v_exp_f32 v159, v159
    v_exp_f32 v183, v183
    v_exp_f32 v152, v152
    v_exp_f32 v176, v176
    v_exp_f32 v160, v160
    v_exp_f32 v184, v184
    v_exp_f32 v153, v153
    v_exp_f32 v177, v177
    v_exp_f32 v161, v161
    v_exp_f32 v185, v185
    v_exp_f32 v154, v154
    v_exp_f32 v178, v178
    v_exp_f32 v162, v162
    v_exp_f32 v186, v186
    v_exp_f32 v155, v155
    v_exp_f32 v179, v179
    v_exp_f32 v163, v163
    v_exp_f32 v187, v187
    v_pk_add_f32 v[144:145], v[148:149], v[150:151]
    v_pk_add_f32 v[168:169], v[172:173], v[174:175]
    v_pk_add_f32 v[146:147], v[152:153], v[154:155]
    v_pk_add_f32 v[170:171], v[176:177], v[178:179]
    v_pk_add_f32 v[108:109], v[156:157], v[158:159]
    v_pk_add_f32 v[124:125], v[180:181], v[182:183]
    v_pk_add_f32 v[110:111], v[160:161], v[162:163]
    v_pk_add_f32 v[126:127], v[184:185], v[186:187]
    v_pk_add_f32 v[144:145], v[144:145], v[146:147]
    v_pk_add_f32 v[168:169], v[168:169], v[170:171]
    v_pk_add_f32 v[108:109], v[108:109], v[110:111]
    v_pk_add_f32 v[124:125], v[124:125], v[126:127]
    v_add_f32 v164, v144, v145
    v_add_f32 v188, v168, v169
    v_add_f32 v166, v108, v109
    v_add_f32 v190, v124, v125
    s_nop 0
    v_permlane32_swap_b32 v164, v166
    v_permlane32_swap_b32 v188, v190
    v_add_f32 v164, v164, v166
    v_add_f32 v188, v188, v190
    v_mov_b32 v166, v164
    v_mov_b32 v190, v188
    s_nop 0
    v_permlane16_swap_b32 v164, v166
    v_permlane16_swap_b32 v188, v190
    v_add_f32 v164, v164, v166
    v_add_f32 v188, v188, v190
    v_mov_b32 v166, v164
    v_mov_b32 v190, v188
    s_nop 0
    v_permlane32_swap_b32 v164, v166
    v_permlane32_swap_b32 v188, v190
    v_rcp_f32 v164, v164
    v_rcp_f32 v188, v188
    v_rcp_f32 v166, v166
    v_rcp_f32 v190, v190
    v_pk_mul_f32 v[148:149], v[148:149], v[164:165] op_sel_hi:[1,0]
    v_pk_mul_f32 v[172:173], v[172:173], v[188:189] op_sel_hi:[1,0]
    v_pk_mul_f32 v[156:157], v[156:157], v[166:167] op_sel_hi:[1,0]
    v_pk_mul_f32 v[180:181], v[180:181], v[190:191] op_sel_hi:[1,0]
    v_pk_mul_f32 v[150:151], v[150:151], v[164:165] op_sel_hi:[1,0]
    v_pk_mul_f32 v[174:175], v[174:175], v[188:189] op_sel_hi:[1,0]
    v_pk_mul_f32 v[158:159], v[158:159], v[166:167] op_sel_hi:[1,0]
    v_pk_mul_f32 v[182:183], v[182:183], v[190:191] op_sel_hi:[1,0]
    v_pk_mul_f32 v[152:153], v[152:153], v[164:165] op_sel_hi:[1,0]
    v_pk_mul_f32 v[176:177], v[176:177], v[188:189] op_sel_hi:[1,0]
    v_pk_mul_f32 v[160:161], v[160:161], v[166:167] op_sel_hi:[1,0]
    v_pk_mul_f32 v[184:185], v[184:185], v[190:191] op_sel_hi:[1,0]
    v_pk_mul_f32 v[154:155], v[154:155], v[164:165] op_sel_hi:[1,0]
    v_pk_mul_f32 v[178:179], v[178:179], v[188:189] op_sel_hi:[1,0]
    v_pk_mul_f32 v[162:163], v[162:163], v[166:167] op_sel_hi:[1,0]
    v_pk_mul_f32 v[186:187], v[186:187], v[190:191] op_sel_hi:[1,0]
    v_cvt_pk_bf16_f32 v104, v148, v149
    v_cvt_pk_bf16_f32 v120, v172, v173
    v_cvt_pk_bf16_f32 v108, v156, v157
    v_cvt_pk_bf16_f32 v124, v180, v181
    v_cvt_pk_bf16_f32 v105, v150, v151
    v_cvt_pk_bf16_f32 v121, v174, v175
    v_cvt_pk_bf16_f32 v109, v158, v159
    v_cvt_pk_bf16_f32 v125, v182, v183
    v_cvt_pk_bf16_f32 v106, v152, v153
    v_cvt_pk_bf16_f32 v122, v176, v177
    v_cvt_pk_bf16_f32 v110, v160, v161
    v_cvt_pk_bf16_f32 v126, v184, v185
    v_cvt_pk_bf16_f32 v107, v154, v155
    v_cvt_pk_bf16_f32 v123, v178, v179
    v_cvt_pk_bf16_f32 v111, v162, v163
    v_cvt_pk_bf16_f32 v127, v186, v187
    v_cvt_pk_bf16_f32 v212, v112, v113
    v_cvt_pk_bf16_f32 v213, v114, v115
    v_cvt_pk_bf16_f32 v214, v128, v129
    v_cvt_pk_bf16_f32 v215, v130, v131
    v_cvt_pk_bf16_f32 v216, v116, v117
    v_cvt_pk_bf16_f32 v217, v118, v119
    v_cvt_pk_bf16_f32 v218, v132, v133
    v_cvt_pk_bf16_f32 v219, v134, v135
    v_mfma_f32_16x16x32_bf16 v[144:147], v[104:107], v[192:195], 0
    v_mfma_f32_16x16x32_bf16 v[168:171], v[120:123], v[192:195], 0
    v_mfma_f32_16x16x32_bf16 v[148:151], v[104:107], v[196:199], 0
    v_mfma_f32_16x16x32_bf16 v[172:175], v[120:123], v[196:199], 0
    v_mfma_f32_16x16x32_bf16 v[152:155], v[108:111], v[192:195], 0
    v_mfma_f32_16x16x32_bf16 v[176:179], v[124:127], v[192:195], 0
    v_mfma_f32_16x16x32_bf16 v[156:159], v[108:111], v[196:199], 0
    v_mfma_f32_16x16x32_bf16 v[180:183], v[124:127], v[196:199], 0
    s_nop 0
    v_cvt_pk_bf16_f32 v204, v144, v145
    v_cvt_pk_bf16_f32 v205, v146, v147
    v_cvt_pk_bf16_f32 v206, v168, v169
    v_cvt_pk_bf16_f32 v207, v170, v171
    s_nop 1
    v_mfma_f32_16x16x32_bf16 v[16:19], v[204:207], v[212:215], v[16:19]
    v_mfma_f32_16x16x32_bf16 v[20:23], v[204:207], v[216:219], v[20:23]
    v_mfma_f32_16x16x32_bf16 v[32:35], v[204:207], v[200:203], v[32:35]
    v_cvt_pk_bf16_f32 v208, v148, v149
    v_cvt_pk_bf16_f32 v209, v150, v151
    v_cvt_pk_bf16_f32 v210, v172, v173
    v_cvt_pk_bf16_f32 v211, v174, v175
    s_nop 1
    v_mfma_f32_16x16x32_bf16 v[36:39], v[208:211], v[212:215], v[36:39]
    v_mfma_f32_16x16x32_bf16 v[220:223], v[208:211], v[216:219], v[220:223]
    v_mfma_f32_16x16x32_bf16 v[224:227], v[208:211], v[200:203], v[224:227]
    v_cvt_pk_bf16_f32 v204, v152, v153
    v_cvt_pk_bf16_f32 v205, v154, v155
    v_cvt_pk_bf16_f32 v206, v176, v177
    v_cvt_pk_bf16_f32 v207, v178, v179
    s_nop 1
    v_mfma_f32_16x16x32_bf16 v[228:231], v[204:207], v[212:215], v[228:231]
    v_mfma_f32_16x16x32_bf16 v[232:235], v[204:207], v[216:219], v[232:235]
    v_mfma_f32_16x16x32_bf16 v[8:11], v[204:207], v[200:203], v[8:11]
    v_cvt_pk_bf16_f32 v208, v156, v157
    v_cvt_pk_bf16_f32 v209, v158, v159
    v_cvt_pk_bf16_f32 v210, v180, v181
    v_cvt_pk_bf16_f32 v211, v182, v183
    s_nop 1
    v_mfma_f32_16x16x32_bf16 v[12:15], v[208:211], v[212:215], v[12:15]
    v_mfma_f32_16x16x32_bf16 v[24:27], v[208:211], v[216:219], v[24:27]
    v_mfma_f32_16x16x32_bf16 v[28:31], v[208:211], v[200:203], v[28:31]
    s_mul_i32 s44, s36, 6144
    s_add_u32 s44, s44, 122880
    v_lshlrev_b32 v2, 4, v1
    v_add_u32 v3, s44, v2
    s_xor_b32 s45, s36, 2
    s_mul_i32 s45, s45, 6144
    s_add_u32 s45, s45, 122880
    v_add_u32 v4, s45, v2
    s_cmp_eq_u32 s40, 0
    s_cbranch_scc0 Lx1_7
    ds_write_b128 v3, v[228:231] offset:0
    ds_write_b128 v3, v[232:235] offset:1024
    ds_write_b128 v3, v[12:15] offset:2048
    ds_write_b128 v3, v[24:27] offset:3072
    ds_write_b128 v3, v[8:11] offset:4096
    ds_write_b128 v3, v[28:31] offset:5120
    s_branch Lx2_8
Lx1_7:
    ds_write_b128 v3, v[16:19] offset:0
    ds_write_b128 v3, v[20:23] offset:1024
    ds_write_b128 v3, v[36:39] offset:2048
    ds_write_b128 v3, v[220:223] offset:3072
    ds_write_b128 v3, v[32:35] offset:4096
    ds_write_b128 v3, v[224:227] offset:5120
    v_mov_b32 v16, v228
    v_mov_b32 v17, v229
    v_mov_b32 v18, v230
    v_mov_b32 v19, v231
    v_mov_b32 v20, v232
    v_mov_b32 v21, v233
    v_mov_b32 v22, v234
    v_mov_b32 v23, v235
    v_mov_b32 v36, v12
    v_mov_b32 v37, v13
    v_mov_b32 v38, v14
    v_mov_b32 v39, v15
    v_mov_b32 v220, v24
    v_mov_b32 v221, v25
    v_mov_b32 v222, v26
    v_mov_b32 v223, v27
    v_mov_b32 v32, v8
    v_mov_b32 v33, v9
    v_mov_b32 v34, v10
    v_mov_b32 v35, v11
    v_mov_b32 v224, v28
    v_mov_b32 v225, v29
    v_mov_b32 v226, v30
    v_mov_b32 v227, v31
Lx2_8:
    s_waitcnt lgkmcnt(0)
    s_barrier
    ds_read_b128 v[228:231], v4 offset:0
    ds_read_b128 v[232:235], v4 offset:1024
    ds_read_b128 v[12:15], v4 offset:2048
    ds_read_b128 v[24:27], v4 offset:3072
    ds_read_b128 v[8:11], v4 offset:4096
    ds_read_b128 v[28:31], v4 offset:5120
    s_mov_b32 s56, s34
    s_mov_b32 s57, s35
    s_mov_b32 s58, 3145728
    s_mov_b32 s59, 0x20000
    s_mul_i32 s60, s51, 12288
    s_lshl_b32 s45, s40, 12
    s_add_u32 s44, s60, s45
    v_add_u32 v236, s44, v2
    s_lshl_b32 s45, s40, 11
    s_add_u32 s44, s60, s45
    s_add_u32 s44, s44, 8192
    v_and_b32 v237, 48, v1
    v_add_u32 v237, s44, v237
    s_mul_i32 s46, s37, 393216
    v_and_b32 v5, 15, v1
    v_cmp_eq_u32 s[62:63], 0, v5
    s_waitcnt lgkmcnt(5)
    v_pk_add_f32 v[16:17], v[16:17], v[228:229]
    v_pk_add_f32 v[18:19], v[18:19], v[230:231]
    buffer_store_dwordx4 v[16:19], v236, s[56:59], s46 offen offset:0 sc1
    s_waitcnt lgkmcnt(4)
    v_pk_add_f32 v[20:21], v[20:21], v[232:233]
    v_pk_add_f32 v[22:23], v[22:23], v[234:235]
    buffer_store_dwordx4 v[20:23], v236, s[56:59], s46 offen offset:1024 sc1
    s_waitcnt lgkmcnt(3)
    v_pk_add_f32 v[36:37], v[36:37], v[12:13]
    v_pk_add_f32 v[38:39], v[38:39], v[14:15]
    buffer_store_dwordx4 v[36:39], v236, s[56:59], s46 offen offset:2048 sc1
    s_waitcnt lgkmcnt(2)
    v_pk_add_f32 v[220:221], v[220:221], v[24:25]
    v_pk_add_f32 v[222:223], v[222:223], v[26:27]
    buffer_store_dwordx4 v[220:223], v236, s[56:59], s46 offen offset:3072 sc1
    s_waitcnt lgkmcnt(1)
    v_pk_add_f32 v[32:33], v[32:33], v[8:9]
    v_pk_add_f32 v[34:35], v[34:35], v[10:11]
    s_waitcnt lgkmcnt(0)
    v_pk_add_f32 v[224:225], v[224:225], v[28:29]
    v_pk_add_f32 v[226:227], v[226:227], v[30:31]
    s_mov_b64 exec, s[62:63]
    buffer_store_dwordx4 v[32:35], v237, s[56:59], s46 offen offset:0 sc1
    buffer_store_dwordx4 v[224:227], v237, s[56:59], s46 offen offset:1024 sc1
    s_mov_b64 exec, -1
    v_mov_b32 v238, 153616
    ds_read_b32 v238, v238
    s_waitcnt lgkmcnt(0)
    v_readfirstlane_b32 s43, v238
    s_waitcnt vmcnt(0)
    s_add_u32 s64, s34, 10551296
    s_addc_u32 s65, s35, 0
    s_mov_b32 s66, 32768
    s_mov_b32 s67, 0x20000
    v_lshlrev_b32 v238, 12, v1
    s_lshl_b32 s68, s38, 8
    s_lshl_b32 s69, s37, 2
    s_add_u32 s69, s69, s36
    s_lshl_b32 s69, s69, 3
    s_add_u32 s68, s68, s69
    v_add_u32 v238, s68, v238
    v_mov_b32 v240, s43
    v_xor_b32 v241, 1540483477, v240
    s_mov_b64 s[68:69], exec
    s_mov_b64 exec, 0xff
    buffer_store_dwordx2 v[240:241], v238, s[64:67], 0 offen sc1
    s_mov_b64 exec, s[68:69]
    s_setprio 0
    s_add_u32 s64, s34, 10551296
    s_addc_u32 s65, s35, 0
    s_mov_b32 s66, 32768
    s_mov_b32 s67, 0x20000
    s_lshl_b32 s62, s37, 12
    s_lshl_b32 s63, s38, 8
    s_add_u32 s62, s62, s63
    s_lshl_b32 s63, s36, 3
    s_add_u32 s62, s62, s63
    v_and_b32 v218, 7, v1
    v_lshlrev_b32 v218, 5, v218
    v_add_u32 v218, s62, v218
    s_xor_b32 s69, s43, 1540483477
    s_lshl_b32 s70, 1, s37
    s_mov_b32 s68, 0
    s_cmp_eq_u32 s37, 0
    s_cbranch_scc0 Lz_9
    v_mov_b32 v8, 0
    v_mov_b32 v9, 0
    v_mov_b32 v10, 0
    v_mov_b32 v11, 0
    v_mov_b32 v12, 0
    v_mov_b32 v13, 0
    v_mov_b32 v14, 0
    v_mov_b32 v15, 0
    v_mov_b32 v24, 0
    v_mov_b32 v25, 0
    v_mov_b32 v26, 0
    v_mov_b32 v27, 0
    v_mov_b32 v28, 0
    v_mov_b32 v29, 0
    v_mov_b32 v30, 0
    v_mov_b32 v31, 0
    v_mov_b32 v40, 0
    v_mov_b32 v41, 0
    v_mov_b32 v42, 0
    v_mov_b32 v43, 0
    v_mov_b32 v44, 0
    v_mov_b32 v45, 0
    v_mov_b32 v46, 0
    v_mov_b32 v47, 0
Lz_9:
    s_cmp_eq_u32 s37, 1
    s_cbranch_scc0 Lz_10
    v_mov_b32 v48, 0
    v_mov_b32 v49, 0
    v_mov_b32 v50, 0
    v_mov_b32 v51, 0
    v_mov_b32 v52, 0
    v_mov_b32 v53, 0
    v_mov_b32 v54, 0
    v_mov_b32 v55, 0
    v_mov_b32 v56, 0
    v_mov_b32 v57, 0
    v_mov_b32 v58, 0
    v_mov_b32 v59, 0
    v_mov_b32 v60, 0
    v_mov_b32 v61, 0
    v_mov_b32 v62, 0
    v_mov_b32 v63, 0
    v_mov_b32 v64, 0
    v_mov_b32 v65, 0
    v_mov_b32 v66, 0
    v_mov_b32 v67, 0
    v_mov_b32 v68, 0
    v_mov_b32 v69, 0
    v_mov_b32 v70, 0
    v_mov_b32 v71, 0
Lz_10:
    s_cmp_eq_u32 s37, 2
    s_cbranch_scc0 Lz_11
    v_mov_b32 v72, 0
    v_mov_b32 v73, 0
    v_mov_b32 v74, 0
    v_mov_b32 v75, 0
    v_mov_b32 v76, 0
    v_mov_b32 v77, 0
    v_mov_b32 v78, 0
    v_mov_b32 v79, 0
    v_mov_b32 v80, 0
    v_mov_b32 v81, 0
    v_mov_b32 v82, 0
    v_mov_b32 v83, 0
    v_mov_b32 v84, 0
    v_mov_b32 v85, 0
    v_mov_b32 v86, 0
    v_mov_b32 v87, 0
    v_mov_b32 v88, 0
    v_mov_b32 v89, 0
    v_mov_b32 v90, 0
    v_mov_b32 v91, 0
    v_mov_b32 v92, 0
    v_mov_b32 v93, 0
    v_mov_b32 v94, 0
    v_mov_b32 v95, 0
Lz_11:
    s_cmp_eq_u32 s37, 3
    s_cbranch_scc0 Lz_12
    v_mov_b32 v96, 0
    v_mov_b32 v97, 0
    v_mov_b32 v98, 0
    v_mov_b32 v99, 0
    v_mov_b32 v100, 0
    v_mov_b32 v101, 0
    v_mov_b32 v102, 0
    v_mov_b32 v103, 0
    v_mov_b32 v104, 0
    v_mov_b32 v105, 0
    v_mov_b32 v106, 0
    v_mov_b32 v107, 0
    v_mov_b32 v108, 0
    v_mov_b32 v109, 0
    v_mov_b32 v110, 0
    v_mov_b32 v111, 0
    v_mov_b32 v112, 0
    v_mov_b32 v113, 0
    v_mov_b32 v114, 0
    v_mov_b32 v115, 0
    v_mov_b32 v116, 0
    v_mov_b32 v117, 0
    v_mov_b32 v118, 0
    v_mov_b32 v119, 0
Lz_12:
    s_cmp_eq_u32 s37, 4
    s_cbranch_scc0 Lz_13
    v_mov_b32 v120, 0
    v_mov_b32 v121, 0
    v_mov_b32 v122, 0
    v_mov_b32 v123, 0
    v_mov_b32 v124, 0
    v_mov_b32 v125, 0
    v_mov_b32 v126, 0
    v_mov_b32 v127, 0
    v_mov_b32 v128, 0
    v_mov_b32 v129, 0
    v_mov_b32 v130, 0
    v_mov_b32 v131, 0
    v_mov_b32 v132, 0
    v_mov_b32 v133, 0
    v_mov_b32 v134, 0
    v_mov_b32 v135, 0
    v_mov_b32 v136, 0
    v_mov_b32 v137, 0
    v_mov_b32 v138, 0
    v_mov_b32 v139, 0
    v_mov_b32 v140, 0
    v_mov_b32 v141, 0
    v_mov_b32 v142, 0
    v_mov_b32 v143, 0
Lz_13:
    s_cmp_eq_u32 s37, 5
    s_cbranch_scc0 Lz_14
    v_mov_b32 v144, 0
    v_mov_b32 v145, 0
    v_mov_b32 v146, 0
    v_mov_b32 v147, 0
    v_mov_b32 v148, 0
    v_mov_b32 v149, 0
    v_mov_b32 v150, 0
    v_mov_b32 v151, 0
    v_mov_b32 v152, 0
    v_mov_b32 v153, 0
    v_mov_b32 v154, 0
    v_mov_b32 v155, 0
    v_mov_b32 v156, 0
    v_mov_b32 v157, 0
    v_mov_b32 v158, 0
    v_mov_b32 v159, 0
    v_mov_b32 v160, 0
    v_mov_b32 v161, 0
    v_mov_b32 v162, 0
    v_mov_b32 v163, 0
    v_mov_b32 v164, 0
    v_mov_b32 v165, 0
    v_mov_b32 v166, 0
    v_mov_b32 v167, 0
Lz_14:
    s_cmp_eq_u32 s37, 6
    s_cbranch_scc0 Lz_15
    v_mov_b32 v168, 0
    v_mov_b32 v169, 0
    v_mov_b32 v170, 0
    v_mov_b32 v171, 0
    v_mov_b32 v172, 0
    v_mov_b32 v173, 0
    v_mov_b32 v174, 0
    v_mov_b32 v175, 0
    v_mov_b32 v176, 0
    v_mov_b32 v177, 0
    v_mov_b32 v178, 0
    v_mov_b32 v179, 0
    v_mov_b32 v180, 0
    v_mov_b32 v181, 0
    v_mov_b32 v182, 0
    v_mov_b32 v183, 0
    v_mov_b32 v184, 0
    v_mov_b32 v185, 0
    v_mov_b32 v186, 0
    v_mov_b32 v187, 0
    v_mov_b32 v188, 0
    v_mov_b32 v189, 0
    v_mov_b32 v190, 0
    v_mov_b32 v191, 0
Lz_15:
    s_cmp_eq_u32 s37, 7
    s_cbranch_scc0 Lz_16
    v_mov_b32 v192, 0
    v_mov_b32 v193, 0
    v_mov_b32 v194, 0
    v_mov_b32 v195, 0
    v_mov_b32 v196, 0
    v_mov_b32 v197, 0
    v_mov_b32 v198, 0
    v_mov_b32 v199, 0
    v_mov_b32 v200, 0
    v_mov_b32 v201, 0
    v_mov_b32 v202, 0
    v_mov_b32 v203, 0
    v_mov_b32 v204, 0
    v_mov_b32 v205, 0
    v_mov_b32 v206, 0
    v_mov_b32 v207, 0
    v_mov_b32 v208, 0
    v_mov_b32 v209, 0
    v_mov_b32 v210, 0
    v_mov_b32 v211, 0
    v_mov_b32 v212, 0
    v_mov_b32 v213, 0
    v_mov_b32 v214, 0
    v_mov_b32 v215, 0
Lz_16:
    s_mov_b32 s72, 0
    buffer_load_dwordx2 v[216:217], v218, s[64:67], 0 offen sc1
Lpg_17:
    s_cmp_eq_u32 s72, 0
    s_cbranch_scc0 Lwn_20
    s_waitcnt vmcnt(0)
    s_branch Lwd_19
Lwn_20:
    s_cmp_eq_u32 s72, 1
    s_cbranch_scc0 Lwn_21
    s_waitcnt vmcnt(6)
    s_branch Lwd_19
Lwn_21:
    s_cmp_eq_u32 s72, 2
    s_cbranch_scc0 Lwn_22
    s_waitcnt vmcnt(12)
    s_branch Lwd_19
Lwn_22:
    s_cmp_eq_u32 s72, 3
    s_cbranch_scc0 Lwn_23
    s_waitcnt vmcnt(18)
    s_branch Lwd_19
Lwn_23:
    s_cmp_eq_u32 s72, 4
    s_cbranch_scc0 Lwn_24
    s_waitcnt vmcnt(24)
    s_branch Lwd_19
Lwn_24:
    s_cmp_eq_u32 s72, 5
    s_cbranch_scc0 Lwn_25
    s_waitcnt vmcnt(30)
    s_branch Lwd_19
Lwn_25:
    s_cmp_eq_u32 s72, 6
    s_cbranch_scc0 Lwn_26
    s_waitcnt vmcnt(36)
    s_branch Lwd_19
Lwn_26:
    s_waitcnt vmcnt(42)
Lwd_19:
    v_cmp_eq_u32 vcc, s43, v216
    v_cmp_eq_u32 s[62:63], s69, v217
    s_nop 0
    s_and_b32 s62, s62, vcc_lo
    s_and_b32 s62, s62, 0xff
    s_andn2_b32 s71, s62, s70
    s_or_b32 s70, s70, s62
    s_bcnt1_i32_b32 s72, s71
    buffer_load_dwordx2 v[216:217], v218, s[64:67], 0 offen sc1
    s_bitcmp1_b32 s71, 0
    s_cbranch_scc0 Lgr_28
    s_mov_b32 s46, 0
    buffer_load_dwordx4 v[8:11], v236, s[56:59], s46 offen offset:0 sc1
    buffer_load_dwordx4 v[12:15], v236, s[56:59], s46 offen offset:1024 sc1
    buffer_load_dwordx4 v[24:27], v236, s[56:59], s46 offen offset:2048 sc1
    buffer_load_dwordx4 v[28:31], v236, s[56:59], s46 offen offset:3072 sc1
    buffer_load_dwordx4 v[40:43], v237, s[56:59], s46 offen offset:0 sc1
    buffer_load_dwordx4 v[44:47], v237, s[56:59], s46 offen offset:1024 sc1
Lgr_28:
    s_bitcmp1_b32 s71, 1
    s_cbranch_scc0 Lgr_29
    s_mov_b32 s46, 393216
    buffer_load_dwordx4 v[48:51], v236, s[56:59], s46 offen offset:0 sc1
    buffer_load_dwordx4 v[52:55], v236, s[56:59], s46 offen offset:1024 sc1
    buffer_load_dwordx4 v[56:59], v236, s[56:59], s46 offen offset:2048 sc1
    buffer_load_dwordx4 v[60:63], v236, s[56:59], s46 offen offset:3072 sc1
    buffer_load_dwordx4 v[64:67], v237, s[56:59], s46 offen offset:0 sc1
    buffer_load_dwordx4 v[68:71], v237, s[56:59], s46 offen offset:1024 sc1
Lgr_29:
    s_bitcmp1_b32 s71, 2
    s_cbranch_scc0 Lgr_30
    s_mov_b32 s46, 786432
    buffer_load_dwordx4 v[72:75], v236, s[56:59], s46 offen offset:0 sc1
    buffer_load_dwordx4 v[76:79], v236, s[56:59], s46 offen offset:1024 sc1
    buffer_load_dwordx4 v[80:83], v236, s[56:59], s46 offen offset:2048 sc1
    buffer_load_dwordx4 v[84:87], v236, s[56:59], s46 offen offset:3072 sc1
    buffer_load_dwordx4 v[88:91], v237, s[56:59], s46 offen offset:0 sc1
    buffer_load_dwordx4 v[92:95], v237, s[56:59], s46 offen offset:1024 sc1
Lgr_30:
    s_bitcmp1_b32 s71, 3
    s_cbranch_scc0 Lgr_31
    s_mov_b32 s46, 1179648
    buffer_load_dwordx4 v[96:99], v236, s[56:59], s46 offen offset:0 sc1
    buffer_load_dwordx4 v[100:103], v236, s[56:59], s46 offen offset:1024 sc1
    buffer_load_dwordx4 v[104:107], v236, s[56:59], s46 offen offset:2048 sc1
    buffer_load_dwordx4 v[108:111], v236, s[56:59], s46 offen offset:3072 sc1
    buffer_load_dwordx4 v[112:115], v237, s[56:59], s46 offen offset:0 sc1
    buffer_load_dwordx4 v[116:119], v237, s[56:59], s46 offen offset:1024 sc1
Lgr_31:
    s_bitcmp1_b32 s71, 4
    s_cbranch_scc0 Lgr_32
    s_mov_b32 s46, 1572864
    buffer_load_dwordx4 v[120:123], v236, s[56:59], s46 offen offset:0 sc1
    buffer_load_dwordx4 v[124:127], v236, s[56:59], s46 offen offset:1024 sc1
    buffer_load_dwordx4 v[128:131], v236, s[56:59], s46 offen offset:2048 sc1
    buffer_load_dwordx4 v[132:135], v236, s[56:59], s46 offen offset:3072 sc1
    buffer_load_dwordx4 v[136:139], v237, s[56:59], s46 offen offset:0 sc1
    buffer_load_dwordx4 v[140:143], v237, s[56:59], s46 offen offset:1024 sc1
Lgr_32:
    s_bitcmp1_b32 s71, 5
    s_cbranch_scc0 Lgr_33
    s_mov_b32 s46, 1966080
    buffer_load_dwordx4 v[144:147], v236, s[56:59], s46 offen offset:0 sc1
    buffer_load_dwordx4 v[148:151], v236, s[56:59], s46 offen offset:1024 sc1
    buffer_load_dwordx4 v[152:155], v236, s[56:59], s46 offen offset:2048 sc1
    buffer_load_dwordx4 v[156:159], v236, s[56:59], s46 offen offset:3072 sc1
    buffer_load_dwordx4 v[160:163], v237, s[56:59], s46 offen offset:0 sc1
    buffer_load_dwordx4 v[164:167], v237, s[56:59], s46 offen offset:1024 sc1
Lgr_33:
    s_bitcmp1_b32 s71, 6
    s_cbranch_scc0 Lgr_34
    s_mov_b32 s46, 2359296
    buffer_load_dwordx4 v[168:171], v236, s[56:59], s46 offen offset:0 sc1
    buffer_load_dwordx4 v[172:175], v236, s[56:59], s46 offen offset:1024 sc1
    buffer_load_dwordx4 v[176:179], v236, s[56:59], s46 offen offset:2048 sc1
    buffer_load_dwordx4 v[180:183], v236, s[56:59], s46 offen offset:3072 sc1
    buffer_load_dwordx4 v[184:187], v237, s[56:59], s46 offen offset:0 sc1
    buffer_load_dwordx4 v[188:191], v237, s[56:59], s46 offen offset:1024 sc1
Lgr_34:
    s_bitcmp1_b32 s71, 7
    s_cbranch_scc0 Lgr_35
    s_mov_b32 s46, 2752512
    buffer_load_dwordx4 v[192:195], v236, s[56:59], s46 offen offset:0 sc1
    buffer_load_dwordx4 v[196:199], v236, s[56:59], s46 offen offset:1024 sc1
    buffer_load_dwordx4 v[200:203], v236, s[56:59], s46 offen offset:2048 sc1
    buffer_load_dwordx4 v[204:207], v236, s[56:59], s46 offen offset:3072 sc1
    buffer_load_dwordx4 v[208:211], v237, s[56:59], s46 offen offset:0 sc1
    buffer_load_dwordx4 v[212:215], v237, s[56:59], s46 offen offset:1024 sc1
Lgr_35:
    s_cmp_eq_u32 s70, 0xff
    s_cbranch_scc1 Lpgd_18
    s_add_u32 s68, s68, 1
    s_cmp_lt_u32 s68, 0x40000
    s_cbranch_scc1 Lpg_17
Lpgd_18:
    s_mul_i32 s44, s41, 6144
    s_add_u32 s44, s44, 65536
    v_add_u32 v2, s44, v2
    s_waitcnt vmcnt(0)
    v_pk_add_f32 v[8:9], v[8:9], v[48:49]
    v_pk_add_f32 v[10:11], v[10:11], v[50:51]
    v_pk_add_f32 v[12:13], v[12:13], v[52:53]
    v_pk_add_f32 v[14:15], v[14:15], v[54:55]
    v_pk_add_f32 v[24:25], v[24:25], v[56:57]
    v_pk_add_f32 v[26:27], v[26:27], v[58:59]
    v_pk_add_f32 v[28:29], v[28:29], v[60:61]
    v_pk_add_f32 v[30:31], v[30:31], v[62:63]
    v_pk_add_f32 v[40:41], v[40:41], v[64:65]
    v_pk_add_f32 v[42:43], v[42:43], v[66:67]
    v_pk_add_f32 v[44:45], v[44:45], v[68:69]
    v_pk_add_f32 v[46:47], v[46:47], v[70:71]
    v_pk_add_f32 v[72:73], v[72:73], v[96:97]
    v_pk_add_f32 v[74:75], v[74:75], v[98:99]
    v_pk_add_f32 v[76:77], v[76:77], v[100:101]
    v_pk_add_f32 v[78:79], v[78:79], v[102:103]
    v_pk_add_f32 v[80:81], v[80:81], v[104:105]
    v_pk_add_f32 v[82:83], v[82:83], v[106:107]
    v_pk_add_f32 v[84:85], v[84:85], v[108:109]
    v_pk_add_f32 v[86:87], v[86:87], v[110:111]
    v_pk_add_f32 v[88:89], v[88:89], v[112:113]
    v_pk_add_f32 v[90:91], v[90:91], v[114:115]
    v_pk_add_f32 v[92:93], v[92:93], v[116:117]
    v_pk_add_f32 v[94:95], v[94:95], v[118:119]
    v_pk_add_f32 v[120:121], v[120:121], v[144:145]
    v_pk_add_f32 v[122:123], v[122:123], v[146:147]
    v_pk_add_f32 v[124:125], v[124:125], v[148:149]
    v_pk_add_f32 v[126:127], v[126:127], v[150:151]
    v_pk_add_f32 v[128:129], v[128:129], v[152:153]
    v_pk_add_f32 v[130:131], v[130:131], v[154:155]
    v_pk_add_f32 v[132:133], v[132:133], v[156:157]
    v_pk_add_f32 v[134:135], v[134:135], v[158:159]
    v_pk_add_f32 v[136:137], v[136:137], v[160:161]
    v_pk_add_f32 v[138:139], v[138:139], v[162:163]
    v_pk_add_f32 v[140:141], v[140:141], v[164:165]
    v_pk_add_f32 v[142:143], v[142:143], v[166:167]
    v_pk_add_f32 v[168:169], v[168:169], v[192:193]
    v_pk_add_f32 v[170:171], v[170:171], v[194:195]
    v_pk_add_f32 v[172:173], v[172:173], v[196:197]
    v_pk_add_f32 v[174:175], v[174:175], v[198:199]
    v_pk_add_f32 v[176:177], v[176:177], v[200:201]
    v_pk_add_f32 v[178:179], v[178:179], v[202:203]
    v_pk_add_f32 v[180:181], v[180:181], v[204:205]
    v_pk_add_f32 v[182:183], v[182:183], v[206:207]
    v_pk_add_f32 v[184:185], v[184:185], v[208:209]
    v_pk_add_f32 v[186:187], v[186:187], v[210:211]
    v_pk_add_f32 v[188:189], v[188:189], v[212:213]
    v_pk_add_f32 v[190:191], v[190:191], v[214:215]
    v_pk_add_f32 v[8:9], v[8:9], v[72:73]
    v_pk_add_f32 v[10:11], v[10:11], v[74:75]
    v_pk_add_f32 v[12:13], v[12:13], v[76:77]
    v_pk_add_f32 v[14:15], v[14:15], v[78:79]
    v_pk_add_f32 v[24:25], v[24:25], v[80:81]
    v_pk_add_f32 v[26:27], v[26:27], v[82:83]
    v_pk_add_f32 v[28:29], v[28:29], v[84:85]
    v_pk_add_f32 v[30:31], v[30:31], v[86:87]
    v_pk_add_f32 v[40:41], v[40:41], v[88:89]
    v_pk_add_f32 v[42:43], v[42:43], v[90:91]
    v_pk_add_f32 v[44:45], v[44:45], v[92:93]
    v_pk_add_f32 v[46:47], v[46:47], v[94:95]
    v_pk_add_f32 v[120:121], v[120:121], v[168:169]
    v_pk_add_f32 v[122:123], v[122:123], v[170:171]
    v_pk_add_f32 v[124:125], v[124:125], v[172:173]
    v_pk_add_f32 v[126:127], v[126:127], v[174:175]
    v_pk_add_f32 v[128:129], v[128:129], v[176:177]
    v_pk_add_f32 v[130:131], v[130:131], v[178:179]
    v_pk_add_f32 v[132:133], v[132:133], v[180:181]
    v_pk_add_f32 v[134:135], v[134:135], v[182:183]
    v_pk_add_f32 v[136:137], v[136:137], v[184:185]
    v_pk_add_f32 v[138:139], v[138:139], v[186:187]
    v_pk_add_f32 v[140:141], v[140:141], v[188:189]
    v_pk_add_f32 v[142:143], v[142:143], v[190:191]
    v_pk_add_f32 v[8:9], v[8:9], v[120:121]
    v_pk_add_f32 v[10:11], v[10:11], v[122:123]
    v_pk_add_f32 v[12:13], v[12:13], v[124:125]
    v_pk_add_f32 v[14:15], v[14:15], v[126:127]
    v_pk_add_f32 v[24:25], v[24:25], v[128:129]
    v_pk_add_f32 v[26:27], v[26:27], v[130:131]
    v_pk_add_f32 v[28:29], v[28:29], v[132:133]
    v_pk_add_f32 v[30:31], v[30:31], v[134:135]
    v_pk_add_f32 v[40:41], v[40:41], v[136:137]
    v_pk_add_f32 v[42:43], v[42:43], v[138:139]
    v_pk_add_f32 v[44:45], v[44:45], v[140:141]
    v_pk_add_f32 v[46:47], v[46:47], v[142:143]
    v_pk_add_f32 v[16:17], v[16:17], v[8:9]
    v_pk_add_f32 v[18:19], v[18:19], v[10:11]
    v_pk_add_f32 v[20:21], v[20:21], v[12:13]
    v_pk_add_f32 v[22:23], v[22:23], v[14:15]
    v_pk_add_f32 v[36:37], v[36:37], v[24:25]
    v_pk_add_f32 v[38:39], v[38:39], v[26:27]
    v_pk_add_f32 v[220:221], v[220:221], v[28:29]
    v_pk_add_f32 v[222:223], v[222:223], v[30:31]
    v_pk_add_f32 v[32:33], v[32:33], v[40:41]
    v_pk_add_f32 v[34:35], v[34:35], v[42:43]
    v_pk_add_f32 v[224:225], v[224:225], v[44:45]
    v_pk_add_f32 v[226:227], v[226:227], v[46:47]
    v_cvt_pk_bf16_f32 v48, v16, v17
    v_cvt_pk_bf16_f32 v49, v18, v19
    v_cvt_pk_bf16_f32 v52, v20, v21
    v_cvt_pk_bf16_f32 v53, v22, v23
    v_cvt_pk_bf16_f32 v56, v36, v37
    v_cvt_pk_bf16_f32 v57, v38, v39
    v_cvt_pk_bf16_f32 v60, v220, v221
    v_cvt_pk_bf16_f32 v61, v222, v223
    v_cvt_pk_bf16_f32 v64, v32, v33
    v_cvt_pk_bf16_f32 v65, v34, v35
    v_cvt_pk_bf16_f32 v68, v224, v225
    v_cvt_pk_bf16_f32 v69, v226, v227
    s_cmp_eq_u32 s40, 1
    s_cbranch_scc1 Lg1_36
    ds_write_b64 v2, v[48:49] offset:0
    ds_write_b64 v2, v[52:53] offset:1024
    ds_write_b64 v2, v[56:57] offset:8
    ds_write_b64 v2, v[60:61] offset:1032
    ds_write_b64 v2, v[64:65] offset:4096
    ds_write_b64 v2, v[68:69] offset:4104
    s_branch Lg2_37
Lg1_36:
    ds_write_b64 v2, v[48:49] offset:2048
    ds_write_b64 v2, v[52:53] offset:3072
    ds_write_b64 v2, v[56:57] offset:2056
    ds_write_b64 v2, v[60:61] offset:3080
    ds_write_b64 v2, v[64:65] offset:5120
    ds_write_b64 v2, v[68:69] offset:5128
Lg2_37:
    s_waitcnt lgkmcnt(0)
    s_barrier
    s_barrier
    s_lshr_b32 s40, s36, 1
    s_and_b32 s41, s36, 1
    s_lshl_b32 s50, s37, 8
    s_and_b32 s44, s38, 1
    s_lshl_b32 s44, s44, 7
    s_add_u32 s50, s50, s44
    s_lshl_b32 s44, s40, 6
    s_add_u32 s50, s50, s44
    s_lshr_b32 s51, s38, 1
    s_lshl_b32 s51, s51, 7
    s_lshl_b32 s44, s41, 6
    s_add_u32 s51, s51, s44
    v_and_b32 v72, 15, v1
    v_add_u32 v72, s50, v72
    v_lshrrev_b32 v73, 4, v1
    v_lshlrev_b32 v73, 2, v73
    v_add_u32 v73, s51, v73
    v_and_b32 v2, 15, v1
    v_lshlrev_b32 v2, 7, v2
    v_lshrrev_b32 v3, 4, v1
    v_bfe_u32 v4, v1, 1, 3
    v_xor_b32 v3, v3, v4
    v_lshl_add_u32 v2, v3, 4, v2
    s_mul_i32 s44, s40, 8192
    s_add_u32 s44, s44, 0
    v_add_u32 v2, s44, v2
    v_xor_b32 v74, 0, v2
    v_xor_b32 v75, 64, v2
    v_lshrrev_b32 v2, 4, v1
    v_lshlrev_b32 v2, 3, v2
    v_bfe_u32 v3, v1, 2, 2
    v_add_u32 v2, v2, v3
    v_lshlrev_b32 v2, 7, v2
    v_bfe_u32 v3, v1, 3, 2
    v_lshl_add_u32 v2, v3, 5, v2
    v_and_b32 v3, 3, v1
    v_lshl_add_u32 v2, v3, 3, v2
    s_lshl_b32 s44, s41, 13
    s_add_u32 s44, s44, 16384
    v_add_u32 v2, s44, v2
    v_xor_b32 v78, 0, v2
    v_xor_b32 v79, 32, v2
    v_xor_b32 v80, 64, v2
    v_xor_b32 v81, 96, v2
    s_barrier
    v_mov_b32 v8, 0
    v_mov_b32 v9, 0
    v_mov_b32 v10, 0
    v_mov_b32 v11, 0
    v_mov_b32 v12, 0
    v_mov_b32 v13, 0
    v_mov_b32 v14, 0
    v_mov_b32 v15, 0
    v_mov_b32 v16, 0
    v_mov_b32 v17, 0
    v_mov_b32 v18, 0
    v_mov_b32 v19, 0
    v_mov_b32 v20, 0
    v_mov_b32 v21, 0
    v_mov_b32 v22, 0
    v_mov_b32 v23, 0
    v_mov_b32 v24, 0
    v_mov_b32 v25, 0
    v_mov_b32 v26, 0
    v_mov_b32 v27, 0
    v_mov_b32 v28, 0
    v_mov_b32 v29, 0
    v_mov_b32 v30, 0
    v_mov_b32 v31, 0
    v_mov_b32 v32, 0
    v_mov_b32 v33, 0
    v_mov_b32 v34, 0
    v_mov_b32 v35, 0
    v_mov_b32 v36, 0
    v_mov_b32 v37, 0
    v_mov_b32 v38, 0
    v_mov_b32 v39, 0
    v_mov_b32 v40, 0
    v_mov_b32 v41, 0
    v_mov_b32 v42, 0
    v_mov_b32 v43, 0
    v_mov_b32 v44, 0
    v_mov_b32 v45, 0
    v_mov_b32 v46, 0
    v_mov_b32 v47, 0
    v_mov_b32 v48, 0
    v_mov_b32 v49, 0
    v_mov_b32 v50, 0
    v_mov_b32 v51, 0
    v_mov_b32 v52, 0
    v_mov_b32 v53, 0
    v_mov_b32 v54, 0
    v_mov_b32 v55, 0
    v_mov_b32 v56, 0
    v_mov_b32 v57, 0
    v_mov_b32 v58, 0
    v_mov_b32 v59, 0
    v_mov_b32 v60, 0
    v_mov_b32 v61, 0
    v_mov_b32 v62, 0
    v_mov_b32 v63, 0
    v_mov_b32 v64, 0
    v_mov_b32 v65, 0
    v_mov_b32 v66, 0
    v_mov_b32 v67, 0
    v_mov_b32 v68, 0
    v_mov_b32 v69, 0
    v_mov_b32 v70, 0
    v_mov_b32 v71, 0
    s_mov_b32 s48, 0
    v_add_u32 v76, s48, v74
    v_add_u32 v77, s48, v75
    v_add_u32 v82, s48, v78
    v_add_u32 v83, s48, v79
    v_add_u32 v84, s48, v80
    v_add_u32 v85, s48, v81
    s_barrier
    ds_read_b128 v[88:91], v76 offset:0
    ds_read_b128 v[92:95], v76 offset:2048
    ds_read_b128 v[96:99], v76 offset:4096
    ds_read_b128 v[100:103], v76 offset:6144
    ds_read_b64_tr_b16 v[120:121], v82 offset:0
    ds_read_b64_tr_b16 v[122:123], v82 offset:512
    ds_read_b64_tr_b16 v[124:125], v83 offset:0
    ds_read_b64_tr_b16 v[126:127], v83 offset:512
    ds_read_b64_tr_b16 v[128:129], v84 offset:0
    ds_read_b64_tr_b16 v[130:131], v84 offset:512
    ds_read_b64_tr_b16 v[132:133], v85 offset:0
    ds_read_b64_tr_b16 v[134:135], v85 offset:512
    s_mov_b32 s49, 0
Lmm_38:
    s_waitcnt lgkmcnt(0)
    v_mfma_f32_16x16x32_bf16 v[8:11], v[120:123], v[88:91], v[8:11]
    ds_read_b128 v[104:107], v77 offset:0
    ds_read_b128 v[108:111], v77 offset:2048
    v_mfma_f32_16x16x32_bf16 v[12:15], v[124:127], v[88:91], v[12:15]
    ds_read_b128 v[112:115], v77 offset:4096
    ds_read_b128 v[116:119], v77 offset:6144
    v_mfma_f32_16x16x32_bf16 v[16:19], v[128:131], v[88:91], v[16:19]
    ds_read_b64_tr_b16 v[136:137], v82 offset:4096
    ds_read_b64_tr_b16 v[138:139], v82 offset:4608
    v_mfma_f32_16x16x32_bf16 v[20:23], v[132:135], v[88:91], v[20:23]
    ds_read_b64_tr_b16 v[140:141], v83 offset:4096
    ds_read_b64_tr_b16 v[142:143], v83 offset:4608
    v_mfma_f32_16x16x32_bf16 v[24:27], v[120:123], v[92:95], v[24:27]
    ds_read_b64_tr_b16 v[144:145], v84 offset:4096
    ds_read_b64_tr_b16 v[146:147], v84 offset:4608
    v_mfma_f32_16x16x32_bf16 v[28:31], v[124:127], v[92:95], v[28:31]
    ds_read_b64_tr_b16 v[148:149], v85 offset:4096
    ds_read_b64_tr_b16 v[150:151], v85 offset:4608
    v_mfma_f32_16x16x32_bf16 v[32:35], v[128:131], v[92:95], v[32:35]
    s_add_u32 s48, s48, 32768
    s_cmp_ge_u32 s48, 131072
    s_cselect_b32 s48, 0, s48
    v_add_u32 v76, s48, v74
    v_mfma_f32_16x16x32_bf16 v[36:39], v[132:135], v[92:95], v[36:39]
    v_add_u32 v77, s48, v75
    v_add_u32 v82, s48, v78
    v_mfma_f32_16x16x32_bf16 v[40:43], v[120:123], v[96:99], v[40:43]
    v_add_u32 v83, s48, v79
    v_add_u32 v84, s48, v80
    v_mfma_f32_16x16x32_bf16 v[44:47], v[124:127], v[96:99], v[44:47]
    v_add_u32 v85, s48, v81
    v_mfma_f32_16x16x32_bf16 v[48:51], v[128:131], v[96:99], v[48:51]
    v_mfma_f32_16x16x32_bf16 v[52:55], v[132:135], v[96:99], v[52:55]
    v_mfma_f32_16x16x32_bf16 v[56:59], v[120:123], v[100:103], v[56:59]
    v_mfma_f32_16x16x32_bf16 v[60:63], v[124:127], v[100:103], v[60:63]
    v_mfma_f32_16x16x32_bf16 v[64:67], v[128:131], v[100:103], v[64:67]
    v_mfma_f32_16x16x32_bf16 v[68:71], v[132:135], v[100:103], v[68:71]
    s_waitcnt lgkmcnt(0)
    v_mfma_f32_16x16x32_bf16 v[8:11], v[136:139], v[104:107], v[8:11]
    s_barrier
    ds_read_b128 v[88:91], v76 offset:0
    v_mfma_f32_16x16x32_bf16 v[12:15], v[140:143], v[104:107], v[12:15]
    ds_read_b128 v[92:95], v76 offset:2048
    v_mfma_f32_16x16x32_bf16 v[16:19], v[144:147], v[104:107], v[16:19]
    ds_read_b128 v[96:99], v76 offset:4096
    v_mfma_f32_16x16x32_bf16 v[20:23], v[148:151], v[104:107], v[20:23]
    ds_read_b128 v[100:103], v76 offset:6144
    v_mfma_f32_16x16x32_bf16 v[24:27], v[136:139], v[108:111], v[24:27]
    ds_read_b64_tr_b16 v[120:121], v82 offset:0
    v_mfma_f32_16x16x32_bf16 v[28:31], v[140:143], v[108:111], v[28:31]
    ds_read_b64_tr_b16 v[122:123], v82 offset:512
    v_mfma_f32_16x16x32_bf16 v[32:35], v[144:147], v[108:111], v[32:35]
    ds_read_b64_tr_b16 v[124:125], v83 offset:0
    v_mfma_f32_16x16x32_bf16 v[36:39], v[148:151], v[108:111], v[36:39]
    ds_read_b64_tr_b16 v[126:127], v83 offset:512
    v_mfma_f32_16x16x32_bf16 v[40:43], v[136:139], v[112:115], v[40:43]
    ds_read_b64_tr_b16 v[128:129], v84 offset:0
    v_mfma_f32_16x16x32_bf16 v[44:47], v[140:143], v[112:115], v[44:47]
    ds_read_b64_tr_b16 v[130:131], v84 offset:512
    v_mfma_f32_16x16x32_bf16 v[48:51], v[144:147], v[112:115], v[48:51]
    ds_read_b64_tr_b16 v[132:133], v85 offset:0
    v_mfma_f32_16x16x32_bf16 v[52:55], v[148:151], v[112:115], v[52:55]
    ds_read_b64_tr_b16 v[134:135], v85 offset:512
    v_mfma_f32_16x16x32_bf16 v[56:59], v[136:139], v[116:119], v[56:59]
    v_mfma_f32_16x16x32_bf16 v[60:63], v[140:143], v[116:119], v[60:63]
    v_mfma_f32_16x16x32_bf16 v[64:67], v[144:147], v[116:119], v[64:67]
    v_mfma_f32_16x16x32_bf16 v[68:71], v[148:151], v[116:119], v[68:71]
    s_add_u32 s49, s49, 1
    s_cmp_lt_u32 s49, 16
    s_cbranch_scc1 Lmm_38
    s_waitcnt lgkmcnt(0)
    s_mov_b32 s52, s30
    s_mov_b32 s53, s31
    s_mov_b32 s54, 16777216
    s_mov_b32 s55, 0x20000
    v_lshlrev_b32 v2, 13, v72
    v_lshl_add_u32 v2, v73, 2, v2
    s_lshl_b32 s56, s36, 14
    s_add_u32 s56, s56, s48
    s_add_u32 s56, s56, 32768
    s_and_b32 s56, s56, 0x1ffff
    v_and_b32 v3, 15, v1
    v_lshrrev_b32 v4, 4, v1
    v_xor_b32 v4, v4, v3
    v_lshlrev_b32 v3, 8, v3
    v_lshl_add_u32 v3, v4, 4, v3
    v_add_u32 v3, s56, v3
    v_xor_b32 v74, 0, v3
    v_xor_b32 v75, 64, v3
    v_xor_b32 v76, 128, v3
    v_xor_b32 v77, 192, v3
    s_mov_b32 s44, 0
    v_cvt_pk_bf16_f32 v3, v8, v9
    v_cvt_pk_bf16_f32 v4, v10, v11
    v_lshlrev_b32 v8, 16, v3
    v_and_b32 v9, 0xffff0000, v3
    v_lshlrev_b32 v10, 16, v4
    v_and_b32 v11, 0xffff0000, v4
    ds_write_b128 v74, v[8:11] offset:0
    v_cvt_pk_bf16_f32 v3, v12, v13
    v_cvt_pk_bf16_f32 v4, v14, v15
    v_lshlrev_b32 v12, 16, v3
    v_and_b32 v13, 0xffff0000, v3
    v_lshlrev_b32 v14, 16, v4
    v_and_b32 v15, 0xffff0000, v4
    ds_write_b128 v75, v[12:15] offset:0
    v_cvt_pk_bf16_f32 v3, v16, v17
    v_cvt_pk_bf16_f32 v4, v18, v19
    v_lshlrev_b32 v16, 16, v3
    v_and_b32 v17, 0xffff0000, v3
    v_lshlrev_b32 v18, 16, v4
    v_and_b32 v19, 0xffff0000, v4
    ds_write_b128 v76, v[16:19] offset:0
    v_cvt_pk_bf16_f32 v3, v20, v21
    v_cvt_pk_bf16_f32 v4, v22, v23
    v_lshlrev_b32 v20, 16, v3
    v_and_b32 v21, 0xffff0000, v3
    v_lshlrev_b32 v22, 16, v4
    v_and_b32 v23, 0xffff0000, v4
    ds_write_b128 v77, v[20:23] offset:0
    s_mov_b32 s44, 131072
    v_cvt_pk_bf16_f32 v3, v24, v25
    v_cvt_pk_bf16_f32 v4, v26, v27
    v_lshlrev_b32 v24, 16, v3
    v_and_b32 v25, 0xffff0000, v3
    v_lshlrev_b32 v26, 16, v4
    v_and_b32 v27, 0xffff0000, v4
    ds_write_b128 v74, v[24:27] offset:4096
    v_cvt_pk_bf16_f32 v3, v28, v29
    v_cvt_pk_bf16_f32 v4, v30, v31
    v_lshlrev_b32 v28, 16, v3
    v_and_b32 v29, 0xffff0000, v3
    v_lshlrev_b32 v30, 16, v4
    v_and_b32 v31, 0xffff0000, v4
    ds_write_b128 v75, v[28:31] offset:4096
    v_cvt_pk_bf16_f32 v3, v32, v33
    v_cvt_pk_bf16_f32 v4, v34, v35
    v_lshlrev_b32 v32, 16, v3
    v_and_b32 v33, 0xffff0000, v3
    v_lshlrev_b32 v34, 16, v4
    v_and_b32 v35, 0xffff0000, v4
    ds_write_b128 v76, v[32:35] offset:4096
    v_cvt_pk_bf16_f32 v3, v36, v37
    v_cvt_pk_bf16_f32 v4, v38, v39
    v_lshlrev_b32 v36, 16, v3
    v_and_b32 v37, 0xffff0000, v3
    v_lshlrev_b32 v38, 16, v4
    v_and_b32 v39, 0xffff0000, v4
    ds_write_b128 v77, v[36:39] offset:4096
    s_mov_b32 s44, 262144
    v_cvt_pk_bf16_f32 v3, v40, v41
    v_cvt_pk_bf16_f32 v4, v42, v43
    v_lshlrev_b32 v40, 16, v3
    v_and_b32 v41, 0xffff0000, v3
    v_lshlrev_b32 v42, 16, v4
    v_and_b32 v43, 0xffff0000, v4
    ds_write_b128 v74, v[40:43] offset:8192
    v_cvt_pk_bf16_f32 v3, v44, v45
    v_cvt_pk_bf16_f32 v4, v46, v47
    v_lshlrev_b32 v44, 16, v3
    v_and_b32 v45, 0xffff0000, v3
    v_lshlrev_b32 v46, 16, v4
    v_and_b32 v47, 0xffff0000, v4
    ds_write_b128 v75, v[44:47] offset:8192
    v_cvt_pk_bf16_f32 v3, v48, v49
    v_cvt_pk_bf16_f32 v4, v50, v51
    v_lshlrev_b32 v48, 16, v3
    v_and_b32 v49, 0xffff0000, v3
    v_lshlrev_b32 v50, 16, v4
    v_and_b32 v51, 0xffff0000, v4
    ds_write_b128 v76, v[48:51] offset:8192
    v_cvt_pk_bf16_f32 v3, v52, v53
    v_cvt_pk_bf16_f32 v4, v54, v55
    v_lshlrev_b32 v52, 16, v3
    v_and_b32 v53, 0xffff0000, v3
    v_lshlrev_b32 v54, 16, v4
    v_and_b32 v55, 0xffff0000, v4
    ds_write_b128 v77, v[52:55] offset:8192
    s_mov_b32 s44, 393216
    v_cvt_pk_bf16_f32 v3, v56, v57
    v_cvt_pk_bf16_f32 v4, v58, v59
    v_lshlrev_b32 v56, 16, v3
    v_and_b32 v57, 0xffff0000, v3
    v_lshlrev_b32 v58, 16, v4
    v_and_b32 v59, 0xffff0000, v4
    ds_write_b128 v74, v[56:59] offset:12288
    v_cvt_pk_bf16_f32 v3, v60, v61
    v_cvt_pk_bf16_f32 v4, v62, v63
    v_lshlrev_b32 v60, 16, v3
    v_and_b32 v61, 0xffff0000, v3
    v_lshlrev_b32 v62, 16, v4
    v_and_b32 v63, 0xffff0000, v4
    ds_write_b128 v75, v[60:63] offset:12288
    v_cvt_pk_bf16_f32 v3, v64, v65
    v_cvt_pk_bf16_f32 v4, v66, v67
    v_lshlrev_b32 v64, 16, v3
    v_and_b32 v65, 0xffff0000, v3
    v_lshlrev_b32 v66, 16, v4
    v_and_b32 v67, 0xffff0000, v4
    ds_write_b128 v76, v[64:67] offset:12288
    v_cvt_pk_bf16_f32 v3, v68, v69
    v_cvt_pk_bf16_f32 v4, v70, v71
    v_lshlrev_b32 v68, 16, v3
    v_and_b32 v69, 0xffff0000, v3
    v_lshlrev_b32 v70, 16, v4
    v_and_b32 v71, 0xffff0000, v4
    ds_write_b128 v77, v[68:71] offset:12288
    v_lshrrev_b32 v3, 4, v1
    v_xor_b32 v4, v3, v1
    v_and_b32 v4, 15, v4
    v_lshlrev_b32 v5, 8, v3
    v_lshl_add_u32 v5, v4, 4, v5
    v_add_u32 v5, s56, v5
    v_xor_b32 v78, 0, v5
    v_xor_b32 v79, 64, v5
    v_xor_b32 v80, 128, v5
    v_xor_b32 v81, 192, v5
    v_add_u32 v3, s50, v3
    v_lshlrev_b32 v3, 13, v3
    v_and_b32 v4, 15, v1
    v_lshl_add_u32 v3, v4, 4, v3
    s_lshl_b32 s45, s51, 2
    v_add_u32 v3, s45, v3
    s_waitcnt lgkmcnt(0)
    ds_read_b128 v[8:11], v78 offset:0
    ds_read_b128 v[12:15], v79 offset:1024
    ds_read_b128 v[16:19], v80 offset:2048
    ds_read_b128 v[20:23], v81 offset:3072
    ds_read_b128 v[24:27], v78 offset:4096
    ds_read_b128 v[28:31], v79 offset:5120
    ds_read_b128 v[32:35], v80 offset:6144
    ds_read_b128 v[36:39], v81 offset:7168
    ds_read_b128 v[40:43], v78 offset:8192
    ds_read_b128 v[44:47], v79 offset:9216
    ds_read_b128 v[48:51], v80 offset:10240
    ds_read_b128 v[52:55], v81 offset:11264
    ds_read_b128 v[56:59], v78 offset:12288
    ds_read_b128 v[60:63], v79 offset:13312
    ds_read_b128 v[64:67], v80 offset:14336
    ds_read_b128 v[68:71], v81 offset:15360
    s_waitcnt lgkmcnt(15)
    s_mov_b32 s44, 0
    buffer_store_dwordx4 v[8:11], v3, s[52:55], s44 offen sc1
    s_waitcnt lgkmcnt(14)
    s_mov_b32 s44, 32768
    buffer_store_dwordx4 v[12:15], v3, s[52:55], s44 offen sc1
    s_waitcnt lgkmcnt(13)
    s_mov_b32 s44, 65536
    buffer_store_dwordx4 v[16:19], v3, s[52:55], s44 offen sc1
    s_waitcnt lgkmcnt(12)
    s_mov_b32 s44, 98304
    buffer_store_dwordx4 v[20:23], v3, s[52:55], s44 offen sc1
    s_waitcnt lgkmcnt(11)
    s_mov_b32 s44, 131072
    buffer_store_dwordx4 v[24:27], v3, s[52:55], s44 offen sc1
    s_waitcnt lgkmcnt(10)
    s_mov_b32 s44, 163840
    buffer_store_dwordx4 v[28:31], v3, s[52:55], s44 offen sc1
    s_waitcnt lgkmcnt(9)
    s_mov_b32 s44, 196608
    buffer_store_dwordx4 v[32:35], v3, s[52:55], s44 offen sc1
    s_waitcnt lgkmcnt(8)
    s_mov_b32 s44, 229376
    buffer_store_dwordx4 v[36:39], v3, s[52:55], s44 offen sc1
    s_waitcnt lgkmcnt(7)
    s_mov_b32 s44, 262144
    buffer_store_dwordx4 v[40:43], v3, s[52:55], s44 offen sc1
    s_waitcnt lgkmcnt(6)
    s_mov_b32 s44, 294912
    buffer_store_dwordx4 v[44:47], v3, s[52:55], s44 offen sc1
    s_waitcnt lgkmcnt(5)
    s_mov_b32 s44, 327680
    buffer_store_dwordx4 v[48:51], v3, s[52:55], s44 offen sc1
    s_waitcnt lgkmcnt(4)
    s_mov_b32 s44, 360448
    buffer_store_dwordx4 v[52:55], v3, s[52:55], s44 offen sc1
    s_waitcnt lgkmcnt(3)
    s_mov_b32 s44, 393216
    buffer_store_dwordx4 v[56:59], v3, s[52:55], s44 offen sc1
    s_waitcnt lgkmcnt(2)
    s_mov_b32 s44, 425984
    buffer_store_dwordx4 v[60:63], v3, s[52:55], s44 offen sc1
    s_waitcnt lgkmcnt(1)
    s_mov_b32 s44, 458752
    buffer_store_dwordx4 v[64:67], v3, s[52:55], s44 offen sc1
    s_waitcnt lgkmcnt(0)
    s_mov_b32 s44, 491520
    buffer_store_dwordx4 v[68:71], v3, s[52:55], s44 offen sc1
    s_waitcnt vmcnt(0)
    s_endpgm
LsBc_70:
    s_lshr_b32 s40, s36, 1
    s_and_b32 s41, s36, 1
    s_mov_b32 s52, s14
    s_mov_b32 s53, s15
    s_mov_b32 s54, 2048
    s_mov_b32 s55, 0x20000
    s_mov_b32 s56, s16
    s_mov_b32 s57, s17
    s_mov_b32 s58, 2048
    s_mov_b32 s59, 0x20000
    s_mov_b32 s60, s26
    s_mov_b32 s61, s27
    s_mov_b32 s62, 2048
    s_mov_b32 s63, 0x20000
    v_and_b32 v2, 7, v1
    v_lshlrev_b32 v2, 3, v2
    s_lshl_b32 s44, s38, 7
    s_lshl_b32 s45, s41, 6
    s_add_u32 s44, s44, s45
    buffer_load_dwordx2 v[8:9], v2, s[52:55], s44 offen
    buffer_load_dwordx2 v[10:11], v2, s[56:59], s44 offen
    buffer_load_dwordx2 v[12:13], v2, s[60:63], s44 offen
    s_mov_b32 s46, 1069066811
    s_mov_b32 s47, 0x3e22f983
    s_waitcnt vmcnt(0)
    v_lshlrev_b32 v16, 16, v8
    v_and_b32 v17, 0xffff0000, v8
    v_lshlrev_b32 v18, 16, v9
    v_and_b32 v19, 0xffff0000, v9
    v_lshlrev_b32 v20, 16, v10
    v_and_b32 v21, 0xffff0000, v10
    v_lshlrev_b32 v22, 16, v11
    v_and_b32 v23, 0xffff0000, v11
    v_lshlrev_b32 v24, 16, v12
    v_and_b32 v25, 0xffff0000, v12
    v_lshlrev_b32 v26, 16, v13
    v_and_b32 v27, 0xffff0000, v13
    v_mul_f32 v24, s46, v24
    v_mul_f32 v25, s46, v25
    v_mul_f32 v26, s46, v26
    v_mul_f32 v27, s46, v27
    v_exp_f32 v24, v24
    v_exp_f32 v25, v25
    v_exp_f32 v26, v26
    v_exp_f32 v27, v27
    v_cvt_pk_bf16_f32 v8, v24, v25
    v_cvt_pk_bf16_f32 v9, v26, v27
    v_lshlrev_b32 v24, 16, v8
    v_and_b32 v25, 0xffff0000, v8
    v_lshlrev_b32 v26, 16, v9
    v_and_b32 v27, 0xffff0000, v9
    v_mul_f32 v28, v24, v16
    v_mul_f32 v32, v24, v20
    v_mul_f32 v29, v25, v17
    v_mul_f32 v33, v25, v21
    v_mul_f32 v30, v26, v18
    v_mul_f32 v34, v26, v22
    v_mul_f32 v31, v27, v19
    v_mul_f32 v35, v27, v23
    v_mul_f32 v28, s46, v28
    v_mul_f32 v32, s47, v32
    v_mul_f32 v29, s46, v29
    v_mul_f32 v33, s47, v33
    v_mul_f32 v30, s46, v30
    v_mul_f32 v34, s47, v34
    v_mul_f32 v31, s46, v31
    v_mul_f32 v35, s47, v35
    v_exp_f32 v28, v28
    v_fract_f32 v32, v32
    v_exp_f32 v29, v29
    v_fract_f32 v33, v33
    v_exp_f32 v30, v30
    v_fract_f32 v34, v34
    v_exp_f32 v31, v31
    v_fract_f32 v35, v35
    v_cos_f32 v36, v32
    v_sin_f32 v40, v32
    v_cos_f32 v37, v33
    v_sin_f32 v41, v33
    v_cos_f32 v38, v34
    v_sin_f32 v42, v34
    v_cos_f32 v39, v35
    v_sin_f32 v43, v35
    v_mul_f32 v136, v28, v36
    v_mul_f32 v40, v28, v40
    v_mul_f32 v137, v29, v37
    v_mul_f32 v41, v29, v41
    v_mul_f32 v138, v30, v38
    v_mul_f32 v42, v30, v42
    v_mul_f32 v139, v31, v39
    v_mul_f32 v43, v31, v43
    v_add_f32 v36, -1.0, v136
    v_mul_f32 v28, v16, v16
    v_xor_b32 v140, 0x80000000, v40
    v_add_f32 v37, -1.0, v137
    v_mul_f32 v29, v17, v17
    v_xor_b32 v141, 0x80000000, v41
    v_add_f32 v38, -1.0, v138
    v_mul_f32 v30, v18, v18
    v_xor_b32 v142, 0x80000000, v42
    v_add_f32 v39, -1.0, v139
    v_mul_f32 v31, v19, v19
    v_xor_b32 v143, 0x80000000, v43
    v_fma_f32 v28, v20, v20, v28
    v_mul_f32 v144, v36, v16
    v_mul_f32 v148, v40, v16
    v_fma_f32 v29, v21, v21, v29
    v_mul_f32 v145, v37, v17
    v_mul_f32 v149, v41, v17
    v_fma_f32 v30, v22, v22, v30
    v_mul_f32 v146, v38, v18
    v_mul_f32 v150, v42, v18
    v_fma_f32 v31, v23, v23, v31
    v_mul_f32 v147, v39, v19
    v_mul_f32 v151, v43, v19
    v_rcp_f32 v28, v28
    v_fma_f32 v144, v40, v20, v144
    v_fma_f32 v148, -v36, v20, v148
    v_rcp_f32 v29, v29
    v_fma_f32 v145, v41, v21, v145
    v_fma_f32 v149, -v37, v21, v149
    v_rcp_f32 v30, v30
    v_fma_f32 v146, v42, v22, v146
    v_fma_f32 v150, -v38, v22, v150
    v_rcp_f32 v31, v31
    v_fma_f32 v147, v43, v23, v147
    v_fma_f32 v151, -v39, v23, v151
    v_add_f32 v28, v28, v28
    v_add_f32 v29, v29, v29
    v_add_f32 v30, v30, v30
    v_add_f32 v31, v31, v31
    v_mul_f32 v144, v144, v28
    v_mul_f32 v148, v148, -v28
    v_mul_f32 v145, v145, v29
    v_mul_f32 v149, v149, -v29
    v_mul_f32 v146, v146, v30
    v_mul_f32 v150, v150, -v30
    v_mul_f32 v147, v147, v31
    v_mul_f32 v151, v151, -v31
    v_mov_b32 v56, v136
    v_mov_b32 v60, v140
    v_mov_b32 v168, 1.0
    v_mov_b32 v172, 0
    v_mov_b32 v57, v137
    v_mov_b32 v61, v141
    v_mov_b32 v169, 1.0
    v_mov_b32 v173, 0
    v_mov_b32 v58, v138
    v_mov_b32 v62, v142
    v_mov_b32 v170, 1.0
    v_mov_b32 v174, 0
    v_mov_b32 v59, v139
    v_mov_b32 v63, v143
    v_mov_b32 v171, 1.0
    v_mov_b32 v175, 0
    v_pk_mul_f32 v[48:49], v[60:61], v[60:61]
    v_pk_mul_f32 v[52:53], v[60:61], v[56:57]
    v_pk_mul_f32 v[50:51], v[62:63], v[62:63]
    v_pk_mul_f32 v[54:55], v[62:63], v[58:59]
    v_pk_fma_f32 v[48:49], v[56:57], v[56:57], v[48:49] neg_lo:[0,0,1] neg_hi:[0,0,1]
    v_pk_fma_f32 v[52:53], v[56:57], v[60:61], v[52:53]
    v_pk_fma_f32 v[50:51], v[58:59], v[58:59], v[50:51] neg_lo:[0,0,1] neg_hi:[0,0,1]
    v_pk_fma_f32 v[54:55], v[58:59], v[62:63], v[54:55]
    v_mov_b32 v56, v48
    v_mov_b32 v60, v52
    v_mov_b32 v57, v49
    v_mov_b32 v61, v53
    v_mov_b32 v58, v50
    v_mov_b32 v62, v54
    v_mov_b32 v59, v51
    v_mov_b32 v63, v55
    v_pk_mul_f32 v[48:49], v[60:61], v[60:61]
    v_pk_mul_f32 v[52:53], v[60:61], v[56:57]
    v_pk_mul_f32 v[50:51], v[62:63], v[62:63]
    v_pk_mul_f32 v[54:55], v[62:63], v[58:59]
    v_pk_fma_f32 v[48:49], v[56:57], v[56:57], v[48:49] neg_lo:[0,0,1] neg_hi:[0,0,1]
    v_pk_fma_f32 v[52:53], v[56:57], v[60:61], v[52:53]
    v_pk_fma_f32 v[50:51], v[58:59], v[58:59], v[50:51] neg_lo:[0,0,1] neg_hi:[0,0,1]
    v_pk_fma_f32 v[54:55], v[58:59], v[62:63], v[54:55]
    v_mov_b32 v56, v48
    v_mov_b32 v60, v52
    v_mov_b32 v57, v49
    v_mov_b32 v61, v53
    v_mov_b32 v58, v50
    v_mov_b32 v62, v54
    v_mov_b32 v59, v51
    v_mov_b32 v63, v55
    v_pk_mul_f32 v[48:49], v[60:61], v[60:61]
    v_pk_mul_f32 v[52:53], v[60:61], v[56:57]
    v_pk_mul_f32 v[50:51], v[62:63], v[62:63]
    v_pk_mul_f32 v[54:55], v[62:63], v[58:59]
    v_pk_fma_f32 v[48:49], v[56:57], v[56:57], v[48:49] neg_lo:[0,0,1] neg_hi:[0,0,1]
    v_pk_fma_f32 v[52:53], v[56:57], v[60:61], v[52:53]
    v_pk_fma_f32 v[50:51], v[58:59], v[58:59], v[50:51] neg_lo:[0,0,1] neg_hi:[0,0,1]
    v_pk_fma_f32 v[54:55], v[58:59], v[62:63], v[54:55]
    v_mov_b32 v56, v48
    v_mov_b32 v60, v52
    v_mov_b32 v57, v49
    v_mov_b32 v61, v53
    v_mov_b32 v58, v50
    v_mov_b32 v62, v54
    v_mov_b32 v59, v51
    v_mov_b32 v63, v55
    v_pk_mul_f32 v[48:49], v[60:61], v[60:61]
    v_pk_mul_f32 v[52:53], v[60:61], v[56:57]
    v_pk_mul_f32 v[50:51], v[62:63], v[62:63]
    v_pk_mul_f32 v[54:55], v[62:63], v[58:59]
    v_pk_fma_f32 v[48:49], v[56:57], v[56:57], v[48:49] neg_lo:[0,0,1] neg_hi:[0,0,1]
    v_pk_fma_f32 v[52:53], v[56:57], v[60:61], v[52:53]
    v_pk_fma_f32 v[50:51], v[58:59], v[58:59], v[50:51] neg_lo:[0,0,1] neg_hi:[0,0,1]
    v_pk_fma_f32 v[54:55], v[58:59], v[62:63], v[54:55]
    v_mov_b32 v56, v48
    v_mov_b32 v60, v52
    v_mov_b32 v57, v49
    v_mov_b32 v61, v53
    v_mov_b32 v58, v50
    v_mov_b32 v62, v54
    v_mov_b32 v59, v51
    v_mov_b32 v63, v55
    v_mov_b32 v152, v56
    v_mov_b32 v156, v60
    v_mov_b32 v153, v57
    v_mov_b32 v157, v61
    v_mov_b32 v154, v58
    v_mov_b32 v158, v62
    v_mov_b32 v155, v59
    v_mov_b32 v159, v63
    v_lshrrev_b32 v3, 3, v1
    s_lshl_b32 s44, s40, 3
    v_add_u32 v3, s44, v3
    v_mov_b32 v176, v3
    v_pk_mul_f32 v[48:49], v[172:173], v[60:61]
    v_pk_mul_f32 v[52:53], v[172:173], v[56:57]
    v_pk_mul_f32 v[50:51], v[174:175], v[62:63]
    v_pk_mul_f32 v[54:55], v[174:175], v[58:59]
    v_pk_fma_f32 v[48:49], v[168:169], v[56:57], v[48:49] neg_lo:[0,0,1] neg_hi:[0,0,1]
    v_pk_fma_f32 v[52:53], v[168:169], v[60:61], v[52:53]
    v_pk_fma_f32 v[50:51], v[170:171], v[58:59], v[50:51] neg_lo:[0,0,1] neg_hi:[0,0,1]
    v_pk_fma_f32 v[54:55], v[170:171], v[62:63], v[54:55]
    v_mov_b32 v28, v48
    v_mov_b32 v32, v52
    v_mov_b32 v29, v49
    v_mov_b32 v33, v53
    v_mov_b32 v30, v50
    v_mov_b32 v34, v54
    v_mov_b32 v31, v51
    v_mov_b32 v35, v55
    v_and_b32 v4, 1, v176
    v_cmp_ne_u32 vcc, 0, v4
    s_nop 1
    v_cndmask_b32 v168, v168, v28, vcc
    v_cndmask_b32 v172, v172, v32, vcc
    v_cndmask_b32 v169, v169, v29, vcc
    v_cndmask_b32 v173, v173, v33, vcc
    v_cndmask_b32 v170, v170, v30, vcc
    v_cndmask_b32 v174, v174, v34, vcc
    v_cndmask_b32 v171, v171, v31, vcc
    v_cndmask_b32 v175, v175, v35, vcc
    v_pk_mul_f32 v[48:49], v[60:61], v[60:61]
    v_pk_mul_f32 v[52:53], v[60:61], v[56:57]
    v_pk_mul_f32 v[50:51], v[62:63], v[62:63]
    v_pk_mul_f32 v[54:55], v[62:63], v[58:59]
    v_pk_fma_f32 v[48:49], v[56:57], v[56:57], v[48:49] neg_lo:[0,0,1] neg_hi:[0,0,1]
    v_pk_fma_f32 v[52:53], v[56:57], v[60:61], v[52:53]
    v_pk_fma_f32 v[50:51], v[58:59], v[58:59], v[50:51] neg_lo:[0,0,1] neg_hi:[0,0,1]
    v_pk_fma_f32 v[54:55], v[58:59], v[62:63], v[54:55]
    v_mov_b32 v56, v48
    v_mov_b32 v60, v52
    v_mov_b32 v57, v49
    v_mov_b32 v61, v53
    v_mov_b32 v58, v50
    v_mov_b32 v62, v54
    v_mov_b32 v59, v51
    v_mov_b32 v63, v55
    v_pk_mul_f32 v[48:49], v[172:173], v[60:61]
    v_pk_mul_f32 v[52:53], v[172:173], v[56:57]
    v_pk_mul_f32 v[50:51], v[174:175], v[62:63]
    v_pk_mul_f32 v[54:55], v[174:175], v[58:59]
    v_pk_fma_f32 v[48:49], v[168:169], v[56:57], v[48:49] neg_lo:[0,0,1] neg_hi:[0,0,1]
    v_pk_fma_f32 v[52:53], v[168:169], v[60:61], v[52:53]
    v_pk_fma_f32 v[50:51], v[170:171], v[58:59], v[50:51] neg_lo:[0,0,1] neg_hi:[0,0,1]
    v_pk_fma_f32 v[54:55], v[170:171], v[62:63], v[54:55]
    v_mov_b32 v28, v48
    v_mov_b32 v32, v52
    v_mov_b32 v29, v49
    v_mov_b32 v33, v53
    v_mov_b32 v30, v50
    v_mov_b32 v34, v54
    v_mov_b32 v31, v51
    v_mov_b32 v35, v55
    v_and_b32 v4, 2, v176
    v_cmp_ne_u32 vcc, 0, v4
    s_nop 1
    v_cndmask_b32 v168, v168, v28, vcc
    v_cndmask_b32 v172, v172, v32, vcc
    v_cndmask_b32 v169, v169, v29, vcc
    v_cndmask_b32 v173, v173, v33, vcc
    v_cndmask_b32 v170, v170, v30, vcc
    v_cndmask_b32 v174, v174, v34, vcc
    v_cndmask_b32 v171, v171, v31, vcc
    v_cndmask_b32 v175, v175, v35, vcc
    v_pk_mul_f32 v[48:49], v[60:61], v[60:61]
    v_pk_mul_f32 v[52:53], v[60:61], v[56:57]
    v_pk_mul_f32 v[50:51], v[62:63], v[62:63]
    v_pk_mul_f32 v[54:55], v[62:63], v[58:59]
    v_pk_fma_f32 v[48:49], v[56:57], v[56:57], v[48:49] neg_lo:[0,0,1] neg_hi:[0,0,1]
    v_pk_fma_f32 v[52:53], v[56:57], v[60:61], v[52:53]
    v_pk_fma_f32 v[50:51], v[58:59], v[58:59], v[50:51] neg_lo:[0,0,1] neg_hi:[0,0,1]
    v_pk_fma_f32 v[54:55], v[58:59], v[62:63], v[54:55]
    v_mov_b32 v56, v48
    v_mov_b32 v60, v52
    v_mov_b32 v57, v49
    v_mov_b32 v61, v53
    v_mov_b32 v58, v50
    v_mov_b32 v62, v54
    v_mov_b32 v59, v51
    v_mov_b32 v63, v55
    v_pk_mul_f32 v[48:49], v[172:173], v[60:61]
    v_pk_mul_f32 v[52:53], v[172:173], v[56:57]
    v_pk_mul_f32 v[50:51], v[174:175], v[62:63]
    v_pk_mul_f32 v[54:55], v[174:175], v[58:59]
    v_pk_fma_f32 v[48:49], v[168:169], v[56:57], v[48:49] neg_lo:[0,0,1] neg_hi:[0,0,1]
    v_pk_fma_f32 v[52:53], v[168:169], v[60:61], v[52:53]
    v_pk_fma_f32 v[50:51], v[170:171], v[58:59], v[50:51] neg_lo:[0,0,1] neg_hi:[0,0,1]
    v_pk_fma_f32 v[54:55], v[170:171], v[62:63], v[54:55]
    v_mov_b32 v28, v48
    v_mov_b32 v32, v52
    v_mov_b32 v29, v49
    v_mov_b32 v33, v53
    v_mov_b32 v30, v50
    v_mov_b32 v34, v54
    v_mov_b32 v31, v51
    v_mov_b32 v35, v55
    v_and_b32 v4, 4, v176
    v_cmp_ne_u32 vcc, 0, v4
    s_nop 1
    v_cndmask_b32 v168, v168, v28, vcc
    v_cndmask_b32 v172, v172, v32, vcc
    v_cndmask_b32 v169, v169, v29, vcc
    v_cndmask_b32 v173, v173, v33, vcc
    v_cndmask_b32 v170, v170, v30, vcc
    v_cndmask_b32 v174, v174, v34, vcc
    v_cndmask_b32 v171, v171, v31, vcc
    v_cndmask_b32 v175, v175, v35, vcc
    v_pk_mul_f32 v[48:49], v[60:61], v[60:61]
    v_pk_mul_f32 v[52:53], v[60:61], v[56:57]
    v_pk_mul_f32 v[50:51], v[62:63], v[62:63]
    v_pk_mul_f32 v[54:55], v[62:63], v[58:59]
    v_pk_fma_f32 v[48:49], v[56:57], v[56:57], v[48:49] neg_lo:[0,0,1] neg_hi:[0,0,1]
    v_pk_fma_f32 v[52:53], v[56:57], v[60:61], v[52:53]
    v_pk_fma_f32 v[50:51], v[58:59], v[58:59], v[50:51] neg_lo:[0,0,1] neg_hi:[0,0,1]
    v_pk_fma_f32 v[54:55], v[58:59], v[62:63], v[54:55]
    v_mov_b32 v56, v48
    v_mov_b32 v60, v52
    v_mov_b32 v57, v49
    v_mov_b32 v61, v53
    v_mov_b32 v58, v50
    v_mov_b32 v62, v54
    v_mov_b32 v59, v51
    v_mov_b32 v63, v55
    v_pk_mul_f32 v[48:49], v[172:173], v[60:61]
    v_pk_mul_f32 v[52:53], v[172:173], v[56:57]
    v_pk_mul_f32 v[50:51], v[174:175], v[62:63]
    v_pk_mul_f32 v[54:55], v[174:175], v[58:59]
    v_pk_fma_f32 v[48:49], v[168:169], v[56:57], v[48:49] neg_lo:[0,0,1] neg_hi:[0,0,1]
    v_pk_fma_f32 v[52:53], v[168:169], v[60:61], v[52:53]
    v_pk_fma_f32 v[50:51], v[170:171], v[58:59], v[50:51] neg_lo:[0,0,1] neg_hi:[0,0,1]
    v_pk_fma_f32 v[54:55], v[170:171], v[62:63], v[54:55]
    v_mov_b32 v28, v48
    v_mov_b32 v32, v52
    v_mov_b32 v29, v49
    v_mov_b32 v33, v53
    v_mov_b32 v30, v50
    v_mov_b32 v34, v54
    v_mov_b32 v31, v51
    v_mov_b32 v35, v55
    v_and_b32 v4, 8, v176
    v_cmp_ne_u32 vcc, 0, v4
    s_nop 1
    v_cndmask_b32 v168, v168, v28, vcc
    v_cndmask_b32 v172, v172, v32, vcc
    v_cndmask_b32 v169, v169, v29, vcc
    v_cndmask_b32 v173, v173, v33, vcc
    v_cndmask_b32 v170, v170, v30, vcc
    v_cndmask_b32 v174, v174, v34, vcc
    v_cndmask_b32 v171, v171, v31, vcc
    v_cndmask_b32 v175, v175, v35, vcc
    v_pk_mul_f32 v[48:49], v[60:61], v[60:61]
    v_pk_mul_f32 v[52:53], v[60:61], v[56:57]
    v_pk_mul_f32 v[50:51], v[62:63], v[62:63]
    v_pk_mul_f32 v[54:55], v[62:63], v[58:59]
    v_pk_fma_f32 v[48:49], v[56:57], v[56:57], v[48:49] neg_lo:[0,0,1] neg_hi:[0,0,1]
    v_pk_fma_f32 v[52:53], v[56:57], v[60:61], v[52:53]
    v_pk_fma_f32 v[50:51], v[58:59], v[58:59], v[50:51] neg_lo:[0,0,1] neg_hi:[0,0,1]
    v_pk_fma_f32 v[54:55], v[58:59], v[62:63], v[54:55]
    v_mov_b32 v56, v48
    v_mov_b32 v60, v52
    v_mov_b32 v57, v49
    v_mov_b32 v61, v53
    v_mov_b32 v58, v50
    v_mov_b32 v62, v54
    v_mov_b32 v59, v51
    v_mov_b32 v63, v55
    v_lshrrev_b32 v3, 3, v1
    s_sub_u32 s44, s37, 1
    v_sub_u32 v3, s44, v3
    v_mov_b32 v160, 1.0
    v_mov_b32 v164, 0
    v_mov_b32 v161, 1.0
    v_mov_b32 v165, 0
    v_mov_b32 v162, 1.0
    v_mov_b32 v166, 0
    v_mov_b32 v163, 1.0
    v_mov_b32 v167, 0
    v_pk_mul_f32 v[48:49], v[164:165], v[60:61]
    v_pk_mul_f32 v[52:53], v[164:165], v[56:57]
    v_pk_mul_f32 v[50:51], v[166:167], v[62:63]
    v_pk_mul_f32 v[54:55], v[166:167], v[58:59]
    v_pk_fma_f32 v[48:49], v[160:161], v[56:57], v[48:49] neg_lo:[0,0,1] neg_hi:[0,0,1]
    v_pk_fma_f32 v[52:53], v[160:161], v[60:61], v[52:53]
    v_pk_fma_f32 v[50:51], v[162:163], v[58:59], v[50:51] neg_lo:[0,0,1] neg_hi:[0,0,1]
    v_pk_fma_f32 v[54:55], v[162:163], v[62:63], v[54:55]
    v_mov_b32 v28, v48
    v_mov_b32 v32, v52
    v_mov_b32 v29, v49
    v_mov_b32 v33, v53
    v_mov_b32 v30, v50
    v_mov_b32 v34, v54
    v_mov_b32 v31, v51
    v_mov_b32 v35, v55
    v_and_b32 v4, 1, v3
    v_cmp_ne_u32 vcc, 0, v4
    s_nop 1
    v_cndmask_b32 v160, v160, v28, vcc
    v_cndmask_b32 v164, v164, v32, vcc
    v_cndmask_b32 v161, v161, v29, vcc
    v_cndmask_b32 v165, v165, v33, vcc
    v_cndmask_b32 v162, v162, v30, vcc
    v_cndmask_b32 v166, v166, v34, vcc
    v_cndmask_b32 v163, v163, v31, vcc
    v_cndmask_b32 v167, v167, v35, vcc
    v_pk_mul_f32 v[48:49], v[60:61], v[60:61]
    v_pk_mul_f32 v[52:53], v[60:61], v[56:57]
    v_pk_mul_f32 v[50:51], v[62:63], v[62:63]
    v_pk_mul_f32 v[54:55], v[62:63], v[58:59]
    v_pk_fma_f32 v[48:49], v[56:57], v[56:57], v[48:49] neg_lo:[0,0,1] neg_hi:[0,0,1]
    v_pk_fma_f32 v[52:53], v[56:57], v[60:61], v[52:53]
    v_pk_fma_f32 v[50:51], v[58:59], v[58:59], v[50:51] neg_lo:[0,0,1] neg_hi:[0,0,1]
    v_pk_fma_f32 v[54:55], v[58:59], v[62:63], v[54:55]
    v_mov_b32 v56, v48
    v_mov_b32 v60, v52
    v_mov_b32 v57, v49
    v_mov_b32 v61, v53
    v_mov_b32 v58, v50
    v_mov_b32 v62, v54
    v_mov_b32 v59, v51
    v_mov_b32 v63, v55
    v_pk_mul_f32 v[48:49], v[164:165], v[60:61]
    v_pk_mul_f32 v[52:53], v[164:165], v[56:57]
    v_pk_mul_f32 v[50:51], v[166:167], v[62:63]
    v_pk_mul_f32 v[54:55], v[166:167], v[58:59]
    v_pk_fma_f32 v[48:49], v[160:161], v[56:57], v[48:49] neg_lo:[0,0,1] neg_hi:[0,0,1]
    v_pk_fma_f32 v[52:53], v[160:161], v[60:61], v[52:53]
    v_pk_fma_f32 v[50:51], v[162:163], v[58:59], v[50:51] neg_lo:[0,0,1] neg_hi:[0,0,1]
    v_pk_fma_f32 v[54:55], v[162:163], v[62:63], v[54:55]
    v_mov_b32 v28, v48
    v_mov_b32 v32, v52
    v_mov_b32 v29, v49
    v_mov_b32 v33, v53
    v_mov_b32 v30, v50
    v_mov_b32 v34, v54
    v_mov_b32 v31, v51
    v_mov_b32 v35, v55
    v_and_b32 v4, 2, v3
    v_cmp_ne_u32 vcc, 0, v4
    s_nop 1
    v_cndmask_b32 v160, v160, v28, vcc
    v_cndmask_b32 v164, v164, v32, vcc
    v_cndmask_b32 v161, v161, v29, vcc
    v_cndmask_b32 v165, v165, v33, vcc
    v_cndmask_b32 v162, v162, v30, vcc
    v_cndmask_b32 v166, v166, v34, vcc
    v_cndmask_b32 v163, v163, v31, vcc
    v_cndmask_b32 v167, v167, v35, vcc
    v_pk_mul_f32 v[48:49], v[60:61], v[60:61]
    v_pk_mul_f32 v[52:53], v[60:61], v[56:57]
    v_pk_mul_f32 v[50:51], v[62:63], v[62:63]
    v_pk_mul_f32 v[54:55], v[62:63], v[58:59]
    v_pk_fma_f32 v[48:49], v[56:57], v[56:57], v[48:49] neg_lo:[0,0,1] neg_hi:[0,0,1]
    v_pk_fma_f32 v[52:53], v[56:57], v[60:61], v[52:53]
    v_pk_fma_f32 v[50:51], v[58:59], v[58:59], v[50:51] neg_lo:[0,0,1] neg_hi:[0,0,1]
    v_pk_fma_f32 v[54:55], v[58:59], v[62:63], v[54:55]
    v_mov_b32 v56, v48
    v_mov_b32 v60, v52
    v_mov_b32 v57, v49
    v_mov_b32 v61, v53
    v_mov_b32 v58, v50
    v_mov_b32 v62, v54
    v_mov_b32 v59, v51
    v_mov_b32 v63, v55
    v_pk_mul_f32 v[48:49], v[164:165], v[60:61]
    v_pk_mul_f32 v[52:53], v[164:165], v[56:57]
    v_pk_mul_f32 v[50:51], v[166:167], v[62:63]
    v_pk_mul_f32 v[54:55], v[166:167], v[58:59]
    v_pk_fma_f32 v[48:49], v[160:161], v[56:57], v[48:49] neg_lo:[0,0,1] neg_hi:[0,0,1]
    v_pk_fma_f32 v[52:53], v[160:161], v[60:61], v[52:53]
    v_pk_fma_f32 v[50:51], v[162:163], v[58:59], v[50:51] neg_lo:[0,0,1] neg_hi:[0,0,1]
    v_pk_fma_f32 v[54:55], v[162:163], v[62:63], v[54:55]
    v_mov_b32 v28, v48
    v_mov_b32 v32, v52
    v_mov_b32 v29, v49
    v_mov_b32 v33, v53
    v_mov_b32 v30, v50
    v_mov_b32 v34, v54
    v_mov_b32 v31, v51
    v_mov_b32 v35, v55
    v_and_b32 v4, 4, v3
    v_cmp_ne_u32 vcc, 0, v4
    s_nop 1
    v_cndmask_b32 v160, v160, v28, vcc
    v_cndmask_b32 v164, v164, v32, vcc
    v_cndmask_b32 v161, v161, v29, vcc
    v_cndmask_b32 v165, v165, v33, vcc
    v_cndmask_b32 v162, v162, v30, vcc
    v_cndmask_b32 v166, v166, v34, vcc
    v_cndmask_b32 v163, v163, v31, vcc
    v_cndmask_b32 v167, v167, v35, vcc
    v_cmp_gt_i32 vcc, 0, v3
    s_nop 1
    v_cndmask_b32 v160, v160, 0, vcc
    v_cndmask_b32 v164, v164, 0, vcc
    v_cndmask_b32 v161, v161, 0, vcc
    v_cndmask_b32 v165, v165, 0, vcc
    v_cndmask_b32 v162, v162, 0, vcc
    v_cndmask_b32 v166, v166, 0, vcc
    v_cndmask_b32 v163, v163, 0, vcc
    v_cndmask_b32 v167, v167, 0, vcc
    v_and_b32 v2, 15, v1
    v_lshlrev_b32 v2, 7, v2
    v_lshrrev_b32 v3, 4, v1
    v_bfe_u32 v4, v1, 1, 3
    v_xor_b32 v3, v3, v4
    v_lshl_add_u32 v2, v3, 4, v2
    s_mul_i32 s44, s40, 16384
    s_add_u32 s44, s44, 0
    v_add_u32 v2, s44, v2
    v_xor_b32 v177, 0, v2
    v_xor_b32 v178, 64, v2
    v_and_b32 v2, 15, v1
    v_lshlrev_b32 v2, 7, v2
    v_lshrrev_b32 v3, 4, v1
    v_bfe_u32 v4, v1, 1, 3
    v_xor_b32 v3, v3, v4
    v_lshl_add_u32 v2, v3, 4, v2
    s_mul_i32 s44, s41, 8192
    s_add_u32 s44, s44, 32768
    v_add_u32 v2, s44, v2
    v_xor_b32 v181, 0, v2
    v_xor_b32 v182, 64, v2
    s_cmp_eq_u32 s36, 0
    s_cbranch_scc0 Lni_50
    s_mov_b32 s52, s32
    s_mov_b32 s53, s33
    s_mov_b32 s54, 256
    s_mov_b32 s55, 0x20000
    s_memrealtime s[56:57]
    s_waitcnt lgkmcnt(0)
    s_or_b32 s43, s56, 1
    v_mov_b32 v2, s43
    v_mov_b32 v3, 0
    v_mov_b32 v4, 0
    s_mov_b64 s[56:57], exec
    s_mov_b64 exec, 1
    buffer_atomic_cmpswap v[2:3], v4, s[52:55], 0 offen sc0 sc1
    s_mov_b64 exec, s[56:57]
Lni_50:
    v_mov_b32 v8, 0
    v_mov_b32 v9, 0
    v_mov_b32 v10, 0
    v_mov_b32 v11, 0
    v_mov_b32 v12, 0
    v_mov_b32 v13, 0
    v_mov_b32 v14, 0
    v_mov_b32 v15, 0
    v_mov_b32 v16, 0
    v_mov_b32 v17, 0
    v_mov_b32 v18, 0
    v_mov_b32 v19, 0
    v_mov_b32 v20, 0
    v_mov_b32 v21, 0
    v_mov_b32 v22, 0
    v_mov_b32 v23, 0
    v_mov_b32 v24, 0
    v_mov_b32 v25, 0
    v_mov_b32 v26, 0
    v_mov_b32 v27, 0
    v_mov_b32 v28, 0
    v_mov_b32 v29, 0
    v_mov_b32 v30, 0
    v_mov_b32 v31, 0
    v_mov_b32 v32, 0
    v_mov_b32 v33, 0
    v_mov_b32 v34, 0
    v_mov_b32 v35, 0
    v_mov_b32 v36, 0
    v_mov_b32 v37, 0
    v_mov_b32 v38, 0
    v_mov_b32 v39, 0
    v_mov_b32 v40, 0
    v_mov_b32 v41, 0
    v_mov_b32 v42, 0
    v_mov_b32 v43, 0
    v_mov_b32 v44, 0
    v_mov_b32 v45, 0
    v_mov_b32 v46, 0
    v_mov_b32 v47, 0
    v_mov_b32 v48, 0
    v_mov_b32 v49, 0
    v_mov_b32 v50, 0
    v_mov_b32 v51, 0
    v_mov_b32 v52, 0
    v_mov_b32 v53, 0
    v_mov_b32 v54, 0
    v_mov_b32 v55, 0
    v_mov_b32 v56, 0
    v_mov_b32 v57, 0
    v_mov_b32 v58, 0
    v_mov_b32 v59, 0
    v_mov_b32 v60, 0
    v_mov_b32 v61, 0
    v_mov_b32 v62, 0
    v_mov_b32 v63, 0
    v_mov_b32 v64, 0
    v_mov_b32 v65, 0
    v_mov_b32 v66, 0
    v_mov_b32 v67, 0
    v_mov_b32 v68, 0
    v_mov_b32 v69, 0
    v_mov_b32 v70, 0
    v_mov_b32 v71, 0
    v_mov_b32 v72, 0
    v_mov_b32 v73, 0
    v_mov_b32 v74, 0
    v_mov_b32 v75, 0
    v_mov_b32 v76, 0
    v_mov_b32 v77, 0
    v_mov_b32 v78, 0
    v_mov_b32 v79, 0
    v_mov_b32 v80, 0
    v_mov_b32 v81, 0
    v_mov_b32 v82, 0
    v_mov_b32 v83, 0
    v_mov_b32 v84, 0
    v_mov_b32 v85, 0
    v_mov_b32 v86, 0
    v_mov_b32 v87, 0
    v_mov_b32 v88, 0
    v_mov_b32 v89, 0
    v_mov_b32 v90, 0
    v_mov_b32 v91, 0
    v_mov_b32 v92, 0
    v_mov_b32 v93, 0
    v_mov_b32 v94, 0
    v_mov_b32 v95, 0
    v_mov_b32 v96, 0
    v_mov_b32 v97, 0
    v_mov_b32 v98, 0
    v_mov_b32 v99, 0
    v_mov_b32 v100, 0
    v_mov_b32 v101, 0
    v_mov_b32 v102, 0
    v_mov_b32 v103, 0
    v_mov_b32 v104, 0
    v_mov_b32 v105, 0
    v_mov_b32 v106, 0
    v_mov_b32 v107, 0
    v_mov_b32 v108, 0
    v_mov_b32 v109, 0
    v_mov_b32 v110, 0
    v_mov_b32 v111, 0
    v_mov_b32 v112, 0
    v_mov_b32 v113, 0
    v_mov_b32 v114, 0
    v_mov_b32 v115, 0
    v_mov_b32 v116, 0
    v_mov_b32 v117, 0
    v_mov_b32 v118, 0
    v_mov_b32 v119, 0
    v_mov_b32 v120, 0
    v_mov_b32 v121, 0
    v_mov_b32 v122, 0
    v_mov_b32 v123, 0
    v_mov_b32 v124, 0
    v_mov_b32 v125, 0
    v_mov_b32 v126, 0
    v_mov_b32 v127, 0
    v_mov_b32 v128, 0
    v_mov_b32 v129, 0
    v_mov_b32 v130, 0
    v_mov_b32 v131, 0
    v_mov_b32 v132, 0
    v_mov_b32 v133, 0
    v_mov_b32 v134, 0
    v_mov_b32 v135, 0
    s_mov_b32 s48, 0
    v_add_u32 v179, s48, v177
    v_add_u32 v180, s48, v178
    v_add_u32 v183, s48, v181
    v_add_u32 v184, s48, v182
    s_barrier
    ds_read_b128 v[188:191], v179 offset:0
    ds_read_b128 v[192:195], v179 offset:2048
    ds_read_b128 v[196:199], v179 offset:4096
    ds_read_b128 v[200:203], v179 offset:6144
    ds_read_b128 v[220:223], v183 offset:0
    ds_read_b128 v[224:227], v183 offset:2048
    ds_read_b128 v[228:231], v183 offset:4096
    ds_read_b128 v[232:235], v183 offset:6144
    s_mov_b32 s49, 0
Lmm_51:
    s_waitcnt lgkmcnt(0)
    v_mfma_f32_16x16x32_bf16 v[8:11], v[220:223], v[188:191], v[8:11]
    ds_read_b128 v[204:207], v179 offset:8192
    v_mfma_f32_16x16x32_bf16 v[12:15], v[224:227], v[188:191], v[12:15]
    ds_read_b128 v[208:211], v179 offset:10240
    v_mfma_f32_16x16x32_bf16 v[16:19], v[228:231], v[188:191], v[16:19]
    ds_read_b128 v[212:215], v179 offset:12288
    v_mfma_f32_16x16x32_bf16 v[20:23], v[232:235], v[188:191], v[20:23]
    ds_read_b128 v[216:219], v179 offset:14336
    v_mfma_f32_16x16x32_bf16 v[24:27], v[220:223], v[192:195], v[24:27]
    v_mfma_f32_16x16x32_bf16 v[28:31], v[224:227], v[192:195], v[28:31]
    v_mfma_f32_16x16x32_bf16 v[32:35], v[228:231], v[192:195], v[32:35]
    v_mfma_f32_16x16x32_bf16 v[36:39], v[232:235], v[192:195], v[36:39]
    v_mfma_f32_16x16x32_bf16 v[40:43], v[220:223], v[196:199], v[40:43]
    v_mfma_f32_16x16x32_bf16 v[44:47], v[224:227], v[196:199], v[44:47]
    v_mfma_f32_16x16x32_bf16 v[48:51], v[228:231], v[196:199], v[48:51]
    v_mfma_f32_16x16x32_bf16 v[52:55], v[232:235], v[196:199], v[52:55]
    v_mfma_f32_16x16x32_bf16 v[56:59], v[220:223], v[200:203], v[56:59]
    v_mfma_f32_16x16x32_bf16 v[60:63], v[224:227], v[200:203], v[60:63]
    v_mfma_f32_16x16x32_bf16 v[64:67], v[228:231], v[200:203], v[64:67]
    v_mfma_f32_16x16x32_bf16 v[68:71], v[232:235], v[200:203], v[68:71]
    s_waitcnt lgkmcnt(0)
    v_mfma_f32_16x16x32_bf16 v[72:75], v[220:223], v[204:207], v[72:75]
    ds_read_b128 v[188:191], v180 offset:0
    v_mfma_f32_16x16x32_bf16 v[76:79], v[224:227], v[204:207], v[76:79]
    ds_read_b128 v[192:195], v180 offset:2048
    v_mfma_f32_16x16x32_bf16 v[80:83], v[228:231], v[204:207], v[80:83]
    ds_read_b128 v[196:199], v180 offset:4096
    v_mfma_f32_16x16x32_bf16 v[84:87], v[232:235], v[204:207], v[84:87]
    ds_read_b128 v[200:203], v180 offset:6144
    v_mfma_f32_16x16x32_bf16 v[88:91], v[220:223], v[208:211], v[88:91]
    ds_read_b128 v[236:239], v184 offset:0
    v_mfma_f32_16x16x32_bf16 v[92:95], v[224:227], v[208:211], v[92:95]
    ds_read_b128 v[240:243], v184 offset:2048
    v_mfma_f32_16x16x32_bf16 v[96:99], v[228:231], v[208:211], v[96:99]
    ds_read_b128 v[244:247], v184 offset:4096
    v_mfma_f32_16x16x32_bf16 v[100:103], v[232:235], v[208:211], v[100:103]
    ds_read_b128 v[248:251], v184 offset:6144
    v_mfma_f32_16x16x32_bf16 v[104:107], v[220:223], v[212:215], v[104:107]
    v_mfma_f32_16x16x32_bf16 v[108:111], v[224:227], v[212:215], v[108:111]
    v_mfma_f32_16x16x32_bf16 v[112:115], v[228:231], v[212:215], v[112:115]
    v_mfma_f32_16x16x32_bf16 v[116:119], v[232:235], v[212:215], v[116:119]
    v_mfma_f32_16x16x32_bf16 v[120:123], v[220:223], v[216:219], v[120:123]
    v_mfma_f32_16x16x32_bf16 v[124:127], v[224:227], v[216:219], v[124:127]
    v_mfma_f32_16x16x32_bf16 v[128:131], v[228:231], v[216:219], v[128:131]
    v_mfma_f32_16x16x32_bf16 v[132:135], v[232:235], v[216:219], v[132:135]
    s_waitcnt lgkmcnt(0)
    v_mfma_f32_16x16x32_bf16 v[8:11], v[236:239], v[188:191], v[8:11]
    ds_read_b128 v[204:207], v180 offset:8192
    v_mfma_f32_16x16x32_bf16 v[12:15], v[240:243], v[188:191], v[12:15]
    ds_read_b128 v[208:211], v180 offset:10240
    v_mfma_f32_16x16x32_bf16 v[16:19], v[244:247], v[188:191], v[16:19]
    ds_read_b128 v[212:215], v180 offset:12288
    v_mfma_f32_16x16x32_bf16 v[20:23], v[248:251], v[188:191], v[20:23]
    ds_read_b128 v[216:219], v180 offset:14336
    v_mfma_f32_16x16x32_bf16 v[24:27], v[236:239], v[192:195], v[24:27]
    s_add_u32 s48, s48, 49152
    s_cmp_ge_u32 s48, 147456
    s_cselect_b32 s48, 0, s48
    v_mfma_f32_16x16x32_bf16 v[28:31], v[240:243], v[192:195], v[28:31]
    v_add_u32 v179, s48, v177
    v_mfma_f32_16x16x32_bf16 v[32:35], v[244:247], v[192:195], v[32:35]
    v_add_u32 v180, s48, v178
    v_mfma_f32_16x16x32_bf16 v[36:39], v[248:251], v[192:195], v[36:39]
    v_add_u32 v183, s48, v181
    v_mfma_f32_16x16x32_bf16 v[40:43], v[236:239], v[196:199], v[40:43]
    v_add_u32 v184, s48, v182
    v_mfma_f32_16x16x32_bf16 v[44:47], v[240:243], v[196:199], v[44:47]
    v_mfma_f32_16x16x32_bf16 v[48:51], v[244:247], v[196:199], v[48:51]
    v_mfma_f32_16x16x32_bf16 v[52:55], v[248:251], v[196:199], v[52:55]
    v_mfma_f32_16x16x32_bf16 v[56:59], v[236:239], v[200:203], v[56:59]
    v_mfma_f32_16x16x32_bf16 v[60:63], v[240:243], v[200:203], v[60:63]
    v_mfma_f32_16x16x32_bf16 v[64:67], v[244:247], v[200:203], v[64:67]
    v_mfma_f32_16x16x32_bf16 v[68:71], v[248:251], v[200:203], v[68:71]
    s_waitcnt lgkmcnt(0)
    v_mfma_f32_16x16x32_bf16 v[72:75], v[236:239], v[204:207], v[72:75]
    s_barrier
    ds_read_b128 v[188:191], v179 offset:0
    v_mfma_f32_16x16x32_bf16 v[76:79], v[240:243], v[204:207], v[76:79]
    ds_read_b128 v[192:195], v179 offset:2048
    v_mfma_f32_16x16x32_bf16 v[80:83], v[244:247], v[204:207], v[80:83]
    ds_read_b128 v[196:199], v179 offset:4096
    v_mfma_f32_16x16x32_bf16 v[84:87], v[248:251], v[204:207], v[84:87]
    ds_read_b128 v[200:203], v179 offset:6144
    v_mfma_f32_16x16x32_bf16 v[88:91], v[236:239], v[208:211], v[88:91]
    ds_read_b128 v[220:223], v183 offset:0
    v_mfma_f32_16x16x32_bf16 v[92:95], v[240:243], v[208:211], v[92:95]
    ds_read_b128 v[224:227], v183 offset:2048
    v_mfma_f32_16x16x32_bf16 v[96:99], v[244:247], v[208:211], v[96:99]
    ds_read_b128 v[228:231], v183 offset:4096
    v_mfma_f32_16x16x32_bf16 v[100:103], v[248:251], v[208:211], v[100:103]
    ds_read_b128 v[232:235], v183 offset:6144
    v_mfma_f32_16x16x32_bf16 v[104:107], v[236:239], v[212:215], v[104:107]
    v_mfma_f32_16x16x32_bf16 v[108:111], v[240:243], v[212:215], v[108:111]
    v_mfma_f32_16x16x32_bf16 v[112:115], v[244:247], v[212:215], v[112:115]
    v_mfma_f32_16x16x32_bf16 v[116:119], v[248:251], v[212:215], v[116:119]
    v_mfma_f32_16x16x32_bf16 v[120:123], v[236:239], v[216:219], v[120:123]
    v_mfma_f32_16x16x32_bf16 v[124:127], v[240:243], v[216:219], v[124:127]
    v_mfma_f32_16x16x32_bf16 v[128:131], v[244:247], v[216:219], v[128:131]
    v_mfma_f32_16x16x32_bf16 v[132:135], v[248:251], v[216:219], v[132:135]
    s_add_u32 s49, s49, 1
    s_cmp_lt_u32 s49, 16
    s_cbranch_scc1 Lmm_51
    s_waitcnt lgkmcnt(0)
    s_cmp_eq_u32 s36, 0
    s_cbranch_scc0 Lnf_52
    s_waitcnt vmcnt(0)
    v_readfirstlane_b32 s50, v2
    s_nop 0
    s_cmp_eq_u32 s50, 0
    s_cselect_b32 s43, s43, s50
    v_mov_b32 v3, 153616
    v_mov_b32 v2, s43
    ds_write_b32 v3, v2
    s_waitcnt lgkmcnt(0)
Lnf_52:
    s_mul_i32 s50, s36, 34816
    v_and_b32 v2, 15, v1
    v_lshlrev_b32 v2, 7, v2
    v_lshrrev_b32 v3, 4, v1
    v_xor_b32 v3, v3, v1
    v_and_b32 v3, 7, v3
    v_lshl_add_u32 v2, v3, 4, v2
    v_add_u32 v177, s50, v2
    v_xor_b32 v178, 64, v177
    ds_write_b128 v177, v[8:11] offset:0
    ds_write_b128 v178, v[12:15] offset:0
    ds_write_b128 v177, v[16:19] offset:17408
    ds_write_b128 v178, v[20:23] offset:17408
    ds_write_b128 v177, v[24:27] offset:2176
    ds_write_b128 v178, v[28:31] offset:2176
    ds_write_b128 v177, v[32:35] offset:19584
    ds_write_b128 v178, v[36:39] offset:19584
    ds_write_b128 v177, v[40:43] offset:4352
    ds_write_b128 v178, v[44:47] offset:4352
    ds_write_b128 v177, v[48:51] offset:21760
    ds_write_b128 v178, v[52:55] offset:21760
    ds_write_b128 v177, v[56:59] offset:6528
    ds_write_b128 v178, v[60:63] offset:6528
    ds_write_b128 v177, v[64:67] offset:23936
    ds_write_b128 v178, v[68:71] offset:23936
    ds_write_b128 v177, v[72:75] offset:8704
    ds_write_b128 v178, v[76:79] offset:8704
    ds_write_b128 v177, v[80:83] offset:26112
    ds_write_b128 v178, v[84:87] offset:26112
    ds_write_b128 v177, v[88:91] offset:10880
    ds_write_b128 v178, v[92:95] offset:10880
    ds_write_b128 v177, v[96:99] offset:28288
    ds_write_b128 v178, v[100:103] offset:28288
    ds_write_b128 v177, v[104:107] offset:13056
    ds_write_b128 v178, v[108:111] offset:13056
    ds_write_b128 v177, v[112:115] offset:30464
    ds_write_b128 v178, v[116:119] offset:30464
    ds_write_b128 v177, v[120:123] offset:15232
    ds_write_b128 v178, v[124:127] offset:15232
    ds_write_b128 v177, v[128:131] offset:32640
    ds_write_b128 v178, v[132:135] offset:32640
    v_lshrrev_b32 v2, 3, v1
    v_mul_u32_u24 v2, 2176, v2
    v_and_b32 v3, 7, v1
    v_lshl_add_u32 v2, v3, 4, v2
    v_add_u32 v2, s50, v2
    v_xor_b32 v179, 0, v2
    v_xor_b32 v180, 16, v2
    v_xor_b32 v181, 32, v2
    v_xor_b32 v182, 48, v2
    v_xor_b32 v183, 64, v2
    v_xor_b32 v184, 80, v2
    v_xor_b32 v185, 96, v2
    v_xor_b32 v186, 112, v2
    s_waitcnt lgkmcnt(0)
    ds_read_b128 v[8:11], v179 offset:0
    ds_read_b128 v[12:15], v179 offset:17408
    ds_read_b128 v[16:19], v180 offset:128
    ds_read_b128 v[20:23], v180 offset:17536
    ds_read_b128 v[24:27], v181 offset:256
    ds_read_b128 v[28:31], v181 offset:17664
    ds_read_b128 v[32:35], v182 offset:384
    ds_read_b128 v[36:39], v182 offset:17792
    ds_read_b128 v[40:43], v183 offset:512
    ds_read_b128 v[44:47], v183 offset:17920
    ds_read_b128 v[48:51], v184 offset:640
    ds_read_b128 v[52:55], v184 offset:18048
    ds_read_b128 v[56:59], v185 offset:768
    ds_read_b128 v[60:63], v185 offset:18176
    ds_read_b128 v[64:67], v186 offset:896
    ds_read_b128 v[68:71], v186 offset:18304
    ds_read_b128 v[72:75], v179 offset:1024
    ds_read_b128 v[76:79], v179 offset:18432
    ds_read_b128 v[80:83], v180 offset:1152
    ds_read_b128 v[84:87], v180 offset:18560
    ds_read_b128 v[88:91], v181 offset:1280
    ds_read_b128 v[92:95], v181 offset:18688
    ds_read_b128 v[96:99], v182 offset:1408
    ds_read_b128 v[100:103], v182 offset:18816
    ds_read_b128 v[104:107], v183 offset:1536
    ds_read_b128 v[108:111], v183 offset:18944
    ds_read_b128 v[112:115], v184 offset:1664
    ds_read_b128 v[116:119], v184 offset:19072
    ds_read_b128 v[120:123], v185 offset:1792
    ds_read_b128 v[124:127], v185 offset:19200
    ds_read_b128 v[128:131], v186 offset:1920
    ds_read_b128 v[132:135], v186 offset:19328
    s_waitcnt lgkmcnt(14)
    v_mov_b32 v196, v8
    v_xor_b32 v200, 0x80000000, v12
    v_mov_b32 v197, v9
    v_xor_b32 v201, 0x80000000, v13
    v_mov_b32 v198, v10
    v_xor_b32 v202, 0x80000000, v14
    v_mov_b32 v199, v11
    v_xor_b32 v203, 0x80000000, v15
    s_waitcnt lgkmcnt(12)
    v_pk_fma_f32 v[204:205], v[136:137], v[196:197], v[16:17]
    v_pk_fma_f32 v[208:209], v[136:137], v[200:201], v[20:21] neg_lo:[0,0,1] neg_hi:[0,0,1]
    v_pk_fma_f32 v[206:207], v[138:139], v[198:199], v[18:19]
    v_pk_fma_f32 v[210:211], v[138:139], v[202:203], v[22:23] neg_lo:[0,0,1] neg_hi:[0,0,1]
    v_pk_fma_f32 v[204:205], v[140:141], v[200:201], v[204:205] neg_lo:[1,0,0] neg_hi:[1,0,0]
    v_pk_fma_f32 v[208:209], v[140:141], v[196:197], v[208:209]
    v_pk_fma_f32 v[206:207], v[142:143], v[202:203], v[206:207] neg_lo:[1,0,0] neg_hi:[1,0,0]
    v_pk_fma_f32 v[210:211], v[142:143], v[198:199], v[210:211]
    s_waitcnt lgkmcnt(10)
    v_pk_fma_f32 v[196:197], v[136:137], v[204:205], v[24:25]
    v_pk_fma_f32 v[200:201], v[136:137], v[208:209], v[28:29] neg_lo:[0,0,1] neg_hi:[0,0,1]
    v_pk_fma_f32 v[198:199], v[138:139], v[206:207], v[26:27]
    v_pk_fma_f32 v[202:203], v[138:139], v[210:211], v[30:31] neg_lo:[0,0,1] neg_hi:[0,0,1]
    v_pk_fma_f32 v[196:197], v[140:141], v[208:209], v[196:197] neg_lo:[1,0,0] neg_hi:[1,0,0]
    v_pk_fma_f32 v[200:201], v[140:141], v[204:205], v[200:201]
    v_pk_fma_f32 v[198:199], v[142:143], v[210:211], v[198:199] neg_lo:[1,0,0] neg_hi:[1,0,0]
    v_pk_fma_f32 v[202:203], v[142:143], v[206:207], v[202:203]
    s_waitcnt lgkmcnt(8)
    v_pk_fma_f32 v[204:205], v[136:137], v[196:197], v[32:33]
    v_pk_fma_f32 v[208:209], v[136:137], v[200:201], v[36:37] neg_lo:[0,0,1] neg_hi:[0,0,1]
    v_pk_fma_f32 v[206:207], v[138:139], v[198:199], v[34:35]
    v_pk_fma_f32 v[210:211], v[138:139], v[202:203], v[38:39] neg_lo:[0,0,1] neg_hi:[0,0,1]
    v_pk_fma_f32 v[204:205], v[140:141], v[200:201], v[204:205] neg_lo:[1,0,0] neg_hi:[1,0,0]
    v_pk_fma_f32 v[208:209], v[140:141], v[196:197], v[208:209]
    v_pk_fma_f32 v[206:207], v[142:143], v[202:203], v[206:207] neg_lo:[1,0,0] neg_hi:[1,0,0]
    v_pk_fma_f32 v[210:211], v[142:143], v[198:199], v[210:211]
    s_waitcnt lgkmcnt(6)
    v_pk_fma_f32 v[196:197], v[136:137], v[204:205], v[40:41]
    v_pk_fma_f32 v[200:201], v[136:137], v[208:209], v[44:45] neg_lo:[0,0,1] neg_hi:[0,0,1]
    v_pk_fma_f32 v[198:199], v[138:139], v[206:207], v[42:43]
    v_pk_fma_f32 v[202:203], v[138:139], v[210:211], v[46:47] neg_lo:[0,0,1] neg_hi:[0,0,1]
    v_pk_fma_f32 v[196:197], v[140:141], v[208:209], v[196:197] neg_lo:[1,0,0] neg_hi:[1,0,0]
    v_pk_fma_f32 v[200:201], v[140:141], v[204:205], v[200:201]
    v_pk_fma_f32 v[198:199], v[142:143], v[210:211], v[198:199] neg_lo:[1,0,0] neg_hi:[1,0,0]
    v_pk_fma_f32 v[202:203], v[142:143], v[206:207], v[202:203]
    s_waitcnt lgkmcnt(4)
    v_pk_fma_f32 v[204:205], v[136:137], v[196:197], v[48:49]
    v_pk_fma_f32 v[208:209], v[136:137], v[200:201], v[52:53] neg_lo:[0,0,1] neg_hi:[0,0,1]
    v_pk_fma_f32 v[206:207], v[138:139], v[198:199], v[50:51]
    v_pk_fma_f32 v[210:211], v[138:139], v[202:203], v[54:55] neg_lo:[0,0,1] neg_hi:[0,0,1]
    v_pk_fma_f32 v[204:205], v[140:141], v[200:201], v[204:205] neg_lo:[1,0,0] neg_hi:[1,0,0]
    v_pk_fma_f32 v[208:209], v[140:141], v[196:197], v[208:209]
    v_pk_fma_f32 v[206:207], v[142:143], v[202:203], v[206:207] neg_lo:[1,0,0] neg_hi:[1,0,0]
    v_pk_fma_f32 v[210:211], v[142:143], v[198:199], v[210:211]
    s_waitcnt lgkmcnt(2)
    v_pk_fma_f32 v[196:197], v[136:137], v[204:205], v[56:57]
    v_pk_fma_f32 v[200:201], v[136:137], v[208:209], v[60:61] neg_lo:[0,0,1] neg_hi:[0,0,1]
    v_pk_fma_f32 v[198:199], v[138:139], v[206:207], v[58:59]
    v_pk_fma_f32 v[202:203], v[138:139], v[210:211], v[62:63] neg_lo:[0,0,1] neg_hi:[0,0,1]
    v_pk_fma_f32 v[196:197], v[140:141], v[208:209], v[196:197] neg_lo:[1,0,0] neg_hi:[1,0,0]
    v_pk_fma_f32 v[200:201], v[140:141], v[204:205], v[200:201]
    v_pk_fma_f32 v[198:199], v[142:143], v[210:211], v[198:199] neg_lo:[1,0,0] neg_hi:[1,0,0]
    v_pk_fma_f32 v[202:203], v[142:143], v[206:207], v[202:203]
    s_waitcnt lgkmcnt(0)
    v_pk_fma_f32 v[204:205], v[136:137], v[196:197], v[64:65]
    v_pk_fma_f32 v[208:209], v[136:137], v[200:201], v[68:69] neg_lo:[0,0,1] neg_hi:[0,0,1]
    v_pk_fma_f32 v[206:207], v[138:139], v[198:199], v[66:67]
    v_pk_fma_f32 v[210:211], v[138:139], v[202:203], v[70:71] neg_lo:[0,0,1] neg_hi:[0,0,1]
    v_pk_fma_f32 v[204:205], v[140:141], v[200:201], v[204:205] neg_lo:[1,0,0] neg_hi:[1,0,0]
    v_pk_fma_f32 v[208:209], v[140:141], v[196:197], v[208:209]
    v_pk_fma_f32 v[206:207], v[142:143], v[202:203], v[206:207] neg_lo:[1,0,0] neg_hi:[1,0,0]
    v_pk_fma_f32 v[210:211], v[142:143], v[198:199], v[210:211]
    s_waitcnt lgkmcnt(0)
    v_pk_fma_f32 v[196:197], v[136:137], v[204:205], v[72:73]
    v_pk_fma_f32 v[200:201], v[136:137], v[208:209], v[76:77] neg_lo:[0,0,1] neg_hi:[0,0,1]
    v_pk_fma_f32 v[198:199], v[138:139], v[206:207], v[74:75]
    v_pk_fma_f32 v[202:203], v[138:139], v[210:211], v[78:79] neg_lo:[0,0,1] neg_hi:[0,0,1]
    v_pk_fma_f32 v[196:197], v[140:141], v[208:209], v[196:197] neg_lo:[1,0,0] neg_hi:[1,0,0]
    v_pk_fma_f32 v[200:201], v[140:141], v[204:205], v[200:201]
    v_pk_fma_f32 v[198:199], v[142:143], v[210:211], v[198:199] neg_lo:[1,0,0] neg_hi:[1,0,0]
    v_pk_fma_f32 v[202:203], v[142:143], v[206:207], v[202:203]
    v_pk_fma_f32 v[204:205], v[136:137], v[196:197], v[80:81]
    v_pk_fma_f32 v[208:209], v[136:137], v[200:201], v[84:85] neg_lo:[0,0,1] neg_hi:[0,0,1]
    v_pk_fma_f32 v[206:207], v[138:139], v[198:199], v[82:83]
    v_pk_fma_f32 v[210:211], v[138:139], v[202:203], v[86:87] neg_lo:[0,0,1] neg_hi:[0,0,1]
    v_pk_fma_f32 v[204:205], v[140:141], v[200:201], v[204:205] neg_lo:[1,0,0] neg_hi:[1,0,0]
    v_pk_fma_f32 v[208:209], v[140:141], v[196:197], v[208:209]
    v_pk_fma_f32 v[206:207], v[142:143], v[202:203], v[206:207] neg_lo:[1,0,0] neg_hi:[1,0,0]
    v_pk_fma_f32 v[210:211], v[142:143], v[198:199], v[210:211]
    v_pk_fma_f32 v[196:197], v[136:137], v[204:205], v[88:89]
    v_pk_fma_f32 v[200:201], v[136:137], v[208:209], v[92:93] neg_lo:[0,0,1] neg_hi:[0,0,1]
    v_pk_fma_f32 v[198:199], v[138:139], v[206:207], v[90:91]
    v_pk_fma_f32 v[202:203], v[138:139], v[210:211], v[94:95] neg_lo:[0,0,1] neg_hi:[0,0,1]
    v_pk_fma_f32 v[196:197], v[140:141], v[208:209], v[196:197] neg_lo:[1,0,0] neg_hi:[1,0,0]
    v_pk_fma_f32 v[200:201], v[140:141], v[204:205], v[200:201]
    v_pk_fma_f32 v[198:199], v[142:143], v[210:211], v[198:199] neg_lo:[1,0,0] neg_hi:[1,0,0]
    v_pk_fma_f32 v[202:203], v[142:143], v[206:207], v[202:203]
    v_pk_fma_f32 v[204:205], v[136:137], v[196:197], v[96:97]
    v_pk_fma_f32 v[208:209], v[136:137], v[200:201], v[100:101] neg_lo:[0,0,1] neg_hi:[0,0,1]
    v_pk_fma_f32 v[206:207], v[138:139], v[198:199], v[98:99]
    v_pk_fma_f32 v[210:211], v[138:139], v[202:203], v[102:103] neg_lo:[0,0,1] neg_hi:[0,0,1]
    v_pk_fma_f32 v[204:205], v[140:141], v[200:201], v[204:205] neg_lo:[1,0,0] neg_hi:[1,0,0]
    v_pk_fma_f32 v[208:209], v[140:141], v[196:197], v[208:209]
    v_pk_fma_f32 v[206:207], v[142:143], v[202:203], v[206:207] neg_lo:[1,0,0] neg_hi:[1,0,0]
    v_pk_fma_f32 v[210:211], v[142:143], v[198:199], v[210:211]
    v_pk_fma_f32 v[196:197], v[136:137], v[204:205], v[104:105]
    v_pk_fma_f32 v[200:201], v[136:137], v[208:209], v[108:109] neg_lo:[0,0,1] neg_hi:[0,0,1]
    v_pk_fma_f32 v[198:199], v[138:139], v[206:207], v[106:107]
    v_pk_fma_f32 v[202:203], v[138:139], v[210:211], v[110:111] neg_lo:[0,0,1] neg_hi:[0,0,1]
    v_pk_fma_f32 v[196:197], v[140:141], v[208:209], v[196:197] neg_lo:[1,0,0] neg_hi:[1,0,0]
    v_pk_fma_f32 v[200:201], v[140:141], v[204:205], v[200:201]
    v_pk_fma_f32 v[198:199], v[142:143], v[210:211], v[198:199] neg_lo:[1,0,0] neg_hi:[1,0,0]
    v_pk_fma_f32 v[202:203], v[142:143], v[206:207], v[202:203]
    v_pk_fma_f32 v[204:205], v[136:137], v[196:197], v[112:113]
    v_pk_fma_f32 v[208:209], v[136:137], v[200:201], v[116:117] neg_lo:[0,0,1] neg_hi:[0,0,1]
    v_pk_fma_f32 v[206:207], v[138:139], v[198:199], v[114:115]
    v_pk_fma_f32 v[210:211], v[138:139], v[202:203], v[118:119] neg_lo:[0,0,1] neg_hi:[0,0,1]
    v_pk_fma_f32 v[204:205], v[140:141], v[200:201], v[204:205] neg_lo:[1,0,0] neg_hi:[1,0,0]
    v_pk_fma_f32 v[208:209], v[140:141], v[196:197], v[208:209]
    v_pk_fma_f32 v[206:207], v[142:143], v[202:203], v[206:207] neg_lo:[1,0,0] neg_hi:[1,0,0]
    v_pk_fma_f32 v[210:211], v[142:143], v[198:199], v[210:211]
    v_pk_fma_f32 v[196:197], v[136:137], v[204:205], v[120:121]
    v_pk_fma_f32 v[200:201], v[136:137], v[208:209], v[124:125] neg_lo:[0,0,1] neg_hi:[0,0,1]
    v_pk_fma_f32 v[198:199], v[138:139], v[206:207], v[122:123]
    v_pk_fma_f32 v[202:203], v[138:139], v[210:211], v[126:127] neg_lo:[0,0,1] neg_hi:[0,0,1]
    v_pk_fma_f32 v[196:197], v[140:141], v[208:209], v[196:197] neg_lo:[1,0,0] neg_hi:[1,0,0]
    v_pk_fma_f32 v[200:201], v[140:141], v[204:205], v[200:201]
    v_pk_fma_f32 v[198:199], v[142:143], v[210:211], v[198:199] neg_lo:[1,0,0] neg_hi:[1,0,0]
    v_pk_fma_f32 v[202:203], v[142:143], v[206:207], v[202:203]
    v_pk_fma_f32 v[204:205], v[136:137], v[196:197], v[128:129]
    v_pk_fma_f32 v[208:209], v[136:137], v[200:201], v[132:133] neg_lo:[0,0,1] neg_hi:[0,0,1]
    v_pk_fma_f32 v[206:207], v[138:139], v[198:199], v[130:131]
    v_pk_fma_f32 v[210:211], v[138:139], v[202:203], v[134:135] neg_lo:[0,0,1] neg_hi:[0,0,1]
    v_pk_fma_f32 v[204:205], v[140:141], v[200:201], v[204:205] neg_lo:[1,0,0] neg_hi:[1,0,0]
    v_pk_fma_f32 v[208:209], v[140:141], v[196:197], v[208:209]
    v_pk_fma_f32 v[206:207], v[142:143], v[202:203], v[206:207] neg_lo:[1,0,0] neg_hi:[1,0,0]
    v_pk_fma_f32 v[210:211], v[142:143], v[198:199], v[210:211]
    s_lshl_b32 s44, s41, 12
    s_add_u32 s44, s44, 139264
    v_and_b32 v3, 7, v1
    v_lshlrev_b32 v3, 5, v3
    v_add_u32 v3, s44, v3
    v_lshl_add_u32 v2, v176, 8, v3
    ds_write_b128 v2, v[204:207]
    ds_write_b128 v2, v[208:211] offset:16
    s_waitcnt lgkmcnt(0)
    s_barrier
    v_mov_b32 v212, 153616
    ds_read_b32 v212, v212
    s_waitcnt lgkmcnt(0)
    v_readfirstlane_b32 s43, v212
    s_add_u32 s52, s34, 8388608
    s_addc_u32 s53, s35, 0
    s_mov_b32 s54, 131072
    s_mov_b32 s55, 0x20000
    v_and_b32 v2, 7, v1
    v_lshlrev_b32 v2, 6, v2
    s_lshl_b32 s44, s38, 1
    s_add_u32 s44, s44, s41
    s_lshl_b32 s44, s44, 9
    v_add_u32 v2, s44, v2
    s_lshl_b32 s45, s37, 14
    s_cmp_eq_u32 s40, 0
    s_cbranch_scc0 Lpub_53
    ds_read_b128 v[220:223], v3 offset:0
    ds_read_b128 v[224:227], v3 offset:16
    ds_read_b128 v[228:231], v3 offset:256
    ds_read_b128 v[232:235], v3 offset:272
    ds_read_b128 v[188:191], v3 offset:512
    ds_read_b128 v[192:195], v3 offset:528
    s_waitcnt lgkmcnt(4)
    v_mov_b32 v196, v220
    v_mov_b32 v200, v224
    v_mov_b32 v197, v221
    v_mov_b32 v201, v225
    v_mov_b32 v198, v222
    v_mov_b32 v202, v226
    v_mov_b32 v199, v223
    v_mov_b32 v203, v227
    ds_read_b128 v[220:223], v3 offset:768
    ds_read_b128 v[224:227], v3 offset:784
    s_waitcnt lgkmcnt(4)
    v_pk_fma_f32 v[204:205], v[152:153], v[196:197], v[228:229]
    v_pk_fma_f32 v[208:209], v[152:153], v[200:201], v[232:233]
    v_pk_fma_f32 v[206:207], v[154:155], v[198:199], v[230:231]
    v_pk_fma_f32 v[210:211], v[154:155], v[202:203], v[234:235]
    v_pk_fma_f32 v[204:205], v[156:157], v[200:201], v[204:205] neg_lo:[1,0,0] neg_hi:[1,0,0]
    v_pk_fma_f32 v[208:209], v[156:157], v[196:197], v[208:209]
    v_pk_fma_f32 v[206:207], v[158:159], v[202:203], v[206:207] neg_lo:[1,0,0] neg_hi:[1,0,0]
    v_pk_fma_f32 v[210:211], v[158:159], v[198:199], v[210:211]
    ds_read_b128 v[228:231], v3 offset:1024
    ds_read_b128 v[232:235], v3 offset:1040
    s_waitcnt lgkmcnt(4)
    v_pk_fma_f32 v[196:197], v[152:153], v[204:205], v[188:189]
    v_pk_fma_f32 v[200:201], v[152:153], v[208:209], v[192:193]
    v_pk_fma_f32 v[198:199], v[154:155], v[206:207], v[190:191]
    v_pk_fma_f32 v[202:203], v[154:155], v[210:211], v[194:195]
    v_pk_fma_f32 v[196:197], v[156:157], v[208:209], v[196:197] neg_lo:[1,0,0] neg_hi:[1,0,0]
    v_pk_fma_f32 v[200:201], v[156:157], v[204:205], v[200:201]
    v_pk_fma_f32 v[198:199], v[158:159], v[210:211], v[198:199] neg_lo:[1,0,0] neg_hi:[1,0,0]
    v_pk_fma_f32 v[202:203], v[158:159], v[206:207], v[202:203]
    ds_read_b128 v[188:191], v3 offset:1280
    ds_read_b128 v[192:195], v3 offset:1296
    s_waitcnt lgkmcnt(4)
    v_pk_fma_f32 v[204:205], v[152:153], v[196:197], v[220:221]
    v_pk_fma_f32 v[208:209], v[152:153], v[200:201], v[224:225]
    v_pk_fma_f32 v[206:207], v[154:155], v[198:199], v[222:223]
    v_pk_fma_f32 v[210:211], v[154:155], v[202:203], v[226:227]
    v_pk_fma_f32 v[204:205], v[156:157], v[200:201], v[204:205] neg_lo:[1,0,0] neg_hi:[1,0,0]
    v_pk_fma_f32 v[208:209], v[156:157], v[196:197], v[208:209]
    v_pk_fma_f32 v[206:207], v[158:159], v[202:203], v[206:207] neg_lo:[1,0,0] neg_hi:[1,0,0]
    v_pk_fma_f32 v[210:211], v[158:159], v[198:199], v[210:211]
    ds_read_b128 v[220:223], v3 offset:1536
    ds_read_b128 v[224:227], v3 offset:1552
    s_waitcnt lgkmcnt(4)
    v_pk_fma_f32 v[196:197], v[152:153], v[204:205], v[228:229]
    v_pk_fma_f32 v[200:201], v[152:153], v[208:209], v[232:233]
    v_pk_fma_f32 v[198:199], v[154:155], v[206:207], v[230:231]
    v_pk_fma_f32 v[202:203], v[154:155], v[210:211], v[234:235]
    v_pk_fma_f32 v[196:197], v[156:157], v[208:209], v[196:197] neg_lo:[1,0,0] neg_hi:[1,0,0]
    v_pk_fma_f32 v[200:201], v[156:157], v[204:205], v[200:201]
    v_pk_fma_f32 v[198:199], v[158:159], v[210:211], v[198:199] neg_lo:[1,0,0] neg_hi:[1,0,0]
    v_pk_fma_f32 v[202:203], v[158:159], v[206:207], v[202:203]
    ds_read_b128 v[228:231], v3 offset:1792
    ds_read_b128 v[232:235], v3 offset:1808
    s_waitcnt lgkmcnt(4)
    v_pk_fma_f32 v[204:205], v[152:153], v[196:197], v[188:189]
    v_pk_fma_f32 v[208:209], v[152:153], v[200:201], v[192:193]
    v_pk_fma_f32 v[206:207], v[154:155], v[198:199], v[190:191]
    v_pk_fma_f32 v[210:211], v[154:155], v[202:203], v[194:195]
    v_pk_fma_f32 v[204:205], v[156:157], v[200:201], v[204:205] neg_lo:[1,0,0] neg_hi:[1,0,0]
    v_pk_fma_f32 v[208:209], v[156:157], v[196:197], v[208:209]
    v_pk_fma_f32 v[206:207], v[158:159], v[202:203], v[206:207] neg_lo:[1,0,0] neg_hi:[1,0,0]
    v_pk_fma_f32 v[210:211], v[158:159], v[198:199], v[210:211]
    ds_read_b128 v[188:191], v3 offset:2048
    ds_read_b128 v[192:195], v3 offset:2064
    s_waitcnt lgkmcnt(4)
    v_pk_fma_f32 v[196:197], v[152:153], v[204:205], v[220:221]
    v_pk_fma_f32 v[200:201], v[152:153], v[208:209], v[224:225]
    v_pk_fma_f32 v[198:199], v[154:155], v[206:207], v[222:223]
    v_pk_fma_f32 v[202:203], v[154:155], v[210:211], v[226:227]
    v_pk_fma_f32 v[196:197], v[156:157], v[208:209], v[196:197] neg_lo:[1,0,0] neg_hi:[1,0,0]
    v_pk_fma_f32 v[200:201], v[156:157], v[204:205], v[200:201]
    v_pk_fma_f32 v[198:199], v[158:159], v[210:211], v[198:199] neg_lo:[1,0,0] neg_hi:[1,0,0]
    v_pk_fma_f32 v[202:203], v[158:159], v[206:207], v[202:203]
    ds_read_b128 v[220:223], v3 offset:2304
    ds_read_b128 v[224:227], v3 offset:2320
    s_waitcnt lgkmcnt(4)
    v_pk_fma_f32 v[204:205], v[152:153], v[196:197], v[228:229]
    v_pk_fma_f32 v[208:209], v[152:153], v[200:201], v[232:233]
    v_pk_fma_f32 v[206:207], v[154:155], v[198:199], v[230:231]
    v_pk_fma_f32 v[210:211], v[154:155], v[202:203], v[234:235]
    v_pk_fma_f32 v[204:205], v[156:157], v[200:201], v[204:205] neg_lo:[1,0,0] neg_hi:[1,0,0]
    v_pk_fma_f32 v[208:209], v[156:157], v[196:197], v[208:209]
    v_pk_fma_f32 v[206:207], v[158:159], v[202:203], v[206:207] neg_lo:[1,0,0] neg_hi:[1,0,0]
    v_pk_fma_f32 v[210:211], v[158:159], v[198:199], v[210:211]
    ds_read_b128 v[228:231], v3 offset:2560
    ds_read_b128 v[232:235], v3 offset:2576
    s_waitcnt lgkmcnt(4)
    v_pk_fma_f32 v[196:197], v[152:153], v[204:205], v[188:189]
    v_pk_fma_f32 v[200:201], v[152:153], v[208:209], v[192:193]
    v_pk_fma_f32 v[198:199], v[154:155], v[206:207], v[190:191]
    v_pk_fma_f32 v[202:203], v[154:155], v[210:211], v[194:195]
    v_pk_fma_f32 v[196:197], v[156:157], v[208:209], v[196:197] neg_lo:[1,0,0] neg_hi:[1,0,0]
    v_pk_fma_f32 v[200:201], v[156:157], v[204:205], v[200:201]
    v_pk_fma_f32 v[198:199], v[158:159], v[210:211], v[198:199] neg_lo:[1,0,0] neg_hi:[1,0,0]
    v_pk_fma_f32 v[202:203], v[158:159], v[206:207], v[202:203]
    ds_read_b128 v[188:191], v3 offset:2816
    ds_read_b128 v[192:195], v3 offset:2832
    s_waitcnt lgkmcnt(4)
    v_pk_fma_f32 v[204:205], v[152:153], v[196:197], v[220:221]
    v_pk_fma_f32 v[208:209], v[152:153], v[200:201], v[224:225]
    v_pk_fma_f32 v[206:207], v[154:155], v[198:199], v[222:223]
    v_pk_fma_f32 v[210:211], v[154:155], v[202:203], v[226:227]
    v_pk_fma_f32 v[204:205], v[156:157], v[200:201], v[204:205] neg_lo:[1,0,0] neg_hi:[1,0,0]
    v_pk_fma_f32 v[208:209], v[156:157], v[196:197], v[208:209]
    v_pk_fma_f32 v[206:207], v[158:159], v[202:203], v[206:207] neg_lo:[1,0,0] neg_hi:[1,0,0]
    v_pk_fma_f32 v[210:211], v[158:159], v[198:199], v[210:211]
    ds_read_b128 v[220:223], v3 offset:3072
    ds_read_b128 v[224:227], v3 offset:3088
    s_waitcnt lgkmcnt(4)
    v_pk_fma_f32 v[196:197], v[152:153], v[204:205], v[228:229]
    v_pk_fma_f32 v[200:201], v[152:153], v[208:209], v[232:233]
    v_pk_fma_f32 v[198:199], v[154:155], v[206:207], v[230:231]
    v_pk_fma_f32 v[202:203], v[154:155], v[210:211], v[234:235]
    v_pk_fma_f32 v[196:197], v[156:157], v[208:209], v[196:197] neg_lo:[1,0,0] neg_hi:[1,0,0]
    v_pk_fma_f32 v[200:201], v[156:157], v[204:205], v[200:201]
    v_pk_fma_f32 v[198:199], v[158:159], v[210:211], v[198:199] neg_lo:[1,0,0] neg_hi:[1,0,0]
    v_pk_fma_f32 v[202:203], v[158:159], v[206:207], v[202:203]
    ds_read_b128 v[228:231], v3 offset:3328
    ds_read_b128 v[232:235], v3 offset:3344
    s_waitcnt lgkmcnt(4)
    v_pk_fma_f32 v[204:205], v[152:153], v[196:197], v[188:189]
    v_pk_fma_f32 v[208:209], v[152:153], v[200:201], v[192:193]
    v_pk_fma_f32 v[206:207], v[154:155], v[198:199], v[190:191]
    v_pk_fma_f32 v[210:211], v[154:155], v[202:203], v[194:195]
    v_pk_fma_f32 v[204:205], v[156:157], v[200:201], v[204:205] neg_lo:[1,0,0] neg_hi:[1,0,0]
    v_pk_fma_f32 v[208:209], v[156:157], v[196:197], v[208:209]
    v_pk_fma_f32 v[206:207], v[158:159], v[202:203], v[206:207] neg_lo:[1,0,0] neg_hi:[1,0,0]
    v_pk_fma_f32 v[210:211], v[158:159], v[198:199], v[210:211]
    ds_read_b128 v[188:191], v3 offset:3584
    ds_read_b128 v[192:195], v3 offset:3600
    s_waitcnt lgkmcnt(4)
    v_pk_fma_f32 v[196:197], v[152:153], v[204:205], v[220:221]
    v_pk_fma_f32 v[200:201], v[152:153], v[208:209], v[224:225]
    v_pk_fma_f32 v[198:199], v[154:155], v[206:207], v[222:223]
    v_pk_fma_f32 v[202:203], v[154:155], v[210:211], v[226:227]
    v_pk_fma_f32 v[196:197], v[156:157], v[208:209], v[196:197] neg_lo:[1,0,0] neg_hi:[1,0,0]
    v_pk_fma_f32 v[200:201], v[156:157], v[204:205], v[200:201]
    v_pk_fma_f32 v[198:199], v[158:159], v[210:211], v[198:199] neg_lo:[1,0,0] neg_hi:[1,0,0]
    v_pk_fma_f32 v[202:203], v[158:159], v[206:207], v[202:203]
    ds_read_b128 v[220:223], v3 offset:3840
    ds_read_b128 v[224:227], v3 offset:3856
    s_waitcnt lgkmcnt(4)
    v_pk_fma_f32 v[204:205], v[152:153], v[196:197], v[228:229]
    v_pk_fma_f32 v[208:209], v[152:153], v[200:201], v[232:233]
    v_pk_fma_f32 v[206:207], v[154:155], v[198:199], v[230:231]
    v_pk_fma_f32 v[210:211], v[154:155], v[202:203], v[234:235]
    v_pk_fma_f32 v[204:205], v[156:157], v[200:201], v[204:205] neg_lo:[1,0,0] neg_hi:[1,0,0]
    v_pk_fma_f32 v[208:209], v[156:157], v[196:197], v[208:209]
    v_pk_fma_f32 v[206:207], v[158:159], v[202:203], v[206:207] neg_lo:[1,0,0] neg_hi:[1,0,0]
    v_pk_fma_f32 v[210:211], v[158:159], v[198:199], v[210:211]
    s_waitcnt lgkmcnt(2)
    v_pk_fma_f32 v[196:197], v[152:153], v[204:205], v[188:189]
    v_pk_fma_f32 v[200:201], v[152:153], v[208:209], v[192:193]
    v_pk_fma_f32 v[198:199], v[154:155], v[206:207], v[190:191]
    v_pk_fma_f32 v[202:203], v[154:155], v[210:211], v[194:195]
    v_pk_fma_f32 v[196:197], v[156:157], v[208:209], v[196:197] neg_lo:[1,0,0] neg_hi:[1,0,0]
    v_pk_fma_f32 v[200:201], v[156:157], v[204:205], v[200:201]
    v_pk_fma_f32 v[198:199], v[158:159], v[210:211], v[198:199] neg_lo:[1,0,0] neg_hi:[1,0,0]
    v_pk_fma_f32 v[202:203], v[158:159], v[206:207], v[202:203]
    s_waitcnt lgkmcnt(0)
    v_pk_fma_f32 v[204:205], v[152:153], v[196:197], v[220:221]
    v_pk_fma_f32 v[208:209], v[152:153], v[200:201], v[224:225]
    v_pk_fma_f32 v[206:207], v[154:155], v[198:199], v[222:223]
    v_pk_fma_f32 v[210:211], v[154:155], v[202:203], v[226:227]
    v_pk_fma_f32 v[204:205], v[156:157], v[200:201], v[204:205] neg_lo:[1,0,0] neg_hi:[1,0,0]
    v_pk_fma_f32 v[208:209], v[156:157], v[196:197], v[208:209]
    v_pk_fma_f32 v[206:207], v[158:159], v[202:203], v[206:207] neg_lo:[1,0,0] neg_hi:[1,0,0]
    v_pk_fma_f32 v[210:211], v[158:159], v[198:199], v[210:211]
    v_mov_b32 v220, v204
    v_mov_b32 v221, s43
    v_mov_b32 v222, v205
    v_mov_b32 v223, s43
    v_mov_b32 v224, v206
    v_mov_b32 v225, s43
    v_mov_b32 v226, v207
    v_mov_b32 v227, s43
    v_mov_b32 v228, v208
    v_mov_b32 v229, s43
    v_mov_b32 v230, v209
    v_mov_b32 v231, s43
    v_mov_b32 v232, v210
    v_mov_b32 v233, s43
    v_mov_b32 v234, v211
    v_mov_b32 v235, s43
    s_mov_b64 s[56:57], exec
    s_mov_b64 exec, 0xff
    buffer_store_dwordx4 v[220:223], v2, s[52:55], s45 offen offset:0 sc1
    buffer_store_dwordx4 v[224:227], v2, s[52:55], s45 offen offset:16 sc1
    buffer_store_dwordx4 v[228:231], v2, s[52:55], s45 offen offset:32 sc1
    buffer_store_dwordx4 v[232:235], v2, s[52:55], s45 offen offset:48 sc1
    s_mov_b64 exec, s[56:57]
    s_nop 1
Lpub_53:
    v_mov_b32 v212, 0
    v_mov_b32 v216, 0
    v_mov_b32 v213, 0
    v_mov_b32 v217, 0
    v_mov_b32 v214, 0
    v_mov_b32 v218, 0
    v_mov_b32 v215, 0
    v_mov_b32 v219, 0
    ds_read_b128 v[220:223], v3 offset:0
    ds_read_b128 v[224:227], v3 offset:16
    ds_read_b128 v[228:231], v3 offset:256
    ds_read_b128 v[232:235], v3 offset:272
    ds_read_b128 v[188:191], v3 offset:512
    ds_read_b128 v[192:195], v3 offset:528
    s_waitcnt lgkmcnt(4)
    v_mov_b32 v196, v220
    v_mov_b32 v200, v224
    v_mov_b32 v197, v221
    v_mov_b32 v201, v225
    v_mov_b32 v198, v222
    v_mov_b32 v202, v226
    v_mov_b32 v199, v223
    v_mov_b32 v203, v227
    v_cmp_eq_u32 vcc, 1, v176
    s_nop 1
    v_cndmask_b32 v212, v212, v196, vcc
    v_cndmask_b32 v216, v216, v200, vcc
    v_cndmask_b32 v213, v213, v197, vcc
    v_cndmask_b32 v217, v217, v201, vcc
    v_cndmask_b32 v214, v214, v198, vcc
    v_cndmask_b32 v218, v218, v202, vcc
    v_cndmask_b32 v215, v215, v199, vcc
    v_cndmask_b32 v219, v219, v203, vcc
    ds_read_b128 v[220:223], v3 offset:768
    ds_read_b128 v[224:227], v3 offset:784
    s_waitcnt lgkmcnt(4)
    v_pk_fma_f32 v[204:205], v[152:153], v[196:197], v[228:229]
    v_pk_fma_f32 v[208:209], v[152:153], v[200:201], v[232:233]
    v_pk_fma_f32 v[206:207], v[154:155], v[198:199], v[230:231]
    v_pk_fma_f32 v[210:211], v[154:155], v[202:203], v[234:235]
    v_pk_fma_f32 v[204:205], v[156:157], v[200:201], v[204:205] neg_lo:[1,0,0] neg_hi:[1,0,0]
    v_pk_fma_f32 v[208:209], v[156:157], v[196:197], v[208:209]
    v_pk_fma_f32 v[206:207], v[158:159], v[202:203], v[206:207] neg_lo:[1,0,0] neg_hi:[1,0,0]
    v_pk_fma_f32 v[210:211], v[158:159], v[198:199], v[210:211]
    v_cmp_eq_u32 vcc, 2, v176
    s_nop 1
    v_cndmask_b32 v212, v212, v204, vcc
    v_cndmask_b32 v216, v216, v208, vcc
    v_cndmask_b32 v213, v213, v205, vcc
    v_cndmask_b32 v217, v217, v209, vcc
    v_cndmask_b32 v214, v214, v206, vcc
    v_cndmask_b32 v218, v218, v210, vcc
    v_cndmask_b32 v215, v215, v207, vcc
    v_cndmask_b32 v219, v219, v211, vcc
    ds_read_b128 v[228:231], v3 offset:1024
    ds_read_b128 v[232:235], v3 offset:1040
    s_waitcnt lgkmcnt(4)
    v_pk_fma_f32 v[196:197], v[152:153], v[204:205], v[188:189]
    v_pk_fma_f32 v[200:201], v[152:153], v[208:209], v[192:193]
    v_pk_fma_f32 v[198:199], v[154:155], v[206:207], v[190:191]
    v_pk_fma_f32 v[202:203], v[154:155], v[210:211], v[194:195]
    v_pk_fma_f32 v[196:197], v[156:157], v[208:209], v[196:197] neg_lo:[1,0,0] neg_hi:[1,0,0]
    v_pk_fma_f32 v[200:201], v[156:157], v[204:205], v[200:201]
    v_pk_fma_f32 v[198:199], v[158:159], v[210:211], v[198:199] neg_lo:[1,0,0] neg_hi:[1,0,0]
    v_pk_fma_f32 v[202:203], v[158:159], v[206:207], v[202:203]
    v_cmp_eq_u32 vcc, 3, v176
    s_nop 1
    v_cndmask_b32 v212, v212, v196, vcc
    v_cndmask_b32 v216, v216, v200, vcc
    v_cndmask_b32 v213, v213, v197, vcc
    v_cndmask_b32 v217, v217, v201, vcc
    v_cndmask_b32 v214, v214, v198, vcc
    v_cndmask_b32 v218, v218, v202, vcc
    v_cndmask_b32 v215, v215, v199, vcc
    v_cndmask_b32 v219, v219, v203, vcc
    ds_read_b128 v[188:191], v3 offset:1280
    ds_read_b128 v[192:195], v3 offset:1296
    s_waitcnt lgkmcnt(4)
    v_pk_fma_f32 v[204:205], v[152:153], v[196:197], v[220:221]
    v_pk_fma_f32 v[208:209], v[152:153], v[200:201], v[224:225]
    v_pk_fma_f32 v[206:207], v[154:155], v[198:199], v[222:223]
    v_pk_fma_f32 v[210:211], v[154:155], v[202:203], v[226:227]
    v_pk_fma_f32 v[204:205], v[156:157], v[200:201], v[204:205] neg_lo:[1,0,0] neg_hi:[1,0,0]
    v_pk_fma_f32 v[208:209], v[156:157], v[196:197], v[208:209]
    v_pk_fma_f32 v[206:207], v[158:159], v[202:203], v[206:207] neg_lo:[1,0,0] neg_hi:[1,0,0]
    v_pk_fma_f32 v[210:211], v[158:159], v[198:199], v[210:211]
    v_cmp_eq_u32 vcc, 4, v176
    s_nop 1
    v_cndmask_b32 v212, v212, v204, vcc
    v_cndmask_b32 v216, v216, v208, vcc
    v_cndmask_b32 v213, v213, v205, vcc
    v_cndmask_b32 v217, v217, v209, vcc
    v_cndmask_b32 v214, v214, v206, vcc
    v_cndmask_b32 v218, v218, v210, vcc
    v_cndmask_b32 v215, v215, v207, vcc
    v_cndmask_b32 v219, v219, v211, vcc
    ds_read_b128 v[220:223], v3 offset:1536
    ds_read_b128 v[224:227], v3 offset:1552
    s_waitcnt lgkmcnt(4)
    v_pk_fma_f32 v[196:197], v[152:153], v[204:205], v[228:229]
    v_pk_fma_f32 v[200:201], v[152:153], v[208:209], v[232:233]
    v_pk_fma_f32 v[198:199], v[154:155], v[206:207], v[230:231]
    v_pk_fma_f32 v[202:203], v[154:155], v[210:211], v[234:235]
    v_pk_fma_f32 v[196:197], v[156:157], v[208:209], v[196:197] neg_lo:[1,0,0] neg_hi:[1,0,0]
    v_pk_fma_f32 v[200:201], v[156:157], v[204:205], v[200:201]
    v_pk_fma_f32 v[198:199], v[158:159], v[210:211], v[198:199] neg_lo:[1,0,0] neg_hi:[1,0,0]
    v_pk_fma_f32 v[202:203], v[158:159], v[206:207], v[202:203]
    v_cmp_eq_u32 vcc, 5, v176
    s_nop 1
    v_cndmask_b32 v212, v212, v196, vcc
    v_cndmask_b32 v216, v216, v200, vcc
    v_cndmask_b32 v213, v213, v197, vcc
    v_cndmask_b32 v217, v217, v201, vcc
    v_cndmask_b32 v214, v214, v198, vcc
    v_cndmask_b32 v218, v218, v202, vcc
    v_cndmask_b32 v215, v215, v199, vcc
    v_cndmask_b32 v219, v219, v203, vcc
    ds_read_b128 v[228:231], v3 offset:1792
    ds_read_b128 v[232:235], v3 offset:1808
    s_waitcnt lgkmcnt(4)
    v_pk_fma_f32 v[204:205], v[152:153], v[196:197], v[188:189]
    v_pk_fma_f32 v[208:209], v[152:153], v[200:201], v[192:193]
    v_pk_fma_f32 v[206:207], v[154:155], v[198:199], v[190:191]
    v_pk_fma_f32 v[210:211], v[154:155], v[202:203], v[194:195]
    v_pk_fma_f32 v[204:205], v[156:157], v[200:201], v[204:205] neg_lo:[1,0,0] neg_hi:[1,0,0]
    v_pk_fma_f32 v[208:209], v[156:157], v[196:197], v[208:209]
    v_pk_fma_f32 v[206:207], v[158:159], v[202:203], v[206:207] neg_lo:[1,0,0] neg_hi:[1,0,0]
    v_pk_fma_f32 v[210:211], v[158:159], v[198:199], v[210:211]
    v_cmp_eq_u32 vcc, 6, v176
    s_nop 1
    v_cndmask_b32 v212, v212, v204, vcc
    v_cndmask_b32 v216, v216, v208, vcc
    v_cndmask_b32 v213, v213, v205, vcc
    v_cndmask_b32 v217, v217, v209, vcc
    v_cndmask_b32 v214, v214, v206, vcc
    v_cndmask_b32 v218, v218, v210, vcc
    v_cndmask_b32 v215, v215, v207, vcc
    v_cndmask_b32 v219, v219, v211, vcc
    ds_read_b128 v[188:191], v3 offset:2048
    ds_read_b128 v[192:195], v3 offset:2064
    s_waitcnt lgkmcnt(4)
    v_pk_fma_f32 v[196:197], v[152:153], v[204:205], v[220:221]
    v_pk_fma_f32 v[200:201], v[152:153], v[208:209], v[224:225]
    v_pk_fma_f32 v[198:199], v[154:155], v[206:207], v[222:223]
    v_pk_fma_f32 v[202:203], v[154:155], v[210:211], v[226:227]
    v_pk_fma_f32 v[196:197], v[156:157], v[208:209], v[196:197] neg_lo:[1,0,0] neg_hi:[1,0,0]
    v_pk_fma_f32 v[200:201], v[156:157], v[204:205], v[200:201]
    v_pk_fma_f32 v[198:199], v[158:159], v[210:211], v[198:199] neg_lo:[1,0,0] neg_hi:[1,0,0]
    v_pk_fma_f32 v[202:203], v[158:159], v[206:207], v[202:203]
    v_cmp_eq_u32 vcc, 7, v176
    s_nop 1
    v_cndmask_b32 v212, v212, v196, vcc
    v_cndmask_b32 v216, v216, v200, vcc
    v_cndmask_b32 v213, v213, v197, vcc
    v_cndmask_b32 v217, v217, v201, vcc
    v_cndmask_b32 v214, v214, v198, vcc
    v_cndmask_b32 v218, v218, v202, vcc
    v_cndmask_b32 v215, v215, v199, vcc
    v_cndmask_b32 v219, v219, v203, vcc
    ds_read_b128 v[220:223], v3 offset:2304
    ds_read_b128 v[224:227], v3 offset:2320
    s_waitcnt lgkmcnt(4)
    v_pk_fma_f32 v[204:205], v[152:153], v[196:197], v[228:229]
    v_pk_fma_f32 v[208:209], v[152:153], v[200:201], v[232:233]
    v_pk_fma_f32 v[206:207], v[154:155], v[198:199], v[230:231]
    v_pk_fma_f32 v[210:211], v[154:155], v[202:203], v[234:235]
    v_pk_fma_f32 v[204:205], v[156:157], v[200:201], v[204:205] neg_lo:[1,0,0] neg_hi:[1,0,0]
    v_pk_fma_f32 v[208:209], v[156:157], v[196:197], v[208:209]
    v_pk_fma_f32 v[206:207], v[158:159], v[202:203], v[206:207] neg_lo:[1,0,0] neg_hi:[1,0,0]
    v_pk_fma_f32 v[210:211], v[158:159], v[198:199], v[210:211]
    v_cmp_eq_u32 vcc, 8, v176
    s_nop 1
    v_cndmask_b32 v212, v212, v204, vcc
    v_cndmask_b32 v216, v216, v208, vcc
    v_cndmask_b32 v213, v213, v205, vcc
    v_cndmask_b32 v217, v217, v209, vcc
    v_cndmask_b32 v214, v214, v206, vcc
    v_cndmask_b32 v218, v218, v210, vcc
    v_cndmask_b32 v215, v215, v207, vcc
    v_cndmask_b32 v219, v219, v211, vcc
    ds_read_b128 v[228:231], v3 offset:2560
    ds_read_b128 v[232:235], v3 offset:2576
    s_waitcnt lgkmcnt(4)
    v_pk_fma_f32 v[196:197], v[152:153], v[204:205], v[188:189]
    v_pk_fma_f32 v[200:201], v[152:153], v[208:209], v[192:193]
    v_pk_fma_f32 v[198:199], v[154:155], v[206:207], v[190:191]
    v_pk_fma_f32 v[202:203], v[154:155], v[210:211], v[194:195]
    v_pk_fma_f32 v[196:197], v[156:157], v[208:209], v[196:197] neg_lo:[1,0,0] neg_hi:[1,0,0]
    v_pk_fma_f32 v[200:201], v[156:157], v[204:205], v[200:201]
    v_pk_fma_f32 v[198:199], v[158:159], v[210:211], v[198:199] neg_lo:[1,0,0] neg_hi:[1,0,0]
    v_pk_fma_f32 v[202:203], v[158:159], v[206:207], v[202:203]
    v_cmp_eq_u32 vcc, 9, v176
    s_nop 1
    v_cndmask_b32 v212, v212, v196, vcc
    v_cndmask_b32 v216, v216, v200, vcc
    v_cndmask_b32 v213, v213, v197, vcc
    v_cndmask_b32 v217, v217, v201, vcc
    v_cndmask_b32 v214, v214, v198, vcc
    v_cndmask_b32 v218, v218, v202, vcc
    v_cndmask_b32 v215, v215, v199, vcc
    v_cndmask_b32 v219, v219, v203, vcc
    ds_read_b128 v[188:191], v3 offset:2816
    ds_read_b128 v[192:195], v3 offset:2832
    s_waitcnt lgkmcnt(4)
    v_pk_fma_f32 v[204:205], v[152:153], v[196:197], v[220:221]
    v_pk_fma_f32 v[208:209], v[152:153], v[200:201], v[224:225]
    v_pk_fma_f32 v[206:207], v[154:155], v[198:199], v[222:223]
    v_pk_fma_f32 v[210:211], v[154:155], v[202:203], v[226:227]
    v_pk_fma_f32 v[204:205], v[156:157], v[200:201], v[204:205] neg_lo:[1,0,0] neg_hi:[1,0,0]
    v_pk_fma_f32 v[208:209], v[156:157], v[196:197], v[208:209]
    v_pk_fma_f32 v[206:207], v[158:159], v[202:203], v[206:207] neg_lo:[1,0,0] neg_hi:[1,0,0]
    v_pk_fma_f32 v[210:211], v[158:159], v[198:199], v[210:211]
    v_cmp_eq_u32 vcc, 10, v176
    s_nop 1
    v_cndmask_b32 v212, v212, v204, vcc
    v_cndmask_b32 v216, v216, v208, vcc
    v_cndmask_b32 v213, v213, v205, vcc
    v_cndmask_b32 v217, v217, v209, vcc
    v_cndmask_b32 v214, v214, v206, vcc
    v_cndmask_b32 v218, v218, v210, vcc
    v_cndmask_b32 v215, v215, v207, vcc
    v_cndmask_b32 v219, v219, v211, vcc
    ds_read_b128 v[220:223], v3 offset:3072
    ds_read_b128 v[224:227], v3 offset:3088
    s_waitcnt lgkmcnt(4)
    v_pk_fma_f32 v[196:197], v[152:153], v[204:205], v[228:229]
    v_pk_fma_f32 v[200:201], v[152:153], v[208:209], v[232:233]
    v_pk_fma_f32 v[198:199], v[154:155], v[206:207], v[230:231]
    v_pk_fma_f32 v[202:203], v[154:155], v[210:211], v[234:235]
    v_pk_fma_f32 v[196:197], v[156:157], v[208:209], v[196:197] neg_lo:[1,0,0] neg_hi:[1,0,0]
    v_pk_fma_f32 v[200:201], v[156:157], v[204:205], v[200:201]
    v_pk_fma_f32 v[198:199], v[158:159], v[210:211], v[198:199] neg_lo:[1,0,0] neg_hi:[1,0,0]
    v_pk_fma_f32 v[202:203], v[158:159], v[206:207], v[202:203]
    v_cmp_eq_u32 vcc, 11, v176
    s_nop 1
    v_cndmask_b32 v212, v212, v196, vcc
    v_cndmask_b32 v216, v216, v200, vcc
    v_cndmask_b32 v213, v213, v197, vcc
    v_cndmask_b32 v217, v217, v201, vcc
    v_cndmask_b32 v214, v214, v198, vcc
    v_cndmask_b32 v218, v218, v202, vcc
    v_cndmask_b32 v215, v215, v199, vcc
    v_cndmask_b32 v219, v219, v203, vcc
    ds_read_b128 v[228:231], v3 offset:3328
    ds_read_b128 v[232:235], v3 offset:3344
    s_waitcnt lgkmcnt(4)
    v_pk_fma_f32 v[204:205], v[152:153], v[196:197], v[188:189]
    v_pk_fma_f32 v[208:209], v[152:153], v[200:201], v[192:193]
    v_pk_fma_f32 v[206:207], v[154:155], v[198:199], v[190:191]
    v_pk_fma_f32 v[210:211], v[154:155], v[202:203], v[194:195]
    v_pk_fma_f32 v[204:205], v[156:157], v[200:201], v[204:205] neg_lo:[1,0,0] neg_hi:[1,0,0]
    v_pk_fma_f32 v[208:209], v[156:157], v[196:197], v[208:209]
    v_pk_fma_f32 v[206:207], v[158:159], v[202:203], v[206:207] neg_lo:[1,0,0] neg_hi:[1,0,0]
    v_pk_fma_f32 v[210:211], v[158:159], v[198:199], v[210:211]
    v_cmp_eq_u32 vcc, 12, v176
    s_nop 1
    v_cndmask_b32 v212, v212, v204, vcc
    v_cndmask_b32 v216, v216, v208, vcc
    v_cndmask_b32 v213, v213, v205, vcc
    v_cndmask_b32 v217, v217, v209, vcc
    v_cndmask_b32 v214, v214, v206, vcc
    v_cndmask_b32 v218, v218, v210, vcc
    v_cndmask_b32 v215, v215, v207, vcc
    v_cndmask_b32 v219, v219, v211, vcc
    ds_read_b128 v[188:191], v3 offset:3584
    ds_read_b128 v[192:195], v3 offset:3600
    s_waitcnt lgkmcnt(4)
    v_pk_fma_f32 v[196:197], v[152:153], v[204:205], v[220:221]
    v_pk_fma_f32 v[200:201], v[152:153], v[208:209], v[224:225]
    v_pk_fma_f32 v[198:199], v[154:155], v[206:207], v[222:223]
    v_pk_fma_f32 v[202:203], v[154:155], v[210:211], v[226:227]
    v_pk_fma_f32 v[196:197], v[156:157], v[208:209], v[196:197] neg_lo:[1,0,0] neg_hi:[1,0,0]
    v_pk_fma_f32 v[200:201], v[156:157], v[204:205], v[200:201]
    v_pk_fma_f32 v[198:199], v[158:159], v[210:211], v[198:199] neg_lo:[1,0,0] neg_hi:[1,0,0]
    v_pk_fma_f32 v[202:203], v[158:159], v[206:207], v[202:203]
    v_cmp_eq_u32 vcc, 13, v176
    s_nop 1
    v_cndmask_b32 v212, v212, v196, vcc
    v_cndmask_b32 v216, v216, v200, vcc
    v_cndmask_b32 v213, v213, v197, vcc
    v_cndmask_b32 v217, v217, v201, vcc
    v_cndmask_b32 v214, v214, v198, vcc
    v_cndmask_b32 v218, v218, v202, vcc
    v_cndmask_b32 v215, v215, v199, vcc
    v_cndmask_b32 v219, v219, v203, vcc
    s_waitcnt lgkmcnt(2)
    v_pk_fma_f32 v[204:205], v[152:153], v[196:197], v[228:229]
    v_pk_fma_f32 v[208:209], v[152:153], v[200:201], v[232:233]
    v_pk_fma_f32 v[206:207], v[154:155], v[198:199], v[230:231]
    v_pk_fma_f32 v[210:211], v[154:155], v[202:203], v[234:235]
    v_pk_fma_f32 v[204:205], v[156:157], v[200:201], v[204:205] neg_lo:[1,0,0] neg_hi:[1,0,0]
    v_pk_fma_f32 v[208:209], v[156:157], v[196:197], v[208:209]
    v_pk_fma_f32 v[206:207], v[158:159], v[202:203], v[206:207] neg_lo:[1,0,0] neg_hi:[1,0,0]
    v_pk_fma_f32 v[210:211], v[158:159], v[198:199], v[210:211]
    v_cmp_eq_u32 vcc, 14, v176
    s_nop 1
    v_cndmask_b32 v212, v212, v204, vcc
    v_cndmask_b32 v216, v216, v208, vcc
    v_cndmask_b32 v213, v213, v205, vcc
    v_cndmask_b32 v217, v217, v209, vcc
    v_cndmask_b32 v214, v214, v206, vcc
    v_cndmask_b32 v218, v218, v210, vcc
    v_cndmask_b32 v215, v215, v207, vcc
    v_cndmask_b32 v219, v219, v211, vcc
    s_waitcnt lgkmcnt(0)
    v_pk_fma_f32 v[196:197], v[152:153], v[204:205], v[188:189]
    v_pk_fma_f32 v[200:201], v[152:153], v[208:209], v[192:193]
    v_pk_fma_f32 v[198:199], v[154:155], v[206:207], v[190:191]
    v_pk_fma_f32 v[202:203], v[154:155], v[210:211], v[194:195]
    v_pk_fma_f32 v[196:197], v[156:157], v[208:209], v[196:197] neg_lo:[1,0,0] neg_hi:[1,0,0]
    v_pk_fma_f32 v[200:201], v[156:157], v[204:205], v[200:201]
    v_pk_fma_f32 v[198:199], v[158:159], v[210:211], v[198:199] neg_lo:[1,0,0] neg_hi:[1,0,0]
    v_pk_fma_f32 v[202:203], v[158:159], v[206:207], v[202:203]
    v_cmp_eq_u32 vcc, 15, v176
    s_nop 1
    v_cndmask_b32 v212, v212, v196, vcc
    v_cndmask_b32 v216, v216, v200, vcc
    v_cndmask_b32 v213, v213, v197, vcc
    v_cndmask_b32 v217, v217, v201, vcc
    v_cndmask_b32 v214, v214, v198, vcc
    v_cndmask_b32 v218, v218, v202, vcc
    v_cndmask_b32 v215, v215, v199, vcc
    v_cndmask_b32 v219, v219, v203, vcc
    v_pk_mul_f32 v[188:189], v[148:149], v[8:9]
    v_pk_mul_f32 v[8:9], v[144:145], v[8:9]
    v_pk_mul_f32 v[190:191], v[150:151], v[10:11]
    v_pk_mul_f32 v[10:11], v[146:147], v[10:11]
    v_pk_fma_f32 v[8:9], v[148:149], v[12:13], v[8:9]
    v_pk_fma_f32 v[12:13], v[144:145], v[12:13], v[188:189] neg_lo:[1,0,0] neg_hi:[1,0,0]
    v_pk_fma_f32 v[10:11], v[150:151], v[14:15], v[10:11]
    v_pk_fma_f32 v[14:15], v[146:147], v[14:15], v[190:191] neg_lo:[1,0,0] neg_hi:[1,0,0]
    v_pk_mul_f32 v[188:189], v[148:149], v[16:17]
    v_pk_mul_f32 v[16:17], v[144:145], v[16:17]
    v_pk_mul_f32 v[190:191], v[150:151], v[18:19]
    v_pk_mul_f32 v[18:19], v[146:147], v[18:19]
    v_pk_fma_f32 v[16:17], v[148:149], v[20:21], v[16:17]
    v_pk_fma_f32 v[20:21], v[144:145], v[20:21], v[188:189] neg_lo:[1,0,0] neg_hi:[1,0,0]
    v_pk_fma_f32 v[18:19], v[150:151], v[22:23], v[18:19]
    v_pk_fma_f32 v[22:23], v[146:147], v[22:23], v[190:191] neg_lo:[1,0,0] neg_hi:[1,0,0]
    v_pk_mul_f32 v[188:189], v[148:149], v[24:25]
    v_pk_mul_f32 v[24:25], v[144:145], v[24:25]
    v_pk_mul_f32 v[190:191], v[150:151], v[26:27]
    v_pk_mul_f32 v[26:27], v[146:147], v[26:27]
    v_pk_fma_f32 v[24:25], v[148:149], v[28:29], v[24:25]
    v_pk_fma_f32 v[28:29], v[144:145], v[28:29], v[188:189] neg_lo:[1,0,0] neg_hi:[1,0,0]
    v_pk_fma_f32 v[26:27], v[150:151], v[30:31], v[26:27]
    v_pk_fma_f32 v[30:31], v[146:147], v[30:31], v[190:191] neg_lo:[1,0,0] neg_hi:[1,0,0]
    v_pk_mul_f32 v[188:189], v[148:149], v[32:33]
    v_pk_mul_f32 v[32:33], v[144:145], v[32:33]
    v_pk_mul_f32 v[190:191], v[150:151], v[34:35]
    v_pk_mul_f32 v[34:35], v[146:147], v[34:35]
    v_pk_fma_f32 v[32:33], v[148:149], v[36:37], v[32:33]
    v_pk_fma_f32 v[36:37], v[144:145], v[36:37], v[188:189] neg_lo:[1,0,0] neg_hi:[1,0,0]
    v_pk_fma_f32 v[34:35], v[150:151], v[38:39], v[34:35]
    v_pk_fma_f32 v[38:39], v[146:147], v[38:39], v[190:191] neg_lo:[1,0,0] neg_hi:[1,0,0]
    v_pk_mul_f32 v[188:189], v[148:149], v[40:41]
    v_pk_mul_f32 v[40:41], v[144:145], v[40:41]
    v_pk_mul_f32 v[190:191], v[150:151], v[42:43]
    v_pk_mul_f32 v[42:43], v[146:147], v[42:43]
    v_pk_fma_f32 v[40:41], v[148:149], v[44:45], v[40:41]
    v_pk_fma_f32 v[44:45], v[144:145], v[44:45], v[188:189] neg_lo:[1,0,0] neg_hi:[1,0,0]
    v_pk_fma_f32 v[42:43], v[150:151], v[46:47], v[42:43]
    v_pk_fma_f32 v[46:47], v[146:147], v[46:47], v[190:191] neg_lo:[1,0,0] neg_hi:[1,0,0]
    v_pk_mul_f32 v[188:189], v[148:149], v[48:49]
    v_pk_mul_f32 v[48:49], v[144:145], v[48:49]
    v_pk_mul_f32 v[190:191], v[150:151], v[50:51]
    v_pk_mul_f32 v[50:51], v[146:147], v[50:51]
    v_pk_fma_f32 v[48:49], v[148:149], v[52:53], v[48:49]
    v_pk_fma_f32 v[52:53], v[144:145], v[52:53], v[188:189] neg_lo:[1,0,0] neg_hi:[1,0,0]
    v_pk_fma_f32 v[50:51], v[150:151], v[54:55], v[50:51]
    v_pk_fma_f32 v[54:55], v[146:147], v[54:55], v[190:191] neg_lo:[1,0,0] neg_hi:[1,0,0]
    v_pk_mul_f32 v[188:189], v[148:149], v[56:57]
    v_pk_mul_f32 v[56:57], v[144:145], v[56:57]
    v_pk_mul_f32 v[190:191], v[150:151], v[58:59]
    v_pk_mul_f32 v[58:59], v[146:147], v[58:59]
    v_pk_fma_f32 v[56:57], v[148:149], v[60:61], v[56:57]
    v_pk_fma_f32 v[60:61], v[144:145], v[60:61], v[188:189] neg_lo:[1,0,0] neg_hi:[1,0,0]
    v_pk_fma_f32 v[58:59], v[150:151], v[62:63], v[58:59]
    v_pk_fma_f32 v[62:63], v[146:147], v[62:63], v[190:191] neg_lo:[1,0,0] neg_hi:[1,0,0]
    v_pk_mul_f32 v[188:189], v[148:149], v[64:65]
    v_pk_mul_f32 v[64:65], v[144:145], v[64:65]
    v_pk_mul_f32 v[190:191], v[150:151], v[66:67]
    v_pk_mul_f32 v[66:67], v[146:147], v[66:67]
    v_pk_fma_f32 v[64:65], v[148:149], v[68:69], v[64:65]
    v_pk_fma_f32 v[68:69], v[144:145], v[68:69], v[188:189] neg_lo:[1,0,0] neg_hi:[1,0,0]
    v_pk_fma_f32 v[66:67], v[150:151], v[70:71], v[66:67]
    v_pk_fma_f32 v[70:71], v[146:147], v[70:71], v[190:191] neg_lo:[1,0,0] neg_hi:[1,0,0]
    v_pk_mul_f32 v[188:189], v[148:149], v[72:73]
    v_pk_mul_f32 v[72:73], v[144:145], v[72:73]
    v_pk_mul_f32 v[190:191], v[150:151], v[74:75]
    v_pk_mul_f32 v[74:75], v[146:147], v[74:75]
    v_pk_fma_f32 v[72:73], v[148:149], v[76:77], v[72:73]
    v_pk_fma_f32 v[76:77], v[144:145], v[76:77], v[188:189] neg_lo:[1,0,0] neg_hi:[1,0,0]
    v_pk_fma_f32 v[74:75], v[150:151], v[78:79], v[74:75]
    v_pk_fma_f32 v[78:79], v[146:147], v[78:79], v[190:191] neg_lo:[1,0,0] neg_hi:[1,0,0]
    v_pk_mul_f32 v[188:189], v[148:149], v[80:81]
    v_pk_mul_f32 v[80:81], v[144:145], v[80:81]
    v_pk_mul_f32 v[190:191], v[150:151], v[82:83]
    v_pk_mul_f32 v[82:83], v[146:147], v[82:83]
    v_pk_fma_f32 v[80:81], v[148:149], v[84:85], v[80:81]
    v_pk_fma_f32 v[84:85], v[144:145], v[84:85], v[188:189] neg_lo:[1,0,0] neg_hi:[1,0,0]
    v_pk_fma_f32 v[82:83], v[150:151], v[86:87], v[82:83]
    v_pk_fma_f32 v[86:87], v[146:147], v[86:87], v[190:191] neg_lo:[1,0,0] neg_hi:[1,0,0]
    v_pk_mul_f32 v[188:189], v[148:149], v[88:89]
    v_pk_mul_f32 v[88:89], v[144:145], v[88:89]
    v_pk_mul_f32 v[190:191], v[150:151], v[90:91]
    v_pk_mul_f32 v[90:91], v[146:147], v[90:91]
    v_pk_fma_f32 v[88:89], v[148:149], v[92:93], v[88:89]
    v_pk_fma_f32 v[92:93], v[144:145], v[92:93], v[188:189] neg_lo:[1,0,0] neg_hi:[1,0,0]
    v_pk_fma_f32 v[90:91], v[150:151], v[94:95], v[90:91]
    v_pk_fma_f32 v[94:95], v[146:147], v[94:95], v[190:191] neg_lo:[1,0,0] neg_hi:[1,0,0]
    v_pk_mul_f32 v[188:189], v[148:149], v[96:97]
    v_pk_mul_f32 v[96:97], v[144:145], v[96:97]
    v_pk_mul_f32 v[190:191], v[150:151], v[98:99]
    v_pk_mul_f32 v[98:99], v[146:147], v[98:99]
    v_pk_fma_f32 v[96:97], v[148:149], v[100:101], v[96:97]
    v_pk_fma_f32 v[100:101], v[144:145], v[100:101], v[188:189] neg_lo:[1,0,0] neg_hi:[1,0,0]
    v_pk_fma_f32 v[98:99], v[150:151], v[102:103], v[98:99]
    v_pk_fma_f32 v[102:103], v[146:147], v[102:103], v[190:191] neg_lo:[1,0,0] neg_hi:[1,0,0]
    v_pk_mul_f32 v[188:189], v[148:149], v[104:105]
    v_pk_mul_f32 v[104:105], v[144:145], v[104:105]
    v_pk_mul_f32 v[190:191], v[150:151], v[106:107]
    v_pk_mul_f32 v[106:107], v[146:147], v[106:107]
    v_pk_fma_f32 v[104:105], v[148:149], v[108:109], v[104:105]
    v_pk_fma_f32 v[108:109], v[144:145], v[108:109], v[188:189] neg_lo:[1,0,0] neg_hi:[1,0,0]
    v_pk_fma_f32 v[106:107], v[150:151], v[110:111], v[106:107]
    v_pk_fma_f32 v[110:111], v[146:147], v[110:111], v[190:191] neg_lo:[1,0,0] neg_hi:[1,0,0]
    v_pk_mul_f32 v[188:189], v[148:149], v[112:113]
    v_pk_mul_f32 v[112:113], v[144:145], v[112:113]
    v_pk_mul_f32 v[190:191], v[150:151], v[114:115]
    v_pk_mul_f32 v[114:115], v[146:147], v[114:115]
    v_pk_fma_f32 v[112:113], v[148:149], v[116:117], v[112:113]
    v_pk_fma_f32 v[116:117], v[144:145], v[116:117], v[188:189] neg_lo:[1,0,0] neg_hi:[1,0,0]
    v_pk_fma_f32 v[114:115], v[150:151], v[118:119], v[114:115]
    v_pk_fma_f32 v[118:119], v[146:147], v[118:119], v[190:191] neg_lo:[1,0,0] neg_hi:[1,0,0]
    v_pk_mul_f32 v[188:189], v[148:149], v[120:121]
    v_pk_mul_f32 v[120:121], v[144:145], v[120:121]
    v_pk_mul_f32 v[190:191], v[150:151], v[122:123]
    v_pk_mul_f32 v[122:123], v[146:147], v[122:123]
    v_pk_fma_f32 v[120:121], v[148:149], v[124:125], v[120:121]
    v_pk_fma_f32 v[124:125], v[144:145], v[124:125], v[188:189] neg_lo:[1,0,0] neg_hi:[1,0,0]
    v_pk_fma_f32 v[122:123], v[150:151], v[126:127], v[122:123]
    v_pk_fma_f32 v[126:127], v[146:147], v[126:127], v[190:191] neg_lo:[1,0,0] neg_hi:[1,0,0]
    v_pk_mul_f32 v[188:189], v[148:149], v[128:129]
    v_pk_mul_f32 v[128:129], v[144:145], v[128:129]
    v_pk_mul_f32 v[190:191], v[150:151], v[130:131]
    v_pk_mul_f32 v[130:131], v[146:147], v[130:131]
    v_pk_fma_f32 v[128:129], v[148:149], v[132:133], v[128:129]
    v_pk_fma_f32 v[132:133], v[144:145], v[132:133], v[188:189] neg_lo:[1,0,0] neg_hi:[1,0,0]
    v_pk_fma_f32 v[130:131], v[150:151], v[134:135], v[130:131]
    v_pk_fma_f32 v[134:135], v[146:147], v[134:135], v[190:191] neg_lo:[1,0,0] neg_hi:[1,0,0]
    v_lshrrev_b32 v4, 3, v1
    v_lshl_add_u32 v5, v4, 14, v2
    v_cmp_gt_u32 s[58:59], s37, v4
    s_mov_b32 s62, 0
Lgp_54:
    buffer_load_dwordx4 v[220:223], v5, s[52:55], 0 offen offset:0 sc1
    buffer_load_dwordx4 v[224:227], v5, s[52:55], 0 offen offset:16 sc1
    buffer_load_dwordx4 v[228:231], v5, s[52:55], 0 offen offset:32 sc1
    buffer_load_dwordx4 v[232:235], v5, s[52:55], 0 offen offset:48 sc1
    s_waitcnt vmcnt(0)
    v_xor_b32 v196, s43, v221
    v_xor_b32 v197, s43, v223
    v_or_b32 v196, v196, v197
    v_xor_b32 v197, s43, v225
    v_or_b32 v196, v196, v197
    v_xor_b32 v197, s43, v227
    v_or_b32 v196, v196, v197
    v_xor_b32 v197, s43, v229
    v_or_b32 v196, v196, v197
    v_xor_b32 v197, s43, v231
    v_or_b32 v196, v196, v197
    v_xor_b32 v197, s43, v233
    v_or_b32 v196, v196, v197
    v_xor_b32 v197, s43, v235
    v_or_b32 v196, v196, v197
    v_cmp_ne_u32 vcc, 0, v196
    s_nop 0
    s_and_b64 s[60:61], vcc, s[58:59]
    s_cbranch_scc0 Lgpd_55
    s_sleep 2
    s_add_u32 s62, s62, 1
    s_cmp_lt_u32 s62, 0x40000
    s_cbranch_scc1 Lgp_54
Lgpd_55:
    v_cndmask_b32 v204, 0, v220, s[58:59]
    v_cndmask_b32 v205, 0, v222, s[58:59]
    v_cndmask_b32 v206, 0, v224, s[58:59]
    v_cndmask_b32 v207, 0, v226, s[58:59]
    v_cndmask_b32 v208, 0, v228, s[58:59]
    v_cndmask_b32 v209, 0, v230, s[58:59]
    v_cndmask_b32 v210, 0, v232, s[58:59]
    v_cndmask_b32 v211, 0, v234, s[58:59]
    v_mov_b32 v220, v204
    v_mov_b32 v221, v205
    v_mov_b32 v222, v206
    v_mov_b32 v223, v207
    v_mov_b32 v224, v208
    v_mov_b32 v225, v209
    v_mov_b32 v226, v210
    v_mov_b32 v227, v211
    v_pk_mul_f32 v[188:189], v[164:165], v[224:225]
    v_pk_mul_f32 v[192:193], v[164:165], v[220:221]
    v_pk_mul_f32 v[190:191], v[166:167], v[226:227]
    v_pk_mul_f32 v[194:195], v[166:167], v[222:223]
    v_pk_fma_f32 v[188:189], v[160:161], v[220:221], v[188:189] neg_lo:[0,0,1] neg_hi:[0,0,1]
    v_pk_fma_f32 v[192:193], v[160:161], v[224:225], v[192:193]
    v_pk_fma_f32 v[190:191], v[162:163], v[222:223], v[190:191] neg_lo:[0,0,1] neg_hi:[0,0,1]
    v_pk_fma_f32 v[194:195], v[162:163], v[226:227], v[194:195]
    v_mov_b32 v196, v188
    v_mov_b32 v200, v192
    v_mov_b32 v197, v189
    v_mov_b32 v201, v193
    v_mov_b32 v198, v190
    v_mov_b32 v202, v194
    v_mov_b32 v199, v191
    v_mov_b32 v203, v195
    v_add_f32_dpp v204, v196, v196 row_ror:8 row_mask:0xf bank_mask:0xf
    v_add_f32_dpp v205, v197, v197 row_ror:8 row_mask:0xf bank_mask:0xf
    v_add_f32_dpp v206, v198, v198 row_ror:8 row_mask:0xf bank_mask:0xf
    v_add_f32_dpp v207, v199, v199 row_ror:8 row_mask:0xf bank_mask:0xf
    v_add_f32_dpp v208, v200, v200 row_ror:8 row_mask:0xf bank_mask:0xf
    v_add_f32_dpp v209, v201, v201 row_ror:8 row_mask:0xf bank_mask:0xf
    v_add_f32_dpp v210, v202, v202 row_ror:8 row_mask:0xf bank_mask:0xf
    v_add_f32_dpp v211, v203, v203 row_ror:8 row_mask:0xf bank_mask:0xf
    v_mov_b32 v196, v204
    v_mov_b32 v197, v205
    v_mov_b32 v198, v206
    v_mov_b32 v199, v207
    v_mov_b32 v200, v208
    v_mov_b32 v201, v209
    v_mov_b32 v202, v210
    v_mov_b32 v203, v211
    v_permlane16_swap_b32 v204, v196
    v_permlane16_swap_b32 v205, v197
    v_permlane16_swap_b32 v206, v198
    v_permlane16_swap_b32 v207, v199
    v_permlane16_swap_b32 v208, v200
    v_permlane16_swap_b32 v209, v201
    v_permlane16_swap_b32 v210, v202
    v_permlane16_swap_b32 v211, v203
    v_add_f32 v204, v204, v196
    v_add_f32 v205, v205, v197
    v_add_f32 v206, v206, v198
    v_add_f32 v207, v207, v199
    v_add_f32 v208, v208, v200
    v_add_f32 v209, v209, v201
    v_add_f32 v210, v210, v202
    v_add_f32 v211, v211, v203
    v_mov_b32 v196, v204
    v_mov_b32 v197, v205
    v_mov_b32 v198, v206
    v_mov_b32 v199, v207
    v_mov_b32 v200, v208
    v_mov_b32 v201, v209
    v_mov_b32 v202, v210
    v_mov_b32 v203, v211
    v_permlane32_swap_b32 v204, v196
    v_permlane32_swap_b32 v205, v197
    v_permlane32_swap_b32 v206, v198
    v_permlane32_swap_b32 v207, v199
    v_permlane32_swap_b32 v208, v200
    v_permlane32_swap_b32 v209, v201
    v_permlane32_swap_b32 v210, v202
    v_permlane32_swap_b32 v211, v203
    v_add_f32 v204, v204, v196
    v_add_f32 v205, v205, v197
    v_add_f32 v206, v206, v198
    v_add_f32 v207, v207, v199
    v_add_f32 v208, v208, v200
    v_add_f32 v209, v209, v201
    v_add_f32 v210, v210, v202
    v_add_f32 v211, v211, v203
    v_mov_b32 v196, v204
    v_mov_b32 v197, v205
    v_mov_b32 v198, v206
    v_mov_b32 v199, v207
    v_mov_b32 v200, v208
    v_mov_b32 v201, v209
    v_mov_b32 v202, v210
    v_mov_b32 v203, v211
    v_pk_fma_f32 v[204:205], v[168:169], v[196:197], v[212:213]
    v_pk_fma_f32 v[208:209], v[168:169], v[200:201], v[216:217]
    v_pk_fma_f32 v[206:207], v[170:171], v[198:199], v[214:215]
    v_pk_fma_f32 v[210:211], v[170:171], v[202:203], v[218:219]
    v_pk_fma_f32 v[204:205], v[172:173], v[200:201], v[204:205] neg_lo:[1,0,0] neg_hi:[1,0,0]
    v_pk_fma_f32 v[208:209], v[172:173], v[196:197], v[208:209]
    v_pk_fma_f32 v[206:207], v[174:175], v[202:203], v[206:207] neg_lo:[1,0,0] neg_hi:[1,0,0]
    v_pk_fma_f32 v[210:211], v[174:175], v[198:199], v[210:211]
    v_pk_mul_f32 v[188:189], v[208:209], v[148:149]
    v_pk_mul_f32 v[192:193], v[208:209], v[144:145]
    v_pk_mul_f32 v[190:191], v[210:211], v[150:151]
    v_pk_mul_f32 v[194:195], v[210:211], v[146:147]
    v_pk_fma_f32 v[188:189], v[204:205], v[144:145], v[188:189] neg_lo:[0,0,1] neg_hi:[0,0,1]
    v_pk_fma_f32 v[192:193], v[204:205], v[148:149], v[192:193]
    v_pk_fma_f32 v[190:191], v[206:207], v[146:147], v[190:191] neg_lo:[0,0,1] neg_hi:[0,0,1]
    v_pk_fma_f32 v[194:195], v[206:207], v[150:151], v[194:195]
    v_mov_b32 v204, v188
    v_mov_b32 v208, v192
    v_mov_b32 v205, v189
    v_mov_b32 v209, v193
    v_mov_b32 v206, v190
    v_mov_b32 v210, v194
    v_mov_b32 v207, v191
    v_mov_b32 v211, v195
    s_mul_i32 s63, s40, 33280
    v_lshrrev_b32 v3, 3, v1
    v_mul_u32_u24 v3, 4160, v3
    v_and_b32 v4, 7, v1
    v_lshl_add_u32 v4, v4, 3, v3
    s_lshl_b32 s44, s41, 6
    s_add_u32 s44, s44, s63
    v_add_u32 v4, s44, v4
    v_pk_fma_f32 v[8:9], v[136:137], v[204:205], v[8:9]
    v_pk_fma_f32 v[12:13], v[136:137], v[208:209], v[12:13]
    v_pk_fma_f32 v[10:11], v[138:139], v[206:207], v[10:11]
    v_pk_fma_f32 v[14:15], v[138:139], v[210:211], v[14:15]
    v_pk_fma_f32 v[8:9], v[140:141], v[208:209], v[8:9] neg_lo:[1,0,0] neg_hi:[1,0,0]
    v_pk_fma_f32 v[12:13], v[140:141], v[204:205], v[12:13]
    v_pk_fma_f32 v[10:11], v[142:143], v[210:211], v[10:11] neg_lo:[1,0,0] neg_hi:[1,0,0]
    v_pk_fma_f32 v[14:15], v[142:143], v[206:207], v[14:15]
    v_cvt_pk_bf16_f32 v188, v8, v9
    v_cvt_pk_bf16_f32 v189, v10, v11
    v_cvt_pk_bf16_f32 v190, v12, v13
    v_cvt_pk_bf16_f32 v191, v14, v15
    ds_write_b64 v4, v[188:189] offset:0
    ds_write_b64 v4, v[190:191] offset:128
    v_pk_fma_f32 v[16:17], v[136:137], v[8:9], v[16:17]
    v_pk_fma_f32 v[20:21], v[136:137], v[12:13], v[20:21]
    v_pk_fma_f32 v[18:19], v[138:139], v[10:11], v[18:19]
    v_pk_fma_f32 v[22:23], v[138:139], v[14:15], v[22:23]
    v_pk_fma_f32 v[16:17], v[140:141], v[12:13], v[16:17] neg_lo:[1,0,0] neg_hi:[1,0,0]
    v_pk_fma_f32 v[20:21], v[140:141], v[8:9], v[20:21]
    v_pk_fma_f32 v[18:19], v[142:143], v[14:15], v[18:19] neg_lo:[1,0,0] neg_hi:[1,0,0]
    v_pk_fma_f32 v[22:23], v[142:143], v[10:11], v[22:23]
    v_cvt_pk_bf16_f32 v192, v16, v17
    v_cvt_pk_bf16_f32 v193, v18, v19
    v_cvt_pk_bf16_f32 v194, v20, v21
    v_cvt_pk_bf16_f32 v195, v22, v23
    ds_write_b64 v4, v[192:193] offset:256
    ds_write_b64 v4, v[194:195] offset:384
    v_pk_fma_f32 v[24:25], v[136:137], v[16:17], v[24:25]
    v_pk_fma_f32 v[28:29], v[136:137], v[20:21], v[28:29]
    v_pk_fma_f32 v[26:27], v[138:139], v[18:19], v[26:27]
    v_pk_fma_f32 v[30:31], v[138:139], v[22:23], v[30:31]
    v_pk_fma_f32 v[24:25], v[140:141], v[20:21], v[24:25] neg_lo:[1,0,0] neg_hi:[1,0,0]
    v_pk_fma_f32 v[28:29], v[140:141], v[16:17], v[28:29]
    v_pk_fma_f32 v[26:27], v[142:143], v[22:23], v[26:27] neg_lo:[1,0,0] neg_hi:[1,0,0]
    v_pk_fma_f32 v[30:31], v[142:143], v[18:19], v[30:31]
    v_cvt_pk_bf16_f32 v188, v24, v25
    v_cvt_pk_bf16_f32 v189, v26, v27
    v_cvt_pk_bf16_f32 v190, v28, v29
    v_cvt_pk_bf16_f32 v191, v30, v31
    ds_write_b64 v4, v[188:189] offset:512
    ds_write_b64 v4, v[190:191] offset:640
    v_pk_fma_f32 v[32:33], v[136:137], v[24:25], v[32:33]
    v_pk_fma_f32 v[36:37], v[136:137], v[28:29], v[36:37]
    v_pk_fma_f32 v[34:35], v[138:139], v[26:27], v[34:35]
    v_pk_fma_f32 v[38:39], v[138:139], v[30:31], v[38:39]
    v_pk_fma_f32 v[32:33], v[140:141], v[28:29], v[32:33] neg_lo:[1,0,0] neg_hi:[1,0,0]
    v_pk_fma_f32 v[36:37], v[140:141], v[24:25], v[36:37]
    v_pk_fma_f32 v[34:35], v[142:143], v[30:31], v[34:35] neg_lo:[1,0,0] neg_hi:[1,0,0]
    v_pk_fma_f32 v[38:39], v[142:143], v[26:27], v[38:39]
    v_cvt_pk_bf16_f32 v192, v32, v33
    v_cvt_pk_bf16_f32 v193, v34, v35
    v_cvt_pk_bf16_f32 v194, v36, v37
    v_cvt_pk_bf16_f32 v195, v38, v39
    ds_write_b64 v4, v[192:193] offset:768
    ds_write_b64 v4, v[194:195] offset:896
    v_pk_fma_f32 v[40:41], v[136:137], v[32:33], v[40:41]
    v_pk_fma_f32 v[44:45], v[136:137], v[36:37], v[44:45]
    v_pk_fma_f32 v[42:43], v[138:139], v[34:35], v[42:43]
    v_pk_fma_f32 v[46:47], v[138:139], v[38:39], v[46:47]
    v_pk_fma_f32 v[40:41], v[140:141], v[36:37], v[40:41] neg_lo:[1,0,0] neg_hi:[1,0,0]
    v_pk_fma_f32 v[44:45], v[140:141], v[32:33], v[44:45]
    v_pk_fma_f32 v[42:43], v[142:143], v[38:39], v[42:43] neg_lo:[1,0,0] neg_hi:[1,0,0]
    v_pk_fma_f32 v[46:47], v[142:143], v[34:35], v[46:47]
    v_cvt_pk_bf16_f32 v188, v40, v41
    v_cvt_pk_bf16_f32 v189, v42, v43
    v_cvt_pk_bf16_f32 v190, v44, v45
    v_cvt_pk_bf16_f32 v191, v46, v47
    ds_write_b64 v4, v[188:189] offset:1024
    ds_write_b64 v4, v[190:191] offset:1152
    v_pk_fma_f32 v[48:49], v[136:137], v[40:41], v[48:49]
    v_pk_fma_f32 v[52:53], v[136:137], v[44:45], v[52:53]
    v_pk_fma_f32 v[50:51], v[138:139], v[42:43], v[50:51]
    v_pk_fma_f32 v[54:55], v[138:139], v[46:47], v[54:55]
    v_pk_fma_f32 v[48:49], v[140:141], v[44:45], v[48:49] neg_lo:[1,0,0] neg_hi:[1,0,0]
    v_pk_fma_f32 v[52:53], v[140:141], v[40:41], v[52:53]
    v_pk_fma_f32 v[50:51], v[142:143], v[46:47], v[50:51] neg_lo:[1,0,0] neg_hi:[1,0,0]
    v_pk_fma_f32 v[54:55], v[142:143], v[42:43], v[54:55]
    v_cvt_pk_bf16_f32 v192, v48, v49
    v_cvt_pk_bf16_f32 v193, v50, v51
    v_cvt_pk_bf16_f32 v194, v52, v53
    v_cvt_pk_bf16_f32 v195, v54, v55
    ds_write_b64 v4, v[192:193] offset:1280
    ds_write_b64 v4, v[194:195] offset:1408
    v_pk_fma_f32 v[56:57], v[136:137], v[48:49], v[56:57]
    v_pk_fma_f32 v[60:61], v[136:137], v[52:53], v[60:61]
    v_pk_fma_f32 v[58:59], v[138:139], v[50:51], v[58:59]
    v_pk_fma_f32 v[62:63], v[138:139], v[54:55], v[62:63]
    v_pk_fma_f32 v[56:57], v[140:141], v[52:53], v[56:57] neg_lo:[1,0,0] neg_hi:[1,0,0]
    v_pk_fma_f32 v[60:61], v[140:141], v[48:49], v[60:61]
    v_pk_fma_f32 v[58:59], v[142:143], v[54:55], v[58:59] neg_lo:[1,0,0] neg_hi:[1,0,0]
    v_pk_fma_f32 v[62:63], v[142:143], v[50:51], v[62:63]
    v_cvt_pk_bf16_f32 v188, v56, v57
    v_cvt_pk_bf16_f32 v189, v58, v59
    v_cvt_pk_bf16_f32 v190, v60, v61
    v_cvt_pk_bf16_f32 v191, v62, v63
    ds_write_b64 v4, v[188:189] offset:1536
    ds_write_b64 v4, v[190:191] offset:1664
    v_pk_fma_f32 v[64:65], v[136:137], v[56:57], v[64:65]
    v_pk_fma_f32 v[68:69], v[136:137], v[60:61], v[68:69]
    v_pk_fma_f32 v[66:67], v[138:139], v[58:59], v[66:67]
    v_pk_fma_f32 v[70:71], v[138:139], v[62:63], v[70:71]
    v_pk_fma_f32 v[64:65], v[140:141], v[60:61], v[64:65] neg_lo:[1,0,0] neg_hi:[1,0,0]
    v_pk_fma_f32 v[68:69], v[140:141], v[56:57], v[68:69]
    v_pk_fma_f32 v[66:67], v[142:143], v[62:63], v[66:67] neg_lo:[1,0,0] neg_hi:[1,0,0]
    v_pk_fma_f32 v[70:71], v[142:143], v[58:59], v[70:71]
    v_cvt_pk_bf16_f32 v192, v64, v65
    v_cvt_pk_bf16_f32 v193, v66, v67
    v_cvt_pk_bf16_f32 v194, v68, v69
    v_cvt_pk_bf16_f32 v195, v70, v71
    ds_write_b64 v4, v[192:193] offset:1792
    ds_write_b64 v4, v[194:195] offset:1920
    v_pk_fma_f32 v[72:73], v[136:137], v[64:65], v[72:73]
    v_pk_fma_f32 v[76:77], v[136:137], v[68:69], v[76:77]
    v_pk_fma_f32 v[74:75], v[138:139], v[66:67], v[74:75]
    v_pk_fma_f32 v[78:79], v[138:139], v[70:71], v[78:79]
    v_pk_fma_f32 v[72:73], v[140:141], v[68:69], v[72:73] neg_lo:[1,0,0] neg_hi:[1,0,0]
    v_pk_fma_f32 v[76:77], v[140:141], v[64:65], v[76:77]
    v_pk_fma_f32 v[74:75], v[142:143], v[70:71], v[74:75] neg_lo:[1,0,0] neg_hi:[1,0,0]
    v_pk_fma_f32 v[78:79], v[142:143], v[66:67], v[78:79]
    v_cvt_pk_bf16_f32 v188, v72, v73
    v_cvt_pk_bf16_f32 v189, v74, v75
    v_cvt_pk_bf16_f32 v190, v76, v77
    v_cvt_pk_bf16_f32 v191, v78, v79
    ds_write_b64 v4, v[188:189] offset:2048
    ds_write_b64 v4, v[190:191] offset:2176
    v_pk_fma_f32 v[80:81], v[136:137], v[72:73], v[80:81]
    v_pk_fma_f32 v[84:85], v[136:137], v[76:77], v[84:85]
    v_pk_fma_f32 v[82:83], v[138:139], v[74:75], v[82:83]
    v_pk_fma_f32 v[86:87], v[138:139], v[78:79], v[86:87]
    v_pk_fma_f32 v[80:81], v[140:141], v[76:77], v[80:81] neg_lo:[1,0,0] neg_hi:[1,0,0]
    v_pk_fma_f32 v[84:85], v[140:141], v[72:73], v[84:85]
    v_pk_fma_f32 v[82:83], v[142:143], v[78:79], v[82:83] neg_lo:[1,0,0] neg_hi:[1,0,0]
    v_pk_fma_f32 v[86:87], v[142:143], v[74:75], v[86:87]
    v_cvt_pk_bf16_f32 v192, v80, v81
    v_cvt_pk_bf16_f32 v193, v82, v83
    v_cvt_pk_bf16_f32 v194, v84, v85
    v_cvt_pk_bf16_f32 v195, v86, v87
    ds_write_b64 v4, v[192:193] offset:2304
    ds_write_b64 v4, v[194:195] offset:2432
    v_pk_fma_f32 v[88:89], v[136:137], v[80:81], v[88:89]
    v_pk_fma_f32 v[92:93], v[136:137], v[84:85], v[92:93]
    v_pk_fma_f32 v[90:91], v[138:139], v[82:83], v[90:91]
    v_pk_fma_f32 v[94:95], v[138:139], v[86:87], v[94:95]
    v_pk_fma_f32 v[88:89], v[140:141], v[84:85], v[88:89] neg_lo:[1,0,0] neg_hi:[1,0,0]
    v_pk_fma_f32 v[92:93], v[140:141], v[80:81], v[92:93]
    v_pk_fma_f32 v[90:91], v[142:143], v[86:87], v[90:91] neg_lo:[1,0,0] neg_hi:[1,0,0]
    v_pk_fma_f32 v[94:95], v[142:143], v[82:83], v[94:95]
    v_cvt_pk_bf16_f32 v188, v88, v89
    v_cvt_pk_bf16_f32 v189, v90, v91
    v_cvt_pk_bf16_f32 v190, v92, v93
    v_cvt_pk_bf16_f32 v191, v94, v95
    ds_write_b64 v4, v[188:189] offset:2560
    ds_write_b64 v4, v[190:191] offset:2688
    v_pk_fma_f32 v[96:97], v[136:137], v[88:89], v[96:97]
    v_pk_fma_f32 v[100:101], v[136:137], v[92:93], v[100:101]
    v_pk_fma_f32 v[98:99], v[138:139], v[90:91], v[98:99]
    v_pk_fma_f32 v[102:103], v[138:139], v[94:95], v[102:103]
    v_pk_fma_f32 v[96:97], v[140:141], v[92:93], v[96:97] neg_lo:[1,0,0] neg_hi:[1,0,0]
    v_pk_fma_f32 v[100:101], v[140:141], v[88:89], v[100:101]
    v_pk_fma_f32 v[98:99], v[142:143], v[94:95], v[98:99] neg_lo:[1,0,0] neg_hi:[1,0,0]
    v_pk_fma_f32 v[102:103], v[142:143], v[90:91], v[102:103]
    v_cvt_pk_bf16_f32 v192, v96, v97
    v_cvt_pk_bf16_f32 v193, v98, v99
    v_cvt_pk_bf16_f32 v194, v100, v101
    v_cvt_pk_bf16_f32 v195, v102, v103
    ds_write_b64 v4, v[192:193] offset:2816
    ds_write_b64 v4, v[194:195] offset:2944
    v_pk_fma_f32 v[104:105], v[136:137], v[96:97], v[104:105]
    v_pk_fma_f32 v[108:109], v[136:137], v[100:101], v[108:109]
    v_pk_fma_f32 v[106:107], v[138:139], v[98:99], v[106:107]
    v_pk_fma_f32 v[110:111], v[138:139], v[102:103], v[110:111]
    v_pk_fma_f32 v[104:105], v[140:141], v[100:101], v[104:105] neg_lo:[1,0,0] neg_hi:[1,0,0]
    v_pk_fma_f32 v[108:109], v[140:141], v[96:97], v[108:109]
    v_pk_fma_f32 v[106:107], v[142:143], v[102:103], v[106:107] neg_lo:[1,0,0] neg_hi:[1,0,0]
    v_pk_fma_f32 v[110:111], v[142:143], v[98:99], v[110:111]
    v_cvt_pk_bf16_f32 v188, v104, v105
    v_cvt_pk_bf16_f32 v189, v106, v107
    v_cvt_pk_bf16_f32 v190, v108, v109
    v_cvt_pk_bf16_f32 v191, v110, v111
    ds_write_b64 v4, v[188:189] offset:3072
    ds_write_b64 v4, v[190:191] offset:3200
    v_pk_fma_f32 v[112:113], v[136:137], v[104:105], v[112:113]
    v_pk_fma_f32 v[116:117], v[136:137], v[108:109], v[116:117]
    v_pk_fma_f32 v[114:115], v[138:139], v[106:107], v[114:115]
    v_pk_fma_f32 v[118:119], v[138:139], v[110:111], v[118:119]
    v_pk_fma_f32 v[112:113], v[140:141], v[108:109], v[112:113] neg_lo:[1,0,0] neg_hi:[1,0,0]
    v_pk_fma_f32 v[116:117], v[140:141], v[104:105], v[116:117]
    v_pk_fma_f32 v[114:115], v[142:143], v[110:111], v[114:115] neg_lo:[1,0,0] neg_hi:[1,0,0]
    v_pk_fma_f32 v[118:119], v[142:143], v[106:107], v[118:119]
    v_cvt_pk_bf16_f32 v192, v112, v113
    v_cvt_pk_bf16_f32 v193, v114, v115
    v_cvt_pk_bf16_f32 v194, v116, v117
    v_cvt_pk_bf16_f32 v195, v118, v119
    ds_write_b64 v4, v[192:193] offset:3328
    ds_write_b64 v4, v[194:195] offset:3456
    v_pk_fma_f32 v[120:121], v[136:137], v[112:113], v[120:121]
    v_pk_fma_f32 v[124:125], v[136:137], v[116:117], v[124:125]
    v_pk_fma_f32 v[122:123], v[138:139], v[114:115], v[122:123]
    v_pk_fma_f32 v[126:127], v[138:139], v[118:119], v[126:127]
    v_pk_fma_f32 v[120:121], v[140:141], v[116:117], v[120:121] neg_lo:[1,0,0] neg_hi:[1,0,0]
    v_pk_fma_f32 v[124:125], v[140:141], v[112:113], v[124:125]
    v_pk_fma_f32 v[122:123], v[142:143], v[118:119], v[122:123] neg_lo:[1,0,0] neg_hi:[1,0,0]
    v_pk_fma_f32 v[126:127], v[142:143], v[114:115], v[126:127]
    v_cvt_pk_bf16_f32 v188, v120, v121
    v_cvt_pk_bf16_f32 v189, v122, v123
    v_cvt_pk_bf16_f32 v190, v124, v125
    v_cvt_pk_bf16_f32 v191, v126, v127
    ds_write_b64 v4, v[188:189] offset:3584
    ds_write_b64 v4, v[190:191] offset:3712
    v_pk_fma_f32 v[128:129], v[136:137], v[120:121], v[128:129]
    v_pk_fma_f32 v[132:133], v[136:137], v[124:125], v[132:133]
    v_pk_fma_f32 v[130:131], v[138:139], v[122:123], v[130:131]
    v_pk_fma_f32 v[134:135], v[138:139], v[126:127], v[134:135]
    v_pk_fma_f32 v[128:129], v[140:141], v[124:125], v[128:129] neg_lo:[1,0,0] neg_hi:[1,0,0]
    v_pk_fma_f32 v[132:133], v[140:141], v[120:121], v[132:133]
    v_pk_fma_f32 v[130:131], v[142:143], v[126:127], v[130:131] neg_lo:[1,0,0] neg_hi:[1,0,0]
    v_pk_fma_f32 v[134:135], v[142:143], v[122:123], v[134:135]
    v_cvt_pk_bf16_f32 v192, v128, v129
    v_cvt_pk_bf16_f32 v193, v130, v131
    v_cvt_pk_bf16_f32 v194, v132, v133
    v_cvt_pk_bf16_f32 v195, v134, v135
    ds_write_b64 v4, v[192:193] offset:3840
    ds_write_b64 v4, v[194:195] offset:3968
    s_add_u32 s64, s34, 16777216
    s_addc_u32 s65, s35, 0
    s_mov_b32 s66, 8388608
    s_mov_b32 s67, 0x20000
    v_lshrrev_b32 v2, 4, v1
    v_and_b32 v5, 15, v1
    v_lshlrev_b32 v3, 8, v2
    v_lshl_add_u32 v3, v5, 4, v3
    s_mul_i32 s44, s41, 16640
    s_add_u32 s44, s44, s63
    v_add_u32 v3, s44, v3
    v_lshlrev_b32 v2, 12, v2
    v_lshrrev_b32 v4, 3, v5
    v_lshl_add_u32 v2, v4, 11, v2
    v_and_b32 v5, 7, v5
    v_lshl_add_u32 v2, v5, 4, v2
    s_lshl_b32 s44, s37, 2
    s_add_u32 s44, s44, s36
    s_lshl_b32 s44, s44, 18
    s_lshl_b32 s45, s38, 7
    s_add_u32 s44, s44, s45
    v_add_u32 v2, s44, v2
    s_waitcnt lgkmcnt(0)
    s_barrier
    ds_read_b128 v[8:11], v3 offset:0
    ds_read_b128 v[12:15], v3 offset:1024
    ds_read_b128 v[16:19], v3 offset:2048
    ds_read_b128 v[20:23], v3 offset:3072
    ds_read_b128 v[24:27], v3 offset:4160
    ds_read_b128 v[28:31], v3 offset:5184
    ds_read_b128 v[32:35], v3 offset:6208
    ds_read_b128 v[36:39], v3 offset:7232
    ds_read_b128 v[40:43], v3 offset:8320
    ds_read_b128 v[44:47], v3 offset:9344
    ds_read_b128 v[48:51], v3 offset:10368
    ds_read_b128 v[52:55], v3 offset:11392
    ds_read_b128 v[56:59], v3 offset:12480
    ds_read_b128 v[60:63], v3 offset:13504
    ds_read_b128 v[64:67], v3 offset:14528
    ds_read_b128 v[68:71], v3 offset:15552
    s_waitcnt lgkmcnt(15)
    s_mov_b32 s46, 0
    buffer_store_dwordx4 v[8:11], v2, s[64:67], s46 offen sc1
    s_waitcnt lgkmcnt(14)
    s_mov_b32 s46, 16384
    buffer_store_dwordx4 v[12:15], v2, s[64:67], s46 offen sc1
    s_waitcnt lgkmcnt(13)
    s_mov_b32 s46, 32768
    buffer_store_dwordx4 v[16:19], v2, s[64:67], s46 offen sc1
    s_waitcnt lgkmcnt(12)
    s_mov_b32 s46, 49152
    buffer_store_dwordx4 v[20:23], v2, s[64:67], s46 offen sc1
    s_waitcnt lgkmcnt(11)
    s_mov_b32 s46, 65536
    buffer_store_dwordx4 v[24:27], v2, s[64:67], s46 offen sc1
    s_waitcnt lgkmcnt(10)
    s_mov_b32 s46, 81920
    buffer_store_dwordx4 v[28:31], v2, s[64:67], s46 offen sc1
    s_waitcnt lgkmcnt(9)
    s_mov_b32 s46, 98304
    buffer_store_dwordx4 v[32:35], v2, s[64:67], s46 offen sc1
    s_waitcnt lgkmcnt(8)
    s_mov_b32 s46, 114688
    buffer_store_dwordx4 v[36:39], v2, s[64:67], s46 offen sc1
    s_waitcnt lgkmcnt(7)
    s_mov_b32 s46, 131072
    buffer_store_dwordx4 v[40:43], v2, s[64:67], s46 offen sc1
    s_waitcnt lgkmcnt(6)
    s_mov_b32 s46, 147456
    buffer_store_dwordx4 v[44:47], v2, s[64:67], s46 offen sc1
    s_waitcnt lgkmcnt(5)
    s_mov_b32 s46, 163840
    buffer_store_dwordx4 v[48:51], v2, s[64:67], s46 offen sc1
    s_waitcnt lgkmcnt(4)
    s_mov_b32 s46, 180224
    buffer_store_dwordx4 v[52:55], v2, s[64:67], s46 offen sc1
    s_waitcnt lgkmcnt(3)
    s_mov_b32 s46, 196608
    buffer_store_dwordx4 v[56:59], v2, s[64:67], s46 offen sc1
    s_waitcnt lgkmcnt(2)
    s_mov_b32 s46, 212992
    buffer_store_dwordx4 v[60:63], v2, s[64:67], s46 offen sc1
    s_waitcnt lgkmcnt(1)
    s_mov_b32 s46, 229376
    buffer_store_dwordx4 v[64:67], v2, s[64:67], s46 offen sc1
    s_waitcnt lgkmcnt(0)
    s_mov_b32 s46, 245760
    buffer_store_dwordx4 v[68:71], v2, s[64:67], s46 offen sc1
    s_waitcnt vmcnt(0)
    s_barrier
    s_cmp_eq_u32 s36, 0
    s_cbranch_scc0 Lsig_56
    s_add_u32 s68, s34, 10485760
    s_addc_u32 s69, s35, 0
    s_mov_b32 s70, 65536
    s_mov_b32 s71, 0x20000
    v_lshlrev_b32 v236, 7, v1
    s_lshl_b32 s72, s37, 11
    s_lshl_b32 s73, s38, 3
    s_add_u32 s72, s72, s73
    s_add_u32 s72, s72, 49152
    v_add_u32 v236, s72, v236
    v_mov_b32 v238, s43
    v_xor_b32 v239, 1540483477, v238
    s_mov_b64 s[72:73], exec
    s_mov_b64 exec, 65535
    buffer_store_dwordx2 v[238:239], v236, s[68:71], 0 offen sc1
    s_mov_b64 exec, s[72:73]
Lsig_56:
    s_lshr_b32 s40, s36, 1
    s_and_b32 s41, s36, 1
    s_lshl_b32 s50, s37, 8
    s_and_b32 s44, s38, 1
    s_lshl_b32 s44, s44, 7
    s_add_u32 s50, s50, s44
    s_lshl_b32 s44, s40, 6
    s_add_u32 s50, s50, s44
    s_lshr_b32 s51, s38, 1
    s_lshl_b32 s51, s51, 7
    s_lshl_b32 s44, s41, 6
    s_add_u32 s51, s51, s44
    v_and_b32 v72, 15, v1
    v_add_u32 v72, s50, v72
    v_lshrrev_b32 v73, 4, v1
    v_lshlrev_b32 v73, 2, v73
    v_add_u32 v73, s51, v73
    s_mov_b32 s52, s28
    s_mov_b32 s53, s29
    s_mov_b32 s54, 2048
    s_mov_b32 s55, 0x20000
    v_lshlrev_b32 v3, 1, v73
    buffer_load_dwordx2 v[74:75], v3, s[52:55], 0 offen offset:0
    buffer_load_dwordx2 v[76:77], v3, s[52:55], 0 offen offset:32
    buffer_load_dwordx2 v[78:79], v3, s[52:55], 0 offen offset:64
    buffer_load_dwordx2 v[80:81], v3, s[52:55], 0 offen offset:96
    v_and_b32 v2, 15, v1
    v_lshlrev_b32 v2, 7, v2
    v_lshrrev_b32 v3, 4, v1
    v_bfe_u32 v4, v1, 1, 3
    v_xor_b32 v3, v3, v4
    v_lshl_add_u32 v2, v3, 4, v2
    s_mul_i32 s44, s40, 8192
    s_add_u32 s44, s44, 0
    v_add_u32 v2, s44, v2
    v_xor_b32 v82, 0, v2
    v_xor_b32 v83, 64, v2
    v_and_b32 v2, 15, v1
    v_lshlrev_b32 v2, 7, v2
    v_lshrrev_b32 v3, 4, v1
    v_bfe_u32 v4, v1, 1, 3
    v_xor_b32 v3, v3, v4
    v_lshl_add_u32 v2, v3, 4, v2
    s_mul_i32 s44, s41, 8192
    s_add_u32 s44, s44, 16384
    v_add_u32 v2, s44, v2
    v_xor_b32 v86, 0, v2
    v_xor_b32 v87, 64, v2
    s_barrier
    v_mov_b32 v8, 0
    v_mov_b32 v9, 0
    v_mov_b32 v10, 0
    v_mov_b32 v11, 0
    v_mov_b32 v12, 0
    v_mov_b32 v13, 0
    v_mov_b32 v14, 0
    v_mov_b32 v15, 0
    v_mov_b32 v16, 0
    v_mov_b32 v17, 0
    v_mov_b32 v18, 0
    v_mov_b32 v19, 0
    v_mov_b32 v20, 0
    v_mov_b32 v21, 0
    v_mov_b32 v22, 0
    v_mov_b32 v23, 0
    v_mov_b32 v24, 0
    v_mov_b32 v25, 0
    v_mov_b32 v26, 0
    v_mov_b32 v27, 0
    v_mov_b32 v28, 0
    v_mov_b32 v29, 0
    v_mov_b32 v30, 0
    v_mov_b32 v31, 0
    v_mov_b32 v32, 0
    v_mov_b32 v33, 0
    v_mov_b32 v34, 0
    v_mov_b32 v35, 0
    v_mov_b32 v36, 0
    v_mov_b32 v37, 0
    v_mov_b32 v38, 0
    v_mov_b32 v39, 0
    v_mov_b32 v40, 0
    v_mov_b32 v41, 0
    v_mov_b32 v42, 0
    v_mov_b32 v43, 0
    v_mov_b32 v44, 0
    v_mov_b32 v45, 0
    v_mov_b32 v46, 0
    v_mov_b32 v47, 0
    v_mov_b32 v48, 0
    v_mov_b32 v49, 0
    v_mov_b32 v50, 0
    v_mov_b32 v51, 0
    v_mov_b32 v52, 0
    v_mov_b32 v53, 0
    v_mov_b32 v54, 0
    v_mov_b32 v55, 0
    v_mov_b32 v56, 0
    v_mov_b32 v57, 0
    v_mov_b32 v58, 0
    v_mov_b32 v59, 0
    v_mov_b32 v60, 0
    v_mov_b32 v61, 0
    v_mov_b32 v62, 0
    v_mov_b32 v63, 0
    v_mov_b32 v64, 0
    v_mov_b32 v65, 0
    v_mov_b32 v66, 0
    v_mov_b32 v67, 0
    v_mov_b32 v68, 0
    v_mov_b32 v69, 0
    v_mov_b32 v70, 0
    v_mov_b32 v71, 0
    s_mov_b32 s48, 0
    v_add_u32 v84, s48, v82
    v_add_u32 v85, s48, v83
    v_add_u32 v88, s48, v86
    v_add_u32 v89, s48, v87
    s_barrier
    ds_read_b128 v[92:95], v84 offset:0
    ds_read_b128 v[96:99], v84 offset:2048
    ds_read_b128 v[100:103], v84 offset:4096
    ds_read_b128 v[104:107], v84 offset:6144
    ds_read_b128 v[124:127], v88 offset:0
    ds_read_b128 v[128:131], v88 offset:2048
    ds_read_b128 v[132:135], v88 offset:4096
    ds_read_b128 v[136:139], v88 offset:6144
    s_mov_b32 s49, 0
Lmm_57:
    s_waitcnt lgkmcnt(0)
    v_mfma_f32_16x16x32_bf16 v[8:11], v[124:127], v[92:95], v[8:11]
    ds_read_b128 v[108:111], v85 offset:0
    v_mfma_f32_16x16x32_bf16 v[12:15], v[128:131], v[92:95], v[12:15]
    ds_read_b128 v[112:115], v85 offset:2048
    v_mfma_f32_16x16x32_bf16 v[16:19], v[132:135], v[92:95], v[16:19]
    ds_read_b128 v[116:119], v85 offset:4096
    v_mfma_f32_16x16x32_bf16 v[20:23], v[136:139], v[92:95], v[20:23]
    ds_read_b128 v[120:123], v85 offset:6144
    v_mfma_f32_16x16x32_bf16 v[24:27], v[124:127], v[96:99], v[24:27]
    ds_read_b128 v[140:143], v89 offset:0
    v_mfma_f32_16x16x32_bf16 v[28:31], v[128:131], v[96:99], v[28:31]
    ds_read_b128 v[144:147], v89 offset:2048
    v_mfma_f32_16x16x32_bf16 v[32:35], v[132:135], v[96:99], v[32:35]
    ds_read_b128 v[148:151], v89 offset:4096
    v_mfma_f32_16x16x32_bf16 v[36:39], v[136:139], v[96:99], v[36:39]
    ds_read_b128 v[152:155], v89 offset:6144
    v_mfma_f32_16x16x32_bf16 v[40:43], v[124:127], v[100:103], v[40:43]
    s_add_u32 s48, s48, 32768
    s_cmp_ge_u32 s48, 131072
    s_cselect_b32 s48, 0, s48
    v_mfma_f32_16x16x32_bf16 v[44:47], v[128:131], v[100:103], v[44:47]
    v_add_u32 v84, s48, v82
    v_mfma_f32_16x16x32_bf16 v[48:51], v[132:135], v[100:103], v[48:51]
    v_add_u32 v85, s48, v83
    v_mfma_f32_16x16x32_bf16 v[52:55], v[136:139], v[100:103], v[52:55]
    v_add_u32 v88, s48, v86
    v_mfma_f32_16x16x32_bf16 v[56:59], v[124:127], v[104:107], v[56:59]
    v_add_u32 v89, s48, v87
    v_mfma_f32_16x16x32_bf16 v[60:63], v[128:131], v[104:107], v[60:63]
    v_mfma_f32_16x16x32_bf16 v[64:67], v[132:135], v[104:107], v[64:67]
    v_mfma_f32_16x16x32_bf16 v[68:71], v[136:139], v[104:107], v[68:71]
    s_waitcnt lgkmcnt(0)
    v_mfma_f32_16x16x32_bf16 v[8:11], v[140:143], v[108:111], v[8:11]
    s_barrier
    ds_read_b128 v[92:95], v84 offset:0
    v_mfma_f32_16x16x32_bf16 v[12:15], v[144:147], v[108:111], v[12:15]
    ds_read_b128 v[96:99], v84 offset:2048
    v_mfma_f32_16x16x32_bf16 v[16:19], v[148:151], v[108:111], v[16:19]
    ds_read_b128 v[100:103], v84 offset:4096
    v_mfma_f32_16x16x32_bf16 v[20:23], v[152:155], v[108:111], v[20:23]
    ds_read_b128 v[104:107], v84 offset:6144
    v_mfma_f32_16x16x32_bf16 v[24:27], v[140:143], v[112:115], v[24:27]
    ds_read_b128 v[124:127], v88 offset:0
    v_mfma_f32_16x16x32_bf16 v[28:31], v[144:147], v[112:115], v[28:31]
    ds_read_b128 v[128:131], v88 offset:2048
    v_mfma_f32_16x16x32_bf16 v[32:35], v[148:151], v[112:115], v[32:35]
    ds_read_b128 v[132:135], v88 offset:4096
    v_mfma_f32_16x16x32_bf16 v[36:39], v[152:155], v[112:115], v[36:39]
    ds_read_b128 v[136:139], v88 offset:6144
    v_mfma_f32_16x16x32_bf16 v[40:43], v[140:143], v[116:119], v[40:43]
    v_mfma_f32_16x16x32_bf16 v[44:47], v[144:147], v[116:119], v[44:47]
    v_mfma_f32_16x16x32_bf16 v[48:51], v[148:151], v[116:119], v[48:51]
    v_mfma_f32_16x16x32_bf16 v[52:55], v[152:155], v[116:119], v[52:55]
    v_mfma_f32_16x16x32_bf16 v[56:59], v[140:143], v[120:123], v[56:59]
    v_mfma_f32_16x16x32_bf16 v[60:63], v[144:147], v[120:123], v[60:63]
    v_mfma_f32_16x16x32_bf16 v[64:67], v[148:151], v[120:123], v[64:67]
    v_mfma_f32_16x16x32_bf16 v[68:71], v[152:155], v[120:123], v[68:71]
    s_add_u32 s49, s49, 1
    s_cmp_lt_u32 s49, 32
    s_cbranch_scc1 Lmm_57
    s_waitcnt lgkmcnt(0)
    s_mov_b32 s52, s30
    s_mov_b32 s53, s31
    s_mov_b32 s54, 16777216
    s_mov_b32 s55, 0x20000
    v_lshlrev_b32 v2, 13, v72
    v_lshl_add_u32 v2, v73, 2, v2
    v_add_u32 v2, 4096, v2
    v_and_b32 v3, 15, v1
    v_lshrrev_b32 v4, 5, v1
    s_lshl_b32 s44, s41, 3
    v_or_b32 v4, s44, v4
    v_xor_b32 v4, v4, v3
    v_lshlrev_b32 v3, 8, v3
    v_lshl_add_u32 v3, v4, 4, v3
    v_bfe_u32 v4, v1, 4, 1
    v_lshl_add_u32 v3, v4, 3, v3
    s_lshl_b32 s44, s40, 14
    s_add_u32 s44, s44, s48
    v_add_u32 v3, s44, v3
    v_xor_b32 v114, 0, v3
    v_xor_b32 v115, 32, v3
    v_xor_b32 v116, 64, v3
    v_xor_b32 v117, 96, v3
    ds_read_b64 v[82:83], v114 offset:0
    ds_read_b64 v[84:85], v115 offset:0
    ds_read_b64 v[86:87], v116 offset:0
    ds_read_b64 v[88:89], v117 offset:0
    ds_read_b64 v[90:91], v114 offset:4096
    ds_read_b64 v[92:93], v115 offset:4096
    ds_read_b64 v[94:95], v116 offset:4096
    ds_read_b64 v[96:97], v117 offset:4096
    ds_read_b64 v[98:99], v114 offset:8192
    ds_read_b64 v[100:101], v115 offset:8192
    ds_read_b64 v[102:103], v116 offset:8192
    ds_read_b64 v[104:105], v117 offset:8192
    ds_read_b64 v[106:107], v114 offset:12288
    ds_read_b64 v[108:109], v115 offset:12288
    ds_read_b64 v[110:111], v116 offset:12288
    ds_read_b64 v[112:113], v117 offset:12288
    s_waitcnt vmcnt(0) lgkmcnt(0)
    v_lshlrev_b32 v128, 16, v74
    v_and_b32 v129, 0xffff0000, v74
    v_lshlrev_b32 v130, 16, v75
    v_and_b32 v131, 0xffff0000, v75
    v_lshlrev_b32 v132, 16, v76
    v_and_b32 v133, 0xffff0000, v76
    v_lshlrev_b32 v134, 16, v77
    v_and_b32 v135, 0xffff0000, v77
    v_lshlrev_b32 v136, 16, v78
    v_and_b32 v137, 0xffff0000, v78
    v_lshlrev_b32 v138, 16, v79
    v_and_b32 v139, 0xffff0000, v79
    v_lshlrev_b32 v140, 16, v80
    v_and_b32 v141, 0xffff0000, v80
    v_lshlrev_b32 v142, 16, v81
    v_and_b32 v143, 0xffff0000, v81
    s_lshl_b32 s56, s36, 14
    s_add_u32 s56, s56, s48
    s_add_u32 s56, s56, 32768
    s_and_b32 s56, s56, 0x1ffff
    v_and_b32 v3, 15, v1
    v_lshrrev_b32 v4, 4, v1
    v_xor_b32 v4, v4, v3
    v_lshlrev_b32 v3, 8, v3
    v_lshl_add_u32 v3, v4, 4, v3
    v_add_u32 v3, s56, v3
    v_xor_b32 v144, 0, v3
    v_xor_b32 v145, 64, v3
    v_xor_b32 v146, 128, v3
    v_xor_b32 v147, 192, v3
    s_mov_b32 s44, 0
    v_lshlrev_b32 v120, 16, v82
    v_and_b32 v121, 0xffff0000, v82
    v_lshlrev_b32 v122, 16, v83
    v_and_b32 v123, 0xffff0000, v83
    v_mul_f32 v120, v120, v128
    v_mul_f32 v121, v121, v129
    v_mul_f32 v122, v122, v130
    v_mul_f32 v123, v123, v131
    v_cvt_pk_bf16_f32 v124, v120, v121
    v_cvt_pk_bf16_f32 v125, v122, v123
    v_lshlrev_b32 v120, 16, v124
    v_and_b32 v121, 0xffff0000, v124
    v_lshlrev_b32 v122, 16, v125
    v_and_b32 v123, 0xffff0000, v125
    v_add_f32 v8, v8, v120
    v_add_f32 v9, v9, v121
    v_add_f32 v10, v10, v122
    v_add_f32 v11, v11, v123
    ds_write_b128 v144, v[8:11] offset:0
    v_lshlrev_b32 v120, 16, v84
    v_and_b32 v121, 0xffff0000, v84
    v_lshlrev_b32 v122, 16, v85
    v_and_b32 v123, 0xffff0000, v85
    v_mul_f32 v120, v120, v132
    v_mul_f32 v121, v121, v133
    v_mul_f32 v122, v122, v134
    v_mul_f32 v123, v123, v135
    v_cvt_pk_bf16_f32 v124, v120, v121
    v_cvt_pk_bf16_f32 v125, v122, v123
    v_lshlrev_b32 v120, 16, v124
    v_and_b32 v121, 0xffff0000, v124
    v_lshlrev_b32 v122, 16, v125
    v_and_b32 v123, 0xffff0000, v125
    v_add_f32 v12, v12, v120
    v_add_f32 v13, v13, v121
    v_add_f32 v14, v14, v122
    v_add_f32 v15, v15, v123
    ds_write_b128 v145, v[12:15] offset:0
    v_lshlrev_b32 v120, 16, v86
    v_and_b32 v121, 0xffff0000, v86
    v_lshlrev_b32 v122, 16, v87
    v_and_b32 v123, 0xffff0000, v87
    v_mul_f32 v120, v120, v136
    v_mul_f32 v121, v121, v137
    v_mul_f32 v122, v122, v138
    v_mul_f32 v123, v123, v139
    v_cvt_pk_bf16_f32 v124, v120, v121
    v_cvt_pk_bf16_f32 v125, v122, v123
    v_lshlrev_b32 v120, 16, v124
    v_and_b32 v121, 0xffff0000, v124
    v_lshlrev_b32 v122, 16, v125
    v_and_b32 v123, 0xffff0000, v125
    v_add_f32 v16, v16, v120
    v_add_f32 v17, v17, v121
    v_add_f32 v18, v18, v122
    v_add_f32 v19, v19, v123
    ds_write_b128 v146, v[16:19] offset:0
    v_lshlrev_b32 v120, 16, v88
    v_and_b32 v121, 0xffff0000, v88
    v_lshlrev_b32 v122, 16, v89
    v_and_b32 v123, 0xffff0000, v89
    v_mul_f32 v120, v120, v140
    v_mul_f32 v121, v121, v141
    v_mul_f32 v122, v122, v142
    v_mul_f32 v123, v123, v143
    v_cvt_pk_bf16_f32 v124, v120, v121
    v_cvt_pk_bf16_f32 v125, v122, v123
    v_lshlrev_b32 v120, 16, v124
    v_and_b32 v121, 0xffff0000, v124
    v_lshlrev_b32 v122, 16, v125
    v_and_b32 v123, 0xffff0000, v125
    v_add_f32 v20, v20, v120
    v_add_f32 v21, v21, v121
    v_add_f32 v22, v22, v122
    v_add_f32 v23, v23, v123
    ds_write_b128 v147, v[20:23] offset:0
    s_mov_b32 s44, 131072
    v_lshlrev_b32 v120, 16, v90
    v_and_b32 v121, 0xffff0000, v90
    v_lshlrev_b32 v122, 16, v91
    v_and_b32 v123, 0xffff0000, v91
    v_mul_f32 v120, v120, v128
    v_mul_f32 v121, v121, v129
    v_mul_f32 v122, v122, v130
    v_mul_f32 v123, v123, v131
    v_cvt_pk_bf16_f32 v124, v120, v121
    v_cvt_pk_bf16_f32 v125, v122, v123
    v_lshlrev_b32 v120, 16, v124
    v_and_b32 v121, 0xffff0000, v124
    v_lshlrev_b32 v122, 16, v125
    v_and_b32 v123, 0xffff0000, v125
    v_add_f32 v24, v24, v120
    v_add_f32 v25, v25, v121
    v_add_f32 v26, v26, v122
    v_add_f32 v27, v27, v123
    ds_write_b128 v144, v[24:27] offset:4096
    v_lshlrev_b32 v120, 16, v92
    v_and_b32 v121, 0xffff0000, v92
    v_lshlrev_b32 v122, 16, v93
    v_and_b32 v123, 0xffff0000, v93
    v_mul_f32 v120, v120, v132
    v_mul_f32 v121, v121, v133
    v_mul_f32 v122, v122, v134
    v_mul_f32 v123, v123, v135
    v_cvt_pk_bf16_f32 v124, v120, v121
    v_cvt_pk_bf16_f32 v125, v122, v123
    v_lshlrev_b32 v120, 16, v124
    v_and_b32 v121, 0xffff0000, v124
    v_lshlrev_b32 v122, 16, v125
    v_and_b32 v123, 0xffff0000, v125
    v_add_f32 v28, v28, v120
    v_add_f32 v29, v29, v121
    v_add_f32 v30, v30, v122
    v_add_f32 v31, v31, v123
    ds_write_b128 v145, v[28:31] offset:4096
    v_lshlrev_b32 v120, 16, v94
    v_and_b32 v121, 0xffff0000, v94
    v_lshlrev_b32 v122, 16, v95
    v_and_b32 v123, 0xffff0000, v95
    v_mul_f32 v120, v120, v136
    v_mul_f32 v121, v121, v137
    v_mul_f32 v122, v122, v138
    v_mul_f32 v123, v123, v139
    v_cvt_pk_bf16_f32 v124, v120, v121
    v_cvt_pk_bf16_f32 v125, v122, v123
    v_lshlrev_b32 v120, 16, v124
    v_and_b32 v121, 0xffff0000, v124
    v_lshlrev_b32 v122, 16, v125
    v_and_b32 v123, 0xffff0000, v125
    v_add_f32 v32, v32, v120
    v_add_f32 v33, v33, v121
    v_add_f32 v34, v34, v122
    v_add_f32 v35, v35, v123
    ds_write_b128 v146, v[32:35] offset:4096
    v_lshlrev_b32 v120, 16, v96
    v_and_b32 v121, 0xffff0000, v96
    v_lshlrev_b32 v122, 16, v97
    v_and_b32 v123, 0xffff0000, v97
    v_mul_f32 v120, v120, v140
    v_mul_f32 v121, v121, v141
    v_mul_f32 v122, v122, v142
    v_mul_f32 v123, v123, v143
    v_cvt_pk_bf16_f32 v124, v120, v121
    v_cvt_pk_bf16_f32 v125, v122, v123
    v_lshlrev_b32 v120, 16, v124
    v_and_b32 v121, 0xffff0000, v124
    v_lshlrev_b32 v122, 16, v125
    v_and_b32 v123, 0xffff0000, v125
    v_add_f32 v36, v36, v120
    v_add_f32 v37, v37, v121
    v_add_f32 v38, v38, v122
    v_add_f32 v39, v39, v123
    ds_write_b128 v147, v[36:39] offset:4096
    s_mov_b32 s44, 262144
    v_lshlrev_b32 v120, 16, v98
    v_and_b32 v121, 0xffff0000, v98
    v_lshlrev_b32 v122, 16, v99
    v_and_b32 v123, 0xffff0000, v99
    v_mul_f32 v120, v120, v128
    v_mul_f32 v121, v121, v129
    v_mul_f32 v122, v122, v130
    v_mul_f32 v123, v123, v131
    v_cvt_pk_bf16_f32 v124, v120, v121
    v_cvt_pk_bf16_f32 v125, v122, v123
    v_lshlrev_b32 v120, 16, v124
    v_and_b32 v121, 0xffff0000, v124
    v_lshlrev_b32 v122, 16, v125
    v_and_b32 v123, 0xffff0000, v125
    v_add_f32 v40, v40, v120
    v_add_f32 v41, v41, v121
    v_add_f32 v42, v42, v122
    v_add_f32 v43, v43, v123
    ds_write_b128 v144, v[40:43] offset:8192
    v_lshlrev_b32 v120, 16, v100
    v_and_b32 v121, 0xffff0000, v100
    v_lshlrev_b32 v122, 16, v101
    v_and_b32 v123, 0xffff0000, v101
    v_mul_f32 v120, v120, v132
    v_mul_f32 v121, v121, v133
    v_mul_f32 v122, v122, v134
    v_mul_f32 v123, v123, v135
    v_cvt_pk_bf16_f32 v124, v120, v121
    v_cvt_pk_bf16_f32 v125, v122, v123
    v_lshlrev_b32 v120, 16, v124
    v_and_b32 v121, 0xffff0000, v124
    v_lshlrev_b32 v122, 16, v125
    v_and_b32 v123, 0xffff0000, v125
    v_add_f32 v44, v44, v120
    v_add_f32 v45, v45, v121
    v_add_f32 v46, v46, v122
    v_add_f32 v47, v47, v123
    ds_write_b128 v145, v[44:47] offset:8192
    v_lshlrev_b32 v120, 16, v102
    v_and_b32 v121, 0xffff0000, v102
    v_lshlrev_b32 v122, 16, v103
    v_and_b32 v123, 0xffff0000, v103
    v_mul_f32 v120, v120, v136
    v_mul_f32 v121, v121, v137
    v_mul_f32 v122, v122, v138
    v_mul_f32 v123, v123, v139
    v_cvt_pk_bf16_f32 v124, v120, v121
    v_cvt_pk_bf16_f32 v125, v122, v123
    v_lshlrev_b32 v120, 16, v124
    v_and_b32 v121, 0xffff0000, v124
    v_lshlrev_b32 v122, 16, v125
    v_and_b32 v123, 0xffff0000, v125
    v_add_f32 v48, v48, v120
    v_add_f32 v49, v49, v121
    v_add_f32 v50, v50, v122
    v_add_f32 v51, v51, v123
    ds_write_b128 v146, v[48:51] offset:8192
    v_lshlrev_b32 v120, 16, v104
    v_and_b32 v121, 0xffff0000, v104
    v_lshlrev_b32 v122, 16, v105
    v_and_b32 v123, 0xffff0000, v105
    v_mul_f32 v120, v120, v140
    v_mul_f32 v121, v121, v141
    v_mul_f32 v122, v122, v142
    v_mul_f32 v123, v123, v143
    v_cvt_pk_bf16_f32 v124, v120, v121
    v_cvt_pk_bf16_f32 v125, v122, v123
    v_lshlrev_b32 v120, 16, v124
    v_and_b32 v121, 0xffff0000, v124
    v_lshlrev_b32 v122, 16, v125
    v_and_b32 v123, 0xffff0000, v125
    v_add_f32 v52, v52, v120
    v_add_f32 v53, v53, v121
    v_add_f32 v54, v54, v122
    v_add_f32 v55, v55, v123
    ds_write_b128 v147, v[52:55] offset:8192
    s_mov_b32 s44, 393216
    v_lshlrev_b32 v120, 16, v106
    v_and_b32 v121, 0xffff0000, v106
    v_lshlrev_b32 v122, 16, v107
    v_and_b32 v123, 0xffff0000, v107
    v_mul_f32 v120, v120, v128
    v_mul_f32 v121, v121, v129
    v_mul_f32 v122, v122, v130
    v_mul_f32 v123, v123, v131
    v_cvt_pk_bf16_f32 v124, v120, v121
    v_cvt_pk_bf16_f32 v125, v122, v123
    v_lshlrev_b32 v120, 16, v124
    v_and_b32 v121, 0xffff0000, v124
    v_lshlrev_b32 v122, 16, v125
    v_and_b32 v123, 0xffff0000, v125
    v_add_f32 v56, v56, v120
    v_add_f32 v57, v57, v121
    v_add_f32 v58, v58, v122
    v_add_f32 v59, v59, v123
    ds_write_b128 v144, v[56:59] offset:12288
    v_lshlrev_b32 v120, 16, v108
    v_and_b32 v121, 0xffff0000, v108
    v_lshlrev_b32 v122, 16, v109
    v_and_b32 v123, 0xffff0000, v109
    v_mul_f32 v120, v120, v132
    v_mul_f32 v121, v121, v133
    v_mul_f32 v122, v122, v134
    v_mul_f32 v123, v123, v135
    v_cvt_pk_bf16_f32 v124, v120, v121
    v_cvt_pk_bf16_f32 v125, v122, v123
    v_lshlrev_b32 v120, 16, v124
    v_and_b32 v121, 0xffff0000, v124
    v_lshlrev_b32 v122, 16, v125
    v_and_b32 v123, 0xffff0000, v125
    v_add_f32 v60, v60, v120
    v_add_f32 v61, v61, v121
    v_add_f32 v62, v62, v122
    v_add_f32 v63, v63, v123
    ds_write_b128 v145, v[60:63] offset:12288
    v_lshlrev_b32 v120, 16, v110
    v_and_b32 v121, 0xffff0000, v110
    v_lshlrev_b32 v122, 16, v111
    v_and_b32 v123, 0xffff0000, v111
    v_mul_f32 v120, v120, v136
    v_mul_f32 v121, v121, v137
    v_mul_f32 v122, v122, v138
    v_mul_f32 v123, v123, v139
    v_cvt_pk_bf16_f32 v124, v120, v121
    v_cvt_pk_bf16_f32 v125, v122, v123
    v_lshlrev_b32 v120, 16, v124
    v_and_b32 v121, 0xffff0000, v124
    v_lshlrev_b32 v122, 16, v125
    v_and_b32 v123, 0xffff0000, v125
    v_add_f32 v64, v64, v120
    v_add_f32 v65, v65, v121
    v_add_f32 v66, v66, v122
    v_add_f32 v67, v67, v123
    ds_write_b128 v146, v[64:67] offset:12288
    v_lshlrev_b32 v120, 16, v112
    v_and_b32 v121, 0xffff0000, v112
    v_lshlrev_b32 v122, 16, v113
    v_and_b32 v123, 0xffff0000, v113
    v_mul_f32 v120, v120, v140
    v_mul_f32 v121, v121, v141
    v_mul_f32 v122, v122, v142
    v_mul_f32 v123, v123, v143
    v_cvt_pk_bf16_f32 v124, v120, v121
    v_cvt_pk_bf16_f32 v125, v122, v123
    v_lshlrev_b32 v120, 16, v124
    v_and_b32 v121, 0xffff0000, v124
    v_lshlrev_b32 v122, 16, v125
    v_and_b32 v123, 0xffff0000, v125
    v_add_f32 v68, v68, v120
    v_add_f32 v69, v69, v121
    v_add_f32 v70, v70, v122
    v_add_f32 v71, v71, v123
    ds_write_b128 v147, v[68:71] offset:12288
    v_lshrrev_b32 v3, 4, v1
    v_xor_b32 v4, v3, v1
    v_and_b32 v4, 15, v4
    v_lshlrev_b32 v5, 8, v3
    v_lshl_add_u32 v5, v4, 4, v5
    v_add_u32 v5, s56, v5
    v_xor_b32 v148, 0, v5
    v_xor_b32 v149, 64, v5
    v_xor_b32 v150, 128, v5
    v_xor_b32 v151, 192, v5
    v_add_u32 v3, s50, v3
    v_lshlrev_b32 v3, 13, v3
    v_and_b32 v4, 15, v1
    v_lshl_add_u32 v3, v4, 4, v3
    s_lshl_b32 s45, s51, 2
    s_add_u32 s45, s45, 4096
    v_add_u32 v3, s45, v3
    s_waitcnt lgkmcnt(0)
    ds_read_b128 v[8:11], v148 offset:0
    ds_read_b128 v[12:15], v149 offset:1024
    ds_read_b128 v[16:19], v150 offset:2048
    ds_read_b128 v[20:23], v151 offset:3072
    ds_read_b128 v[24:27], v148 offset:4096
    ds_read_b128 v[28:31], v149 offset:5120
    ds_read_b128 v[32:35], v150 offset:6144
    ds_read_b128 v[36:39], v151 offset:7168
    ds_read_b128 v[40:43], v148 offset:8192
    ds_read_b128 v[44:47], v149 offset:9216
    ds_read_b128 v[48:51], v150 offset:10240
    ds_read_b128 v[52:55], v151 offset:11264
    ds_read_b128 v[56:59], v148 offset:12288
    ds_read_b128 v[60:63], v149 offset:13312
    ds_read_b128 v[64:67], v150 offset:14336
    ds_read_b128 v[68:71], v151 offset:15360
    s_waitcnt lgkmcnt(15)
    s_mov_b32 s44, 0
    buffer_store_dwordx4 v[8:11], v3, s[52:55], s44 offen sc1
    s_waitcnt lgkmcnt(14)
    s_mov_b32 s44, 32768
    buffer_store_dwordx4 v[12:15], v3, s[52:55], s44 offen sc1
    s_waitcnt lgkmcnt(13)
    s_mov_b32 s44, 65536
    buffer_store_dwordx4 v[16:19], v3, s[52:55], s44 offen sc1
    s_waitcnt lgkmcnt(12)
    s_mov_b32 s44, 98304
    buffer_store_dwordx4 v[20:23], v3, s[52:55], s44 offen sc1
    s_waitcnt lgkmcnt(11)
    s_mov_b32 s44, 131072
    buffer_store_dwordx4 v[24:27], v3, s[52:55], s44 offen sc1
    s_waitcnt lgkmcnt(10)
    s_mov_b32 s44, 163840
    buffer_store_dwordx4 v[28:31], v3, s[52:55], s44 offen sc1
    s_waitcnt lgkmcnt(9)
    s_mov_b32 s44, 196608
    buffer_store_dwordx4 v[32:35], v3, s[52:55], s44 offen sc1
    s_waitcnt lgkmcnt(8)
    s_mov_b32 s44, 229376
    buffer_store_dwordx4 v[36:39], v3, s[52:55], s44 offen sc1
    s_waitcnt lgkmcnt(7)
    s_mov_b32 s44, 262144
    buffer_store_dwordx4 v[40:43], v3, s[52:55], s44 offen sc1
    s_waitcnt lgkmcnt(6)
    s_mov_b32 s44, 294912
    buffer_store_dwordx4 v[44:47], v3, s[52:55], s44 offen sc1
    s_waitcnt lgkmcnt(5)
    s_mov_b32 s44, 327680
    buffer_store_dwordx4 v[48:51], v3, s[52:55], s44 offen sc1
    s_waitcnt lgkmcnt(4)
    s_mov_b32 s44, 360448
    buffer_store_dwordx4 v[52:55], v3, s[52:55], s44 offen sc1
    s_waitcnt lgkmcnt(3)
    s_mov_b32 s44, 393216
    buffer_store_dwordx4 v[56:59], v3, s[52:55], s44 offen sc1
    s_waitcnt lgkmcnt(2)
    s_mov_b32 s44, 425984
    buffer_store_dwordx4 v[60:63], v3, s[52:55], s44 offen sc1
    s_waitcnt lgkmcnt(1)
    s_mov_b32 s44, 458752
    buffer_store_dwordx4 v[64:67], v3, s[52:55], s44 offen sc1
    s_waitcnt lgkmcnt(0)
    s_mov_b32 s44, 491520
    buffer_store_dwordx4 v[68:71], v3, s[52:55], s44 offen sc1
    s_waitcnt vmcnt(0)
    s_endpgm
Lend_1:
    s_endpgm
.section .rodata,"a"
.p2align 6
.amdhsa_kernel concat_heads__linear_kernel_hedgehog__ssm_conv_s5__prompt_kernel
  .amdhsa_next_free_vgpr 256
  .amdhsa_next_free_sgpr 81
  .amdhsa_accum_offset 256
  .amdhsa_group_segment_fixed_size 0
  .amdhsa_kernarg_size 128
  .amdhsa_user_sgpr_count 2
  .amdhsa_user_sgpr_kernarg_segment_ptr 1
  .amdhsa_system_sgpr_workgroup_id_x 1
.end_amdhsa_kernel
```
